```python
import torch

def _softmax(x, axis=-1):
    return torch.softmax(x, dim=axis)
def _gelu(x):
    return torch.nn.functional.gelu(x, approximate="tanh")
def _silu(x):
    return torch.nn.functional.silu(x)
def _sigmoid(x):
    return torch.sigmoid(x)
def _layernorm(x, axis=-1, eps=1e-5):
    m = x.mean(dim=axis, keepdim=True)
    v = x.var(dim=axis, keepdim=True, unbiased=False)
    return (x - m) / torch.sqrt(v + eps)
def _scatter_add(tgt, idx, src, axis=0):
    return tgt.clone().index_add_(axis, idx, src)
def _segment_sum(src, seg, n):
    out = torch.zeros((n,) + src.shape[1:], dtype=src.dtype)
    return out.index_add_(0, seg, src)
def _pad(x, pw):
    flat = tuple(v for pair in reversed(pw) for v in pair)
    return torch.nn.functional.pad(x, flat)

kernel_name = 'parallel_sum__linear_attn_block__dense_activation_gelu__prompt'

def setup_inputs():

    _w = (lambda a: (lambda t: t.to(torch.bfloat16) if t.is_floating_point() else t)(torch.as_tensor(a)))
    def _A_setup():
        B, S, D = 1, 2048, 448
        return {
            "x": _w((lambda *s: torch.randn(*s, dtype=torch.bfloat16) * 0.05)(B, S, D)),
            "wqkv": _w((lambda *s: torch.randn(*s, dtype=torch.bfloat16) * 0.1)(D, 3 * D)),
            "wo": _w((lambda *s: torch.randn(*s, dtype=torch.bfloat16) * 0.05)(D, D)),
        }
    _A_in = _A_setup()

    def _B_setup():
        B, S, D, F = 1, 2048, 448, 1792
        return {
            "x": _w((lambda *s: torch.randn(*s, dtype=torch.bfloat16) * 0.05)(B, S, D)),
            "w1": _w((lambda *s: torch.randn(*s, dtype=torch.bfloat16) * 0.8)(D, F) * (D ** -0.5)),
            "b1": _w((lambda *s: torch.randn(*s, dtype=torch.bfloat16) * 12.8)(F) * 0.01),
            "w2": _w((lambda *s: torch.randn(*s, dtype=torch.bfloat16) * 0.2)(F, D) * (F ** -0.5)),
            "b2": _w((lambda *s: torch.randn(*s, dtype=torch.bfloat16) * 3.2)(D) * 0.01),
        }
    _B_in = _B_setup()

    return {
        "A_x": _A_in["x"],
        "A_wqkv": _A_in["wqkv"],
        "A_wo": _A_in["wo"],
        "B_x": _B_in["x"],
        "B_w1": _B_in["w1"],
        "B_b1": _B_in["b1"],
        "B_w2": _B_in["w2"],
        "B_b2": _B_in["b2"],
    }

def reference(A_x, A_wqkv, A_wo, B_x, B_w1, B_b1, B_w2, B_b2):
    def _A_ref(x, wqkv, wo):
        B, S, D = x.shape
        H = 16; Dh = D // H
        qkv = (lambda x, *d: x.permute(*d))((x @ wqkv).reshape(B, S, 3, H, Dh), 2, 0, 3, 1, 4)
        q, k, v = qkv[0], qkv[1], qkv[2]
        phi = lambda t: torch.where(t > 0, t + 1, torch.exp(t)) + 1e-6
        pq, pk = phi(q), phi(k)
        kv = torch.einsum("bhsd,bhse->bhde", pk, v)
        z = torch.einsum("bhsd->bhd", pk)
        num = torch.einsum("bhqd,bhde->bhqe", pq, kv)
        den = torch.einsum("bhqd,bhd->bhq", pq, z)[..., None] + 1e-6
        o = num / den
        return (lambda x, *d: x.permute(*d))(o, 0, 2, 1, 3).reshape(B, S, D) @ wo

    def _B_ref(x, w1, b1, w2, b2):
        h = torch.einsum("bsd,df->bsf", x, w1) + b1
        h = _gelu(h)
        return torch.einsum("bsf,fd->bsd", h, w2) + b2

    x = A_x
    xn = _layernorm(x, axis=-1)
    return x + _A_ref(xn, A_wqkv, A_wo) + _B_ref(xn, B_w1, B_b1, B_w2, B_b2)
```

```asm
; @launch grid=(256,1,1) block=(512,1,1) lds=163840
.amdgcn_target "amdgcn-amd-amdhsa--gfx950"
.text
.globl parallel_sum__linear_attn_block__dense_activation_gelu__prompt_kernel
.p2align 8
.type parallel_sum__linear_attn_block__dense_activation_gelu__prompt_kernel,@function
parallel_sum__linear_attn_block__dense_activation_gelu__prompt_kernel:
L_codebeg:
    s_cmp_ge_u32 s2, 256
    s_cbranch_scc1 L_end
    s_load_dwordx2 s[8:9], s[0:1], 0
    s_load_dwordx2 s[12:13], s[0:1], 8
    s_load_dwordx2 s[92:93], s[0:1], 32
    v_readfirstlane_b32 s3, v0
    s_getpc_b64 s[82:83]
    s_lshr_b32 s95, s2, 3
    s_lshl_b32 s96, s95, 11
    v_lshl_add_u32 v48, v0, 2, s96
    v_min_u32 v48, L_codeend-L_codebeg-64, v48
    global_load_dword v44, v48, s[82:83]
    s_lshr_b32 s3, s3, 6
    v_and_b32 v48, 63, v0
    s_add_u32 s7, s95, 16
    v_lshrrev_b32 v49, 3, v48
    s_bfe_u32 s7, s7, 0x30002
    s_and_b32 s80, s95, 3
    v_lshrrev_b32 v51, 4, v48
    s_and_b32 s81, s2, 1
    v_lshl_add_u32 v53, s3, 4, v49
    s_bfe_u32 s96, s2, 0x20001
    v_mul_u32_u24 v53, 896, v53
    s_lshl2_add_u32 s6, s96, s80
    v_xor_b32 v54, v48, v51
    s_add_u32 s95, s80, s7
    v_and_b32 v54, 7, v54
    s_and_b32 s95, s95, 1
    v_lshl_add_u32 v3, v54, 4, v53
    s_lshl2_add_u32 s95, s81, s95
    v_xor_b32 v4, 64, v3
    s_lshl1_add_u32 s95, s96, s95
    v_add_u32 v4, 6144, v4
    s_cmp_ge_u32 s95, 7
    s_cselect_b32 s83, 7, 0
    s_sub_u32 s95, s95, s83
    s_mul_i32 s90, s6, 114688
    s_lshl_b32 s66, s95, 7
    s_add_u32 s66, s66, s90
    s_lshl_b32 s87, s3, 11
    s_bitcmp1_b32 0x70, s7
    s_cselect_b32 s88, 4, 7
    s_lshl_b32 s88, s88, 14
    s_add_u32 m0, s88, s87
    s_mov_b32 s10, 0x1c0000
    s_mov_b32 s11, 0x20000
    s_waitcnt lgkmcnt(0)
    buffer_load_dwordx4 v3, s[8:11], s66 offen lds
    buffer_load_dwordx4 v4, s[8:11], s66 offen offset:1024 lds
    s_and_b32 s4, s3, 3
    s_lshr_b32 s5, s3, 2
    s_lshl_b32 s86, s4, 11
    s_mul_i32 s82, s81, 3
    v_lshlrev_b32 v52, 2, v51
    s_add_u32 s82, s82, s7
    v_xor_b32 v52, v48, v52
    s_lshl_b32 s82, s82, 7
    s_add_u32 s82, s82, 384
    s_lshl2_add_u32 s96, s81, s7
    s_and_b32 s98, s7, 1
    s_lshl_b32 s98, s98, 6
    s_movk_i32 s97, 2688
    s_cmp_lt_u32 s7, 4
    s_cselect_b32 s97, 3584, s97
    s_cselect_b32 s96, s96, s81
    s_cselect_b32 s98, s98, 0
    s_mul_i32 s83, s96, 448
    s_add_u32 s83, s83, s98
    s_lshl_b32 s89, s97, 6
    s_mul_i32 s73, s95, s89
    s_mul_i32 s14, s97, 448
    s_mov_b32 s15, 0x20000
    s_lshl_b32 s95, s4, 1
    s_add_u32 s91, s87, 81920
    s_bitcmp1_b32 0x70, s7
    s_cselect_b32 s82, s82, s83
    s_cselect_b32 s95, s3, s95
    s_cselect_b32 s91, s91, s86
    s_cselect_b32 s83, 4, 3
    s_cselect_b32 s94, 1, s5
    v_lshrrev_b32 v53, s83, v48
    v_lshl_add_u32 v53, s95, 3, v53
    v_bfe_u32 v54, v52, 0, s83
    s_lshr_b32 s83, s89, s83
    v_mul_u32_u24 v53, s97, v53
    s_sub_u32 s83, s83, 1024
    v_lshl_add_u32 v54, v54, 4, s82
    v_add_u32 v5, v53, v54
    s_cmp_lt_u32 s7, 4
    v_add_u32 v42, s83, v5
    s_cselect_b64 s[12:13], s[92:93], s[12:13]
    s_mov_b32 m0, s91
    s_cmp_eq_u32 s94, 0
    s_cbranch_scc1 L_now
    buffer_load_dwordx4 v5, s[12:15], s73 offen lds
    buffer_load_dwordx4 v42, s[12:15], s73 offen offset:1024 lds
L_now:
    s_load_dwordx2 s[16:17], s[0:1], 80
    s_load_dwordx2 s[32:33], s[0:1], 40
    s_load_dwordx2 s[40:41], s[0:1], 72
    s_load_dwordx2 s[20:21], s[0:1], 48
    s_load_dwordx2 s[24:25], s[0:1], 16
    s_load_dwordx2 s[36:37], s[0:1], 56
    s_load_dwordx2 s[28:29], s[0:1], 64
    s_add_u32 s95, s90, 896
    v_lshlrev_b32 v1, 4, v48
    s_add_u32 s67, s66, 128
    v_and_b32 v55, 1, v51
    s_add_u32 s74, s73, s89
    v_and_b32 v56, 31, v48
    s_cmp_eq_u32 s67, s95
    v_lshrrev_b32 v57, 5, v48
    s_cselect_b32 s67, s90, s67
    v_bfe_u32 v58, v48, 2, 2
    s_cselect_b32 s74, 0, s74
    v_and_b32 v59, 3, v48
    s_add_u32 s68, s67, 128
    v_lshl_add_u32 v60, s4, 1, v57
    s_add_u32 s75, s74, s89
    v_bfe_u32 v53, v48, 1, 3
    s_cmp_eq_u32 s68, s95
    v_xor_b32 v53, v60, v53
    s_cselect_b32 s68, s90, s68
    v_lshl_add_u32 v61, s4, 5, v56
    s_cselect_b32 s75, 0, s75
    v_lshlrev_b32 v28, 7, v61
    s_add_u32 s69, s68, 128
    v_lshl_add_u32 v28, v53, 4, v28
    s_add_u32 s76, s75, s89
    v_xor_b32 v29, 32, v28
    s_cmp_eq_u32 s69, s95
    v_xor_b32 v30, 64, v28
    s_cselect_b32 s69, s90, s69
    v_xor_b32 v31, 96, v28
    s_cselect_b32 s76, 0, s76
    v_lshl_add_u32 v60, v60, 3, v58
    s_add_u32 s70, s69, 128
    v_lshl_add_u32 v62, v55, 2, v59
    s_add_u32 s77, s76, s89
    v_and_b32 v53, 7, v52
    s_cmp_eq_u32 s70, s95
    v_mov_b32 v54, 0x3f803f80
    s_cselect_b32 s70, s90, s70
    v_cmp_eq_u32 vcc, 0, v53
    s_cselect_b32 s77, 0, s77
    v_mov_b32 v38, 0
    s_add_u32 s71, s70, 128
    v_mov_b32 v39, 0
    s_add_u32 s78, s77, s89
    v_mov_b32 v40, 0
    s_cmp_eq_u32 s71, s95
    v_mov_b32 v41, 0
    s_cselect_b32 s71, s90, s71
    v_cndmask_b32 v8, 0, v54, vcc
    s_cselect_b32 s78, 0, s78
    v_cndmask_b32 v9, 0, v54, vcc
    s_add_u32 s72, s71, 128
    v_cndmask_b32 v10, 0, v54, vcc
    s_add_u32 s79, s78, s89
    v_cndmask_b32 v11, 0, v54, vcc
    s_cmp_eq_u32 s72, s95
    v_mov_b32 v46, 0x40000000
    s_cselect_b32 s72, s90, s72
    v_cmp_eq_u32 vcc, 0, v48
    s_cselect_b32 s79, 0, s79
    v_mov_b32 v47, 1
    s_mov_b32 s84, 0x3f803f80
    v_mov_b32 v33, 0
    v_cndmask_b32 v46, v46, 0, vcc
    s_cmp_ge_u32 s7, 7
    s_cbranch_scc1 L_q
    s_cmp_ge_u32 s7, 4
    s_cbranch_scc1 L_kv
    s_mul_i32 s83, s5, 64
    v_lshrrev_b32 v54, 1, v58
    v_lshl_add_u32 v53, v62, 3, s83
    v_lshlrev_b32 v54, 6, v54
    v_xor_b32 v53, v53, v54
    v_lshl_add_u32 v20, v60, 7, v53
    v_xor_b32 v21, 2048, v20
    v_xor_b32 v22, 4096, v20
    v_xor_b32 v23, 6144, v20
    s_mov_b32 s18, 0x10000000
    s_mov_b32 s19, 0x20000
    s_mov_b32 s42, 0x100
    s_mov_b32 s43, 0x20000
    s_waitcnt lgkmcnt(0)
    s_cmp_eq_u32 s5, 1
    s_cbranch_scc1 L_fb
    s_add_u32 m0, s87, 131072
    s_nop 0
    buffer_load_dwordx4 v3, s[8:11], s67 offen lds
    buffer_load_dwordx4 v4, s[8:11], s67 offen offset:1024 lds
    s_mov_b32 s22, 0x188000
    s_mov_b32 s23, 0x20000
    s_mov_b32 s26, 0x62000
    s_mov_b32 s27, 0x20000
    s_mov_b32 s30, 0x1c0000
    s_mov_b32 s31, 0x20000
    s_mov_b32 s38, 0x380
    s_mov_b32 s39, 0x20000
    s_mov_b32 s85, 0x358637bd
    s_mov_b32 s99, 0x3fb8aa3b
    s_mov_b32 s92, 0
    s_mov_b32 s93, -1
    s_mov_b32 s94, 0
    v_and_b32 v52, 7, v52
    v_mul_u32_u24 v2, 896, v49
    v_lshl_add_u32 v2, v52, 4, v2
    s_lshl_b32 s83, s5, 9
    s_add_u32 s83, s83, 159744
    v_lshl_add_u32 v7, v56, 4, s83
    v_lshl_add_u32 v6, s4, 2, v7
    s_lshl2_add_u32 s83, s3, 157696
    v_mov_b32 v45, s83
    ds_write_b32 v45, v33 offset:0
    v_lshlrev_b32 v37, 2, v61
    v_add_u32 v36, 155648, v37
    s_and_b32 s83, s2, 7
    s_lshl2_add_u32 s80, s83, s80
    s_lshl1_add_u32 s83, s80, s7
    s_and_b32 s89, s83, 3
    s_and_b32 s83, s83, 4
    s_lshl2_add_u32 s89, s83, s89
    s_lshl_b32 s83, s7, 7
    s_mul_i32 s58, s4, 401408
    s_add_u32 s58, s58, s83
    s_lshr_b32 s62, s4, 1
    s_mul_i32 s62, s62, 6
    s_add_u32 s62, s62, s4
    s_mul_i32 s62, s62, 25088
    s_add_u32 s62, s62, s83
    s_mul_i32 s63, s80, 57344
    s_add_u32 s63, s63, s83
    s_mul_i32 s59, s4, 12288
    s_mul_i32 s60, s4, 10240
    s_add_u32 s60, s60, 114688
    s_mul_i32 s100, s4, 6144
    s_add_u32 s100, s100, 86016
    s_mul_i32 s61, s80, 294912
    s_lshl2_add_u32 s90, s6, s4
    s_mul_i32 s90, s90, 147456
    s_add_u32 s90, s90, 0
    s_mul_i32 s83, s82, 32
    s_add_u32 s90, s90, s83
    s_add_u32 s83, s86, 49152
    v_add_u32 v43, s83, v1
    s_mul_i32 s97, s98, -7
    s_add_u32 s97, s97, s82
    s_add_u32 s97, s97, 384
    v_lshrrev_b32 v53, 2, v48
    v_lshl_add_u32 v53, s4, 4, v53
    v_mul_u32_u24 v53, 3584, v53
    v_lshl_add_u32 v125, v59, 4, s97
    v_add_u32 v125, v125, v53
    v_lshl_add_u32 v53, v60, 3, v62
    v_lshlrev_b32 v53, 3, v53
    v_add_u32 v126, 57344, v53
    s_mov_b32 s34, 0xe00
    s_mov_b32 s35, 0x20000
    v_lshlrev_b32 v53, 1, v56
    buffer_load_ushort v16, v53, s[32:35], s82 offen offset:0
    buffer_load_ushort v17, v53, s[32:35], s82 offen offset:128
    buffer_load_ushort v18, v53, s[32:35], s82 offen offset:256
    buffer_load_ushort v19, v53, s[32:35], s97 offen
    s_lshr_b32 s83, s96, 1
    s_lshl2_add_u32 s83, s6, s83
    s_mul_i32 s91, s83, 896
    s_lshl1_add_u32 s91, s98, s91
    s_lshl_b32 s83, s4, 28
    s_add_u32 s91, s91, s83
    s_add_u32 s91, s91, 0x911000
    s_barrier
    s_add_u32 m0, s87, 65536
    s_nop 0
    buffer_load_dwordx4 v3, s[8:11], s68 offen lds
    buffer_load_dwordx4 v4, s[8:11], s68 offen offset:1024 lds
    s_waitcnt vmcnt(8) lgkmcnt(0)
    s_barrier
    ds_read_b64_tr_b16 v[240:241], v20 offset:0
    ds_read_b64_tr_b16 v[242:243], v20 offset:512
    v_add_u32 v28, 0x1c000, v28
    v_add_u32 v29, 0x1c000, v29
    v_add_u32 v30, 0x1c000, v30
    v_add_u32 v31, 0x1c000, v31
    ds_read_b128 v[128:131], v28 offset:0
    ds_read_b64_tr_b16 v[244:245], v21 offset:0
    ds_read_b64_tr_b16 v[246:247], v21 offset:512
    ds_read_b128 v[132:135], v29 offset:0
    ds_read_b64_tr_b16 v[248:249], v22 offset:0
    ds_read_b64_tr_b16 v[250:251], v22 offset:512
    ds_read_b128 v[136:139], v30 offset:0
    ds_read_b64_tr_b16 v[252:253], v23 offset:0
    ds_read_b64_tr_b16 v[254:255], v23 offset:512
    s_add_u32 m0, s87, 81920
    ds_read_b128 v[140:143], v31 offset:0
    buffer_load_dwordx4 v3, s[8:11], s69 offen lds
    buffer_load_dwordx4 v4, s[8:11], s69 offen offset:1024 lds
    s_waitcnt vmcnt(8) lgkmcnt(0)
    s_barrier
    v_mfma_f32_32x32x16_bf16 v[64:79], v[240:243], v[128:131], 0
    v_mfma_f32_16x16x32_bf16 v[12:15], v[8:11], v[240:243], 0
    ds_read_b64_tr_b16 v[240:241], v20 offset:8192
    ds_read_b64_tr_b16 v[242:243], v20 offset:8704
    ds_read_b128 v[144:147], v28 offset:16384
    v_mfma_f32_32x32x16_bf16 v[64:79], v[244:247], v[132:135], v[64:79]
    ds_read_b64_tr_b16 v[244:245], v21 offset:8192
    ds_read_b64_tr_b16 v[246:247], v21 offset:8704
    ds_read_b128 v[148:151], v29 offset:16384
    v_mfma_f32_32x32x16_bf16 v[64:79], v[248:251], v[136:139], v[64:79]
    ds_read_b64_tr_b16 v[248:249], v22 offset:8192
    ds_read_b64_tr_b16 v[250:251], v22 offset:8704
    ds_read_b128 v[152:155], v30 offset:16384
    v_mfma_f32_32x32x16_bf16 v[64:79], v[252:255], v[140:143], v[64:79]
    ds_read_b64_tr_b16 v[252:253], v23 offset:8192
    ds_read_b64_tr_b16 v[254:255], v23 offset:8704
    s_add_u32 m0, s87, 98304
    ds_read_b128 v[156:159], v31 offset:16384
    buffer_load_dwordx4 v3, s[8:11], s70 offen lds
    buffer_load_dwordx4 v4, s[8:11], s70 offen offset:1024 lds
    s_waitcnt vmcnt(4) lgkmcnt(0)
    s_barrier
    v_mfma_f32_32x32x16_bf16 v[64:79], v[240:243], v[144:147], v[64:79]
    v_mfma_f32_16x16x32_bf16 v[12:15], v[8:11], v[240:243], v[12:15]
    ds_read_b64_tr_b16 v[240:241], v20 offset:16384
    ds_read_b64_tr_b16 v[242:243], v20 offset:16896
    v_add_u32 v28, 0xffff4000, v28
    v_add_u32 v29, 0xffff4000, v29
    v_add_u32 v30, 0xffff4000, v30
    v_add_u32 v31, 0xffff4000, v31
    ds_read_b128 v[160:163], v28 offset:0
    v_mfma_f32_32x32x16_bf16 v[64:79], v[244:247], v[148:151], v[64:79]
    ds_read_b64_tr_b16 v[244:245], v21 offset:16384
    ds_read_b64_tr_b16 v[246:247], v21 offset:16896
    ds_read_b128 v[164:167], v29 offset:0
    v_mfma_f32_32x32x16_bf16 v[64:79], v[248:251], v[152:155], v[64:79]
    ds_read_b64_tr_b16 v[248:249], v22 offset:16384
    ds_read_b64_tr_b16 v[250:251], v22 offset:16896
    ds_read_b128 v[168:171], v30 offset:0
    v_mfma_f32_32x32x16_bf16 v[64:79], v[252:255], v[156:159], v[64:79]
    ds_read_b64_tr_b16 v[252:253], v23 offset:16384
    ds_read_b64_tr_b16 v[254:255], v23 offset:16896
    s_add_u32 m0, s87, 114688
    ds_read_b128 v[172:175], v31 offset:0
    buffer_load_dwordx4 v3, s[8:11], s71 offen lds
    buffer_load_dwordx4 v4, s[8:11], s71 offen offset:1024 lds
    s_waitcnt vmcnt(4) lgkmcnt(0)
    s_barrier
    v_mfma_f32_32x32x16_bf16 v[64:79], v[240:243], v[160:163], v[64:79]
    v_mfma_f32_16x16x32_bf16 v[12:15], v[8:11], v[240:243], v[12:15]
    ds_read_b64_tr_b16 v[240:241], v20 offset:24576
    ds_read_b64_tr_b16 v[242:243], v20 offset:25088
    ds_read_b128 v[176:179], v28 offset:16384
    v_mfma_f32_32x32x16_bf16 v[64:79], v[244:247], v[164:167], v[64:79]
    ds_read_b64_tr_b16 v[244:245], v21 offset:24576
    ds_read_b64_tr_b16 v[246:247], v21 offset:25088
    ds_read_b128 v[180:183], v29 offset:16384
    v_mfma_f32_32x32x16_bf16 v[64:79], v[248:251], v[168:171], v[64:79]
    ds_read_b64_tr_b16 v[248:249], v22 offset:24576
    ds_read_b64_tr_b16 v[250:251], v22 offset:25088
    ds_read_b128 v[184:187], v30 offset:16384
    v_mfma_f32_32x32x16_bf16 v[64:79], v[252:255], v[172:175], v[64:79]
    ds_read_b64_tr_b16 v[252:253], v23 offset:24576
    ds_read_b64_tr_b16 v[254:255], v23 offset:25088
    s_add_u32 m0, s87, 131072
    ds_read_b128 v[188:191], v31 offset:16384
    buffer_load_dwordx4 v3, s[8:11], s72 offen lds
    buffer_load_dwordx4 v4, s[8:11], s72 offen offset:1024 lds
    s_waitcnt vmcnt(4) lgkmcnt(0)
    s_barrier
    v_mfma_f32_32x32x16_bf16 v[64:79], v[240:243], v[176:179], v[64:79]
    v_mfma_f32_16x16x32_bf16 v[12:15], v[8:11], v[240:243], v[12:15]
    ds_read_b64_tr_b16 v[240:241], v20 offset:32768
    ds_read_b64_tr_b16 v[242:243], v20 offset:33280
    ds_read_b128 v[192:195], v28 offset:32768
    v_mfma_f32_32x32x16_bf16 v[64:79], v[244:247], v[180:183], v[64:79]
    ds_read_b64_tr_b16 v[244:245], v21 offset:32768
    ds_read_b64_tr_b16 v[246:247], v21 offset:33280
    ds_read_b128 v[196:199], v29 offset:32768
    v_mfma_f32_32x32x16_bf16 v[64:79], v[248:251], v[184:187], v[64:79]
    ds_read_b64_tr_b16 v[248:249], v22 offset:32768
    ds_read_b64_tr_b16 v[250:251], v22 offset:33280
    ds_read_b128 v[200:203], v30 offset:32768
    v_mfma_f32_32x32x16_bf16 v[64:79], v[252:255], v[188:191], v[64:79]
    ds_read_b64_tr_b16 v[252:253], v23 offset:32768
    ds_read_b64_tr_b16 v[254:255], v23 offset:33280
    ds_read_b128 v[204:207], v31 offset:32768
    v_add_u32 v5, 128, v5
    v_add_u32 v42, 128, v42
    s_and_b32 s95, s7, 3
    s_lshl2_add_u32 s95, s6, s95
    s_lshl3_add_u32 s95, s95, s3
    s_mul_i32 s95, s95, 3584
    s_mul_i32 s88, s81, 1792
    s_add_u32 s95, s95, s88
    v_min_u32 v50, 13, v48
    v_lshlrev_b32 v50, 7, v50
    buffer_load_dword v127, v50, s[12:15], s95 offen
    s_waitcnt vmcnt(3) lgkmcnt(0)
    s_barrier
    v_mfma_f32_32x32x16_bf16 v[64:79], v[240:243], v[192:195], v[64:79]
    v_mfma_f32_16x16x32_bf16 v[12:15], v[8:11], v[240:243], v[12:15]
    ds_read_b64_tr_b16 v[240:241], v20 offset:40960
    ds_read_b64_tr_b16 v[242:243], v20 offset:41472
    ds_read_b128 v[208:211], v28 offset:49152
    v_mfma_f32_32x32x16_bf16 v[64:79], v[244:247], v[196:199], v[64:79]
    ds_read_b64_tr_b16 v[244:245], v21 offset:40960
    ds_read_b64_tr_b16 v[246:247], v21 offset:41472
    ds_read_b128 v[212:215], v29 offset:49152
    v_mfma_f32_32x32x16_bf16 v[64:79], v[248:251], v[200:203], v[64:79]
    ds_read_b64_tr_b16 v[248:249], v22 offset:40960
    ds_read_b64_tr_b16 v[250:251], v22 offset:41472
    ds_read_b128 v[216:219], v30 offset:49152
    v_mfma_f32_32x32x16_bf16 v[64:79], v[252:255], v[204:207], v[64:79]
    ds_read_b64_tr_b16 v[252:253], v23 offset:40960
    ds_read_b64_tr_b16 v[254:255], v23 offset:41472
    ds_read_b128 v[220:223], v31 offset:49152
    v_add_u32 v3, 6144, v2
    s_waitcnt vmcnt(1) lgkmcnt(0)
    s_barrier
    v_mfma_f32_32x32x16_bf16 v[64:79], v[240:243], v[208:211], v[64:79]
    v_mfma_f32_16x16x32_bf16 v[12:15], v[8:11], v[240:243], v[12:15]
    ds_read_b64_tr_b16 v[240:241], v20 offset:49152
    ds_read_b64_tr_b16 v[242:243], v20 offset:49664
    v_add_u32 v28, 0x10000, v28
    v_add_u32 v29, 0x10000, v29
    v_add_u32 v30, 0x10000, v30
    v_add_u32 v31, 0x10000, v31
    ds_read_b128 v[224:227], v28 offset:0
    v_mfma_f32_32x32x16_bf16 v[64:79], v[244:247], v[212:215], v[64:79]
    ds_read_b64_tr_b16 v[244:245], v21 offset:49152
    ds_read_b64_tr_b16 v[246:247], v21 offset:49664
    ds_read_b128 v[228:231], v29 offset:0
    v_mfma_f32_32x32x16_bf16 v[64:79], v[248:251], v[216:219], v[64:79]
    ds_read_b64_tr_b16 v[248:249], v22 offset:49152
    ds_read_b64_tr_b16 v[250:251], v22 offset:49664
    ds_read_b128 v[232:235], v30 offset:0
    v_mfma_f32_32x32x16_bf16 v[64:79], v[252:255], v[220:223], v[64:79]
    ds_read_b64_tr_b16 v[252:253], v23 offset:49152
    ds_read_b64_tr_b16 v[254:255], v23 offset:49664
    ds_read_b128 v[236:239], v31 offset:0
    s_barrier
    s_waitcnt lgkmcnt(7)
    v_mfma_f32_32x32x16_bf16 v[64:79], v[240:243], v[224:227], v[64:79]
    v_mfma_f32_16x16x32_bf16 v[12:15], v[8:11], v[240:243], v[12:15]
    s_waitcnt lgkmcnt(6)
    v_mfma_f32_32x32x16_bf16 v[64:79], v[244:247], v[228:231], v[64:79]
    s_waitcnt lgkmcnt(1)
    v_mfma_f32_32x32x16_bf16 v[64:79], v[248:251], v[232:235], v[64:79]
    s_waitcnt lgkmcnt(0)
    s_add_u32 m0, s86, 81920
    v_mfma_f32_32x32x16_bf16 v[64:79], v[252:255], v[236:239], v[64:79]
    buffer_load_dwordx4 v5, s[12:15], s76 offen lds
    ds_write_b32 v6, v12
    buffer_load_dwordx4 v42, s[12:15], s76 offen offset:1024 lds
    s_waitcnt lgkmcnt(0)
    s_barrier
    s_setprio 2
    ds_read_b32 v48, v36
    ds_read_b128 v[56:59], v7 offset:0
    v_mov_b32 v33, v16
    s_waitcnt lgkmcnt(1)
    v_and_b32 v40, 0xffff0000, v48
    v_rcp_f32 v41, v40
    v_cndmask_b32 v48, v48, 0, s[92:93]
    v_and_b32 v49, 0xffff, v48
    v_lshl_or_b32 v36, v48, 16, v49
    v_lshrrev_b32 v37, 16, v48
    v_mul_f32 v38, 0xc0135761, v41
    v_mul_f32 v48, v41, v41
    v_mul_f32 v39, 0xbdd2d3e8, v41
    v_mul_f32 v39, v48, v39
    s_waitcnt lgkmcnt(0)
    v_add_f32 v56, v56, v57
    v_add_f32 v58, v58, v59
    v_add_f32 v56, v56, v58
    v_cvt_pk_bf16_f32 v57, v56, v56
    v_lshlrev_b32 v57, 16, v57
    v_sub_f32 v57, v56, v57
    v_cvt_pk_bf16_f32 v32, v56, v57
    s_nop 1
    v_mfma_f32_32x32x8_bf16 v[64:79], v[32:33], v[36:37], v[64:79]
    s_setprio 0
    s_nop 10
    v_mul_f32 v48, v64, v64
    v_mul_f32 v49, v65, v65
    v_mul_f32 v50, v66, v66
    v_mul_f32 v51, v67, v67
    v_fma_f32 v48, v48, v39, v38
    v_fma_f32 v49, v49, v39, v38
    v_fma_f32 v50, v50, v39, v38
    v_fma_f32 v51, v51, v39, v38
    v_mul_f32 v48, v64, v48
    v_mul_f32 v49, v65, v49
    v_mul_f32 v50, v66, v50
    v_mul_f32 v51, v67, v51
    v_exp_f32 v48, v48
    v_exp_f32 v49, v49
    v_exp_f32 v50, v50
    v_exp_f32 v51, v51
    v_fma_f32 v48, v48, v40, v40
    v_fma_f32 v49, v49, v40, v40
    v_fma_f32 v50, v50, v40, v40
    v_fma_f32 v51, v51, v40, v40
    v_rcp_f32 v48, v48
    v_rcp_f32 v49, v49
    v_rcp_f32 v50, v50
    v_rcp_f32 v51, v51
    v_mul_f32 v64, v64, v48
    v_mul_f32 v65, v65, v49
    v_mul_f32 v66, v66, v50
    v_mul_f32 v67, v67, v51
    v_cvt_pk_bf16_f32 v64, v64, v65
    v_cvt_pk_bf16_f32 v65, v66, v67
    v_mul_f32 v48, v68, v68
    v_mul_f32 v49, v69, v69
    v_mul_f32 v50, v70, v70
    v_mul_f32 v51, v71, v71
    v_fma_f32 v48, v48, v39, v38
    v_fma_f32 v49, v49, v39, v38
    v_fma_f32 v50, v50, v39, v38
    v_fma_f32 v51, v51, v39, v38
    v_mul_f32 v48, v68, v48
    v_mul_f32 v49, v69, v49
    v_mul_f32 v50, v70, v50
    v_mul_f32 v51, v71, v51
    v_exp_f32 v48, v48
    v_exp_f32 v49, v49
    v_exp_f32 v50, v50
    v_exp_f32 v51, v51
    v_fma_f32 v48, v48, v40, v40
    v_fma_f32 v49, v49, v40, v40
    v_fma_f32 v50, v50, v40, v40
    v_fma_f32 v51, v51, v40, v40
    v_rcp_f32 v48, v48
    v_rcp_f32 v49, v49
    v_rcp_f32 v50, v50
    v_rcp_f32 v51, v51
    v_mul_f32 v68, v68, v48
    v_mul_f32 v69, v69, v49
    ds_read_b64_tr_b16 v[240:241], v20 offset:57344
    v_mul_f32 v70, v70, v50
    v_mul_f32 v71, v71, v51
    v_cvt_pk_bf16_f32 v66, v68, v69
    v_cvt_pk_bf16_f32 v67, v70, v71
    buffer_store_dwordx4 v[64:67], v1, s[16:19], s90 offen offset:0 sc1
    ds_read_b64_tr_b16 v[242:243], v20 offset:57856
    v_mul_f32 v48, v72, v72
    v_mul_f32 v49, v73, v73
    v_mul_f32 v50, v74, v74
    v_mul_f32 v51, v75, v75
    v_fma_f32 v48, v48, v39, v38
    v_fma_f32 v49, v49, v39, v38
    ds_read_b64_tr_b16 v[244:245], v21 offset:57344
    v_fma_f32 v50, v50, v39, v38
    v_fma_f32 v51, v51, v39, v38
    v_mul_f32 v48, v72, v48
    v_mul_f32 v49, v73, v49
    v_mul_f32 v50, v74, v50
    ds_read_b64_tr_b16 v[246:247], v21 offset:57856
    v_mul_f32 v51, v75, v51
    v_exp_f32 v48, v48
    buffer_load_dword v44, v46, s[40:43], 0 offen sc1
    v_exp_f32 v49, v49
    v_exp_f32 v50, v50
    ds_read_b64_tr_b16 v[248:249], v22 offset:57344
    v_exp_f32 v51, v51
    v_fma_f32 v48, v48, v40, v40
    v_fma_f32 v49, v49, v40, v40
    v_fma_f32 v50, v50, v40, v40
    v_fma_f32 v51, v51, v40, v40
    v_rcp_f32 v48, v48
    ds_read_b64_tr_b16 v[250:251], v22 offset:57856
    v_rcp_f32 v49, v49
    v_rcp_f32 v50, v50
    v_rcp_f32 v51, v51
    v_mul_f32 v72, v72, v48
    v_mul_f32 v73, v73, v49
    ds_read_b64_tr_b16 v[252:253], v23 offset:57344
    v_mul_f32 v74, v74, v50
    v_mul_f32 v75, v75, v51
    v_cvt_pk_bf16_f32 v72, v72, v73
    v_cvt_pk_bf16_f32 v73, v74, v75
    v_mul_f32 v48, v76, v76
    v_mul_f32 v49, v77, v77
    ds_read_b64_tr_b16 v[254:255], v23 offset:57856
    v_mul_f32 v50, v78, v78
    v_mul_f32 v51, v79, v79
    v_fma_f32 v48, v48, v39, v38
    v_fma_f32 v49, v49, v39, v38
    v_fma_f32 v50, v50, v39, v38
    v_fma_f32 v51, v51, v39, v38
    v_mul_f32 v48, v76, v48
    v_mul_f32 v49, v77, v49
    v_mul_f32 v50, v78, v50
    v_mul_f32 v51, v79, v51
    v_exp_f32 v48, v48
    v_exp_f32 v49, v49
    v_exp_f32 v50, v50
    v_exp_f32 v51, v51
    v_fma_f32 v48, v48, v40, v40
    v_fma_f32 v49, v49, v40, v40
    v_fma_f32 v50, v50, v40, v40
    v_fma_f32 v51, v51, v40, v40
    v_rcp_f32 v48, v48
    v_rcp_f32 v49, v49
    v_rcp_f32 v50, v50
    v_rcp_f32 v51, v51
    v_mul_f32 v76, v76, v48
    v_mul_f32 v77, v77, v49
    v_mul_f32 v78, v78, v50
    v_mul_f32 v79, v79, v51
    v_cvt_pk_bf16_f32 v74, v76, v77
    v_cvt_pk_bf16_f32 v75, v78, v79
    buffer_store_dwordx4 v[72:75], v1, s[16:19], s90 offen offset:1024 sc1
    s_add_u32 s90, s90, 4096
    s_waitcnt vmcnt(3) lgkmcnt(0)
    s_barrier
    s_setprio 1
    v_mfma_f32_32x32x16_bf16 v[64:79], v[240:243], v[128:131], 0
    v_mfma_f32_16x16x32_bf16 v[12:15], v[8:11], v[240:243], 0
    v_add_u32 v20, 0x10000, v20
    v_add_u32 v21, 0x10000, v21
    v_add_u32 v22, 0x10000, v22
    v_add_u32 v23, 0x10000, v23
    ds_read_b64_tr_b16 v[240:241], v20 offset:0
    ds_read_b64_tr_b16 v[242:243], v20 offset:512
    v_mfma_f32_32x32x16_bf16 v[64:79], v[244:247], v[132:135], v[64:79]
    ds_read_b64_tr_b16 v[244:245], v21 offset:0
    ds_read_b64_tr_b16 v[246:247], v21 offset:512
    v_add_u32 v5, 128, v5
    s_add_u32 m0, s86, 8192
    v_add_u32 v42, 128, v42
    buffer_load_dwordx4 v5, s[12:15], s74 offen lds
    v_mfma_f32_32x32x16_bf16 v[64:79], v[248:251], v[136:139], v[64:79]
    ds_read_b64_tr_b16 v[248:249], v22 offset:0
    ds_read_b64_tr_b16 v[250:251], v22 offset:512
    v_mfma_f32_32x32x16_bf16 v[64:79], v[252:255], v[140:143], v[64:79]
    ds_read_b64_tr_b16 v[252:253], v23 offset:0
    ds_read_b64_tr_b16 v[254:255], v23 offset:512
    s_waitcnt lgkmcnt(4)
    v_mfma_f32_32x32x16_bf16 v[64:79], v[240:243], v[144:147], v[64:79]
    v_mfma_f32_16x16x32_bf16 v[12:15], v[8:11], v[240:243], v[12:15]
    ds_read_b64_tr_b16 v[240:241], v20 offset:8192
    ds_read_b64_tr_b16 v[242:243], v20 offset:8704
    buffer_load_dwordx4 v42, s[12:15], s74 offen offset:1024 lds
    v_mfma_f32_32x32x16_bf16 v[64:79], v[244:247], v[148:151], v[64:79]
    ds_read_b64_tr_b16 v[244:245], v21 offset:8192
    ds_read_b64_tr_b16 v[246:247], v21 offset:8704
    s_waitcnt lgkmcnt(4)
    v_mfma_f32_32x32x16_bf16 v[64:79], v[248:251], v[152:155], v[64:79]
    ds_read_b64_tr_b16 v[248:249], v22 offset:8192
    ds_read_b64_tr_b16 v[250:251], v22 offset:8704
    v_mfma_f32_32x32x16_bf16 v[64:79], v[252:255], v[156:159], v[64:79]
    ds_read_b64_tr_b16 v[252:253], v23 offset:8192
    s_add_u32 m0, s86, 16384
    ds_read_b64_tr_b16 v[254:255], v23 offset:8704
    buffer_load_dwordx4 v5, s[12:15], s75 offen lds
    s_waitcnt lgkmcnt(4)
    v_mfma_f32_32x32x16_bf16 v[64:79], v[240:243], v[160:163], v[64:79]
    v_mfma_f32_16x16x32_bf16 v[12:15], v[8:11], v[240:243], v[12:15]
    ds_read_b64_tr_b16 v[240:241], v20 offset:16384
    ds_read_b64_tr_b16 v[242:243], v20 offset:16896
    v_mfma_f32_32x32x16_bf16 v[64:79], v[244:247], v[164:167], v[64:79]
    ds_read_b64_tr_b16 v[244:245], v21 offset:16384
    ds_read_b64_tr_b16 v[246:247], v21 offset:16896
    s_waitcnt lgkmcnt(4)
    v_mfma_f32_32x32x16_bf16 v[64:79], v[248:251], v[168:171], v[64:79]
    ds_read_b64_tr_b16 v[248:249], v22 offset:16384
    ds_read_b64_tr_b16 v[250:251], v22 offset:16896
    buffer_load_dwordx4 v42, s[12:15], s75 offen offset:1024 lds
    v_mfma_f32_32x32x16_bf16 v[64:79], v[252:255], v[172:175], v[64:79]
    ds_read_b64_tr_b16 v[252:253], v23 offset:16384
    ds_read_b64_tr_b16 v[254:255], v23 offset:16896
    s_waitcnt lgkmcnt(4)
    v_mfma_f32_32x32x16_bf16 v[64:79], v[240:243], v[176:179], v[64:79]
    v_mfma_f32_16x16x32_bf16 v[12:15], v[8:11], v[240:243], v[12:15]
    ds_read_b64_tr_b16 v[240:241], v20 offset:24576
    ds_read_b64_tr_b16 v[242:243], v20 offset:25088
    v_mfma_f32_32x32x16_bf16 v[64:79], v[244:247], v[180:183], v[64:79]
    ds_read_b64_tr_b16 v[244:245], v21 offset:24576
    s_add_u32 m0, s86, 24576
    ds_read_b64_tr_b16 v[246:247], v21 offset:25088
    buffer_load_dwordx4 v5, s[12:15], s76 offen lds
    s_waitcnt lgkmcnt(4)
    v_mfma_f32_32x32x16_bf16 v[64:79], v[248:251], v[184:187], v[64:79]
    ds_read_b64_tr_b16 v[248:249], v22 offset:24576
    ds_read_b64_tr_b16 v[250:251], v22 offset:25088
    v_mfma_f32_32x32x16_bf16 v[64:79], v[252:255], v[188:191], v[64:79]
    ds_read_b64_tr_b16 v[252:253], v23 offset:24576
    ds_read_b64_tr_b16 v[254:255], v23 offset:25088
    s_waitcnt lgkmcnt(4)
    v_mfma_f32_32x32x16_bf16 v[64:79], v[240:243], v[192:195], v[64:79]
    v_mfma_f32_16x16x32_bf16 v[12:15], v[8:11], v[240:243], v[12:15]
    ds_read_b64_tr_b16 v[240:241], v20 offset:32768
    ds_read_b64_tr_b16 v[242:243], v20 offset:33280
    buffer_load_dwordx4 v42, s[12:15], s76 offen offset:1024 lds
    v_mfma_f32_32x32x16_bf16 v[64:79], v[244:247], v[196:199], v[64:79]
    ds_read_b64_tr_b16 v[244:245], v21 offset:32768
    ds_read_b64_tr_b16 v[246:247], v21 offset:33280
    s_waitcnt lgkmcnt(4)
    v_mfma_f32_32x32x16_bf16 v[64:79], v[248:251], v[200:203], v[64:79]
    ds_read_b64_tr_b16 v[248:249], v22 offset:32768
    ds_read_b64_tr_b16 v[250:251], v22 offset:33280
    v_mfma_f32_32x32x16_bf16 v[64:79], v[252:255], v[204:207], v[64:79]
    ds_read_b64_tr_b16 v[252:253], v23 offset:32768
    s_add_u32 m0, s86, 32768
    ds_read_b64_tr_b16 v[254:255], v23 offset:33280
    buffer_load_dwordx4 v5, s[12:15], s77 offen lds
    s_waitcnt lgkmcnt(4)
    v_mfma_f32_32x32x16_bf16 v[64:79], v[240:243], v[208:211], v[64:79]
    v_mfma_f32_16x16x32_bf16 v[12:15], v[8:11], v[240:243], v[12:15]
    ds_read_b64_tr_b16 v[240:241], v20 offset:40960
    ds_read_b64_tr_b16 v[242:243], v20 offset:41472
    v_mfma_f32_32x32x16_bf16 v[64:79], v[244:247], v[212:215], v[64:79]
    ds_read_b64_tr_b16 v[244:245], v21 offset:40960
    ds_read_b64_tr_b16 v[246:247], v21 offset:41472
    s_waitcnt lgkmcnt(4)
    v_mfma_f32_32x32x16_bf16 v[64:79], v[248:251], v[216:219], v[64:79]
    ds_read_b64_tr_b16 v[248:249], v22 offset:40960
    ds_read_b64_tr_b16 v[250:251], v22 offset:41472
    buffer_load_dwordx4 v42, s[12:15], s77 offen offset:1024 lds
    v_mfma_f32_32x32x16_bf16 v[64:79], v[252:255], v[220:223], v[64:79]
    ds_read_b64_tr_b16 v[252:253], v23 offset:40960
    ds_read_b64_tr_b16 v[254:255], v23 offset:41472
    s_waitcnt lgkmcnt(4)
    v_mfma_f32_32x32x16_bf16 v[64:79], v[240:243], v[224:227], v[64:79]
    v_mfma_f32_16x16x32_bf16 v[12:15], v[8:11], v[240:243], v[12:15]
    v_mfma_f32_32x32x16_bf16 v[64:79], v[244:247], v[228:231], v[64:79]
    s_nop 6
    ds_write_b32 v6, v12
    s_waitcnt vmcnt(9)
    v_cmp_le_u32 vcc, 32, v44
    s_nop 0
    s_andn2_b32 s95, 0x1, vcc_lo
    s_cbranch_scc1 L_slow0
L_ret0:
    s_waitcnt vmcnt(8) lgkmcnt(0)
    s_barrier
    s_setprio 2
    ds_read_b128 v[56:59], v7 offset:0
    v_mov_b32 v33, v17
    v_mfma_f32_32x32x16_bf16 v[64:79], v[248:251], v[232:235], v[64:79]
    v_mfma_f32_32x32x16_bf16 v[64:79], v[252:255], v[236:239], v[64:79]
    s_waitcnt lgkmcnt(0)
    v_add_f32 v56, v56, v57
    v_add_f32 v58, v58, v59
    v_add_f32 v56, v56, v58
    v_cvt_pk_bf16_f32 v57, v56, v56
    v_lshlrev_b32 v57, 16, v57
    v_sub_f32 v57, v56, v57
    v_cvt_pk_bf16_f32 v32, v56, v57
    s_nop 1
    v_mfma_f32_32x32x8_bf16 v[64:79], v[32:33], v[36:37], v[64:79]
    s_setprio 0
    s_nop 10
    v_mul_f32 v48, v64, v64
    v_mul_f32 v49, v65, v65
    v_mul_f32 v50, v66, v66
    v_mul_f32 v51, v67, v67
    v_fma_f32 v48, v48, v39, v38
    v_fma_f32 v49, v49, v39, v38
    v_fma_f32 v50, v50, v39, v38
    v_fma_f32 v51, v51, v39, v38
    v_mul_f32 v48, v64, v48
    v_mul_f32 v49, v65, v49
    v_mul_f32 v50, v66, v50
    v_mul_f32 v51, v67, v51
    v_exp_f32 v48, v48
    v_exp_f32 v49, v49
    v_exp_f32 v50, v50
    v_exp_f32 v51, v51
    v_fma_f32 v48, v48, v40, v40
    v_fma_f32 v49, v49, v40, v40
    v_fma_f32 v50, v50, v40, v40
    v_fma_f32 v51, v51, v40, v40
    v_rcp_f32 v48, v48
    v_rcp_f32 v49, v49
    v_rcp_f32 v50, v50
    v_rcp_f32 v51, v51
    v_mul_f32 v64, v64, v48
    v_mul_f32 v65, v65, v49
    v_mul_f32 v66, v66, v50
    v_mul_f32 v67, v67, v51
    v_cvt_pk_bf16_f32 v64, v64, v65
    v_cvt_pk_bf16_f32 v65, v66, v67
    v_mul_f32 v48, v68, v68
    v_mul_f32 v49, v69, v69
    v_mul_f32 v50, v70, v70
    v_mul_f32 v51, v71, v71
    v_fma_f32 v48, v48, v39, v38
    v_fma_f32 v49, v49, v39, v38
    v_fma_f32 v50, v50, v39, v38
    v_fma_f32 v51, v51, v39, v38
    v_mul_f32 v48, v68, v48
    v_mul_f32 v49, v69, v49
    v_mul_f32 v50, v70, v50
    v_mul_f32 v51, v71, v51
    v_exp_f32 v48, v48
    v_exp_f32 v49, v49
    v_exp_f32 v50, v50
    v_exp_f32 v51, v51
    v_fma_f32 v48, v48, v40, v40
    v_fma_f32 v49, v49, v40, v40
    v_fma_f32 v50, v50, v40, v40
    v_fma_f32 v51, v51, v40, v40
    v_rcp_f32 v48, v48
    v_rcp_f32 v49, v49
    v_rcp_f32 v50, v50
    v_rcp_f32 v51, v51
    v_mul_f32 v68, v68, v48
    v_mul_f32 v69, v69, v49
    v_mul_f32 v70, v70, v50
    v_mul_f32 v71, v71, v51
    v_cvt_pk_bf16_f32 v66, v68, v69
    v_add_u32 v20, 0xffff0000, v20
    v_cvt_pk_bf16_f32 v67, v70, v71
    buffer_store_dwordx4 v[64:67], v1, s[16:19], s90 offen offset:0 sc1
    v_lshrrev_b32 v116, 3, v0
    v_add_u32 v21, 0xffff0000, v21
    v_and_b32 v117, 0x70, v1
    v_mul_u32_u24 v116, 896, v116
    s_lshl_b32 s95, s7, 7
    v_add_u32 v116, v116, v117
    v_add_u32 v22, 0xffff0000, v22
    buffer_load_dwordx4 v[108:111], v116, s[8:11], s63 offen
    v_mul_f32 v48, v72, v72
    v_mul_f32 v49, v73, v73
    v_mul_f32 v50, v74, v74
    v_add_u32 v23, 0xffff0000, v23
    v_mul_f32 v51, v75, v75
    v_fma_f32 v48, v48, v39, v38
    v_fma_f32 v49, v49, v39, v38
    v_fma_f32 v50, v50, v39, v38
    ds_read_b64_tr_b16 v[240:241], v20 offset:0
    v_fma_f32 v51, v51, v39, v38
    v_mul_f32 v48, v72, v48
    v_mul_f32 v49, v73, v49
    ds_read_b64_tr_b16 v[242:243], v20 offset:512
    v_mul_f32 v50, v74, v50
    v_mul_f32 v51, v75, v51
    v_exp_f32 v48, v48
    v_exp_f32 v49, v49
    ds_read_b64_tr_b16 v[244:245], v21 offset:0
    v_exp_f32 v50, v50
    v_exp_f32 v51, v51
    v_fma_f32 v48, v48, v40, v40
    v_fma_f32 v49, v49, v40, v40
    ds_read_b64_tr_b16 v[246:247], v21 offset:512
    v_fma_f32 v50, v50, v40, v40
    v_fma_f32 v51, v51, v40, v40
    v_rcp_f32 v48, v48
    v_rcp_f32 v49, v49
    ds_read_b64_tr_b16 v[248:249], v22 offset:0
    buffer_load_dwordx4 v[112:115], v117, s[36:39], s95 offen
    v_rcp_f32 v50, v50
    v_rcp_f32 v51, v51
    ds_read_b64_tr_b16 v[250:251], v22 offset:512
    v_mul_f32 v72, v72, v48
    v_mul_f32 v73, v73, v49
    v_mul_f32 v74, v74, v50
    v_mul_f32 v75, v75, v51
    ds_read_b64_tr_b16 v[252:253], v23 offset:0
    v_cvt_pk_bf16_f32 v72, v72, v73
    v_cvt_pk_bf16_f32 v73, v74, v75
    v_mul_f32 v48, v76, v76
    v_mul_f32 v49, v77, v77
    ds_read_b64_tr_b16 v[254:255], v23 offset:512
    v_mul_f32 v50, v78, v78
    v_mul_f32 v51, v79, v79
    v_fma_f32 v48, v48, v39, v38
    v_fma_f32 v49, v49, v39, v38
    v_fma_f32 v50, v50, v39, v38
    v_fma_f32 v51, v51, v39, v38
    v_mul_f32 v48, v76, v48
    v_mul_f32 v49, v77, v49
    v_mul_f32 v50, v78, v50
    v_mul_f32 v51, v79, v51
    v_exp_f32 v48, v48
    v_exp_f32 v49, v49
    v_exp_f32 v50, v50
    v_exp_f32 v51, v51
    v_fma_f32 v48, v48, v40, v40
    v_fma_f32 v49, v49, v40, v40
    v_fma_f32 v50, v50, v40, v40
    v_fma_f32 v51, v51, v40, v40
    v_rcp_f32 v48, v48
    v_rcp_f32 v49, v49
    v_rcp_f32 v50, v50
    v_rcp_f32 v51, v51
    v_mul_f32 v76, v76, v48
    v_mul_f32 v77, v77, v49
    v_mul_f32 v78, v78, v50
    v_mul_f32 v79, v79, v51
    v_cvt_pk_bf16_f32 v74, v76, v77
    v_cvt_pk_bf16_f32 v75, v78, v79
    buffer_store_dwordx4 v[72:75], v1, s[16:19], s90 offen offset:1024 sc1
    s_add_u32 s90, s90, 4096
    s_waitcnt vmcnt(4) lgkmcnt(0)
    s_barrier
    buffer_store_dword v47, v46, s[16:19], s91 offen offset:0 sc1
    s_setprio 1
    v_mfma_f32_32x32x16_bf16 v[64:79], v[240:243], v[128:131], 0
    v_mfma_f32_16x16x32_bf16 v[12:15], v[8:11], v[240:243], 0
    ds_read_b64_tr_b16 v[240:241], v20 offset:8192
    ds_read_b64_tr_b16 v[242:243], v20 offset:8704
    v_mfma_f32_32x32x16_bf16 v[64:79], v[244:247], v[132:135], v[64:79]
    ds_read_b64_tr_b16 v[244:245], v21 offset:8192
    ds_read_b64_tr_b16 v[246:247], v21 offset:8704
    s_lshr_b32 s86, s86, 1
    s_add_u32 m0, s86, 61440
    s_nop 0
    buffer_load_dwordx4 v125, s[12:15], s74 offen lds
    v_mfma_f32_32x32x16_bf16 v[64:79], v[248:251], v[136:139], v[64:79]
    ds_read_b64_tr_b16 v[248:249], v22 offset:8192
    ds_read_b64_tr_b16 v[250:251], v22 offset:8704
    v_mfma_f32_32x32x16_bf16 v[64:79], v[252:255], v[140:143], v[64:79]
    ds_read_b64_tr_b16 v[252:253], v23 offset:8192
    ds_read_b64_tr_b16 v[254:255], v23 offset:8704
    s_waitcnt lgkmcnt(4)
    v_mfma_f32_32x32x16_bf16 v[64:79], v[240:243], v[144:147], v[64:79]
    v_mfma_f32_16x16x32_bf16 v[12:15], v[8:11], v[240:243], v[12:15]
    ds_read_b64_tr_b16 v[240:241], v20 offset:16384
    s_add_u32 m0, s86, 65536
    ds_read_b64_tr_b16 v[242:243], v20 offset:16896
    buffer_load_dwordx4 v125, s[12:15], s75 offen lds
    v_mfma_f32_32x32x16_bf16 v[64:79], v[244:247], v[148:151], v[64:79]
    ds_read_b64_tr_b16 v[244:245], v21 offset:16384
    ds_read_b64_tr_b16 v[246:247], v21 offset:16896
    s_waitcnt lgkmcnt(4)
    v_mfma_f32_32x32x16_bf16 v[64:79], v[248:251], v[152:155], v[64:79]
    ds_read_b64_tr_b16 v[248:249], v22 offset:16384
    ds_read_b64_tr_b16 v[250:251], v22 offset:16896
    v_mfma_f32_32x32x16_bf16 v[64:79], v[252:255], v[156:159], v[64:79]
    ds_read_b64_tr_b16 v[252:253], v23 offset:16384
    s_add_u32 m0, s86, 69632
    ds_read_b64_tr_b16 v[254:255], v23 offset:16896
    buffer_load_dwordx4 v125, s[12:15], s76 offen lds
    s_waitcnt lgkmcnt(4)
    v_mfma_f32_32x32x16_bf16 v[64:79], v[240:243], v[160:163], v[64:79]
    v_mfma_f32_16x16x32_bf16 v[12:15], v[8:11], v[240:243], v[12:15]
    ds_read_b64_tr_b16 v[240:241], v20 offset:24576
    ds_read_b64_tr_b16 v[242:243], v20 offset:25088
    v_mfma_f32_32x32x16_bf16 v[64:79], v[244:247], v[164:167], v[64:79]
    ds_read_b64_tr_b16 v[244:245], v21 offset:24576
    ds_read_b64_tr_b16 v[246:247], v21 offset:25088
    s_waitcnt lgkmcnt(4)
    v_mfma_f32_32x32x16_bf16 v[64:79], v[248:251], v[168:171], v[64:79]
    ds_read_b64_tr_b16 v[248:249], v22 offset:24576
    s_add_u32 m0, s86, 73728
    ds_read_b64_tr_b16 v[250:251], v22 offset:25088
    buffer_load_dwordx4 v125, s[12:15], s77 offen lds
    v_mfma_f32_32x32x16_bf16 v[64:79], v[252:255], v[172:175], v[64:79]
    ds_read_b64_tr_b16 v[252:253], v23 offset:24576
    ds_read_b64_tr_b16 v[254:255], v23 offset:25088
    s_waitcnt lgkmcnt(4)
    v_mfma_f32_32x32x16_bf16 v[64:79], v[240:243], v[176:179], v[64:79]
    v_mfma_f32_16x16x32_bf16 v[12:15], v[8:11], v[240:243], v[12:15]
    ds_read_b64_tr_b16 v[240:241], v20 offset:32768
    ds_read_b64_tr_b16 v[242:243], v20 offset:33280
    v_mfma_f32_32x32x16_bf16 v[64:79], v[244:247], v[180:183], v[64:79]
    ds_read_b64_tr_b16 v[244:245], v21 offset:32768
    ds_read_b64_tr_b16 v[246:247], v21 offset:33280
    s_xor_b32 s88, s89, 17
    s_add_u32 m0, s100, 0
    s_mul_i32 s88, s88, 14336
    s_add_u32 s88, s88, s58
    buffer_load_dwordx4 v2, s[20:23], s88 offen lds
    s_waitcnt lgkmcnt(4)
    v_mfma_f32_32x32x16_bf16 v[64:79], v[248:251], v[184:187], v[64:79]
    ds_read_b64_tr_b16 v[248:249], v22 offset:32768
    ds_read_b64_tr_b16 v[250:251], v22 offset:33280
    v_mfma_f32_32x32x16_bf16 v[64:79], v[252:255], v[188:191], v[64:79]
    ds_read_b64_tr_b16 v[252:253], v23 offset:32768
    ds_read_b64_tr_b16 v[254:255], v23 offset:33280
    s_waitcnt lgkmcnt(4)
    v_mfma_f32_32x32x16_bf16 v[64:79], v[240:243], v[192:195], v[64:79]
    v_mfma_f32_16x16x32_bf16 v[12:15], v[8:11], v[240:243], v[12:15]
    ds_read_b64_tr_b16 v[240:241], v20 offset:40960
    ds_read_b64_tr_b16 v[242:243], v20 offset:41472
    buffer_load_dwordx4 v3, s[20:23], s88 offen offset:1024 lds
    v_mfma_f32_32x32x16_bf16 v[64:79], v[244:247], v[196:199], v[64:79]
    ds_read_b64_tr_b16 v[244:245], v21 offset:40960
    ds_read_b64_tr_b16 v[246:247], v21 offset:41472
    s_waitcnt lgkmcnt(4)
    v_mfma_f32_32x32x16_bf16 v[64:79], v[248:251], v[200:203], v[64:79]
    ds_read_b64_tr_b16 v[248:249], v22 offset:40960
    ds_read_b64_tr_b16 v[250:251], v22 offset:41472
    v_mfma_f32_32x32x16_bf16 v[64:79], v[252:255], v[204:207], v[64:79]
    ds_read_b64_tr_b16 v[252:253], v23 offset:40960
    ds_read_b64_tr_b16 v[254:255], v23 offset:41472
    s_waitcnt lgkmcnt(4)
    v_mfma_f32_32x32x16_bf16 v[64:79], v[240:243], v[208:211], v[64:79]
    v_mfma_f32_16x16x32_bf16 v[12:15], v[8:11], v[240:243], v[12:15]
    ds_read_b64_tr_b16 v[240:241], v20 offset:49152
    ds_read_b64_tr_b16 v[242:243], v20 offset:49664
    v_mfma_f32_32x32x16_bf16 v[64:79], v[244:247], v[212:215], v[64:79]
    ds_read_b64_tr_b16 v[244:245], v21 offset:49152
    ds_read_b64_tr_b16 v[246:247], v21 offset:49664
    s_waitcnt lgkmcnt(4)
    v_mfma_f32_32x32x16_bf16 v[64:79], v[248:251], v[216:219], v[64:79]
    ds_read_b64_tr_b16 v[248:249], v22 offset:49152
    ds_read_b64_tr_b16 v[250:251], v22 offset:49664
    v_mfma_f32_32x32x16_bf16 v[64:79], v[252:255], v[220:223], v[64:79]
    ds_read_b64_tr_b16 v[252:253], v23 offset:49152
    ds_read_b64_tr_b16 v[254:255], v23 offset:49664
    s_waitcnt lgkmcnt(4)
    v_mfma_f32_32x32x16_bf16 v[64:79], v[240:243], v[224:227], v[64:79]
    v_mfma_f32_16x16x32_bf16 v[12:15], v[8:11], v[240:243], v[12:15]
    v_mfma_f32_32x32x16_bf16 v[64:79], v[244:247], v[228:231], v[64:79]
    s_nop 6
    ds_write_b32 v6, v12
    s_waitcnt vmcnt(7) lgkmcnt(0)
    s_barrier
    s_setprio 2
    ds_read_b128 v[56:59], v7 offset:0
    v_mov_b32 v33, v18
    v_mfma_f32_32x32x16_bf16 v[64:79], v[248:251], v[232:235], v[64:79]
    v_mfma_f32_32x32x16_bf16 v[64:79], v[252:255], v[236:239], v[64:79]
    s_waitcnt lgkmcnt(0)
    v_add_f32 v56, v56, v57
    v_add_f32 v58, v58, v59
    v_add_f32 v56, v56, v58
    v_cvt_pk_bf16_f32 v57, v56, v56
    v_lshlrev_b32 v57, 16, v57
    v_sub_f32 v57, v56, v57
    v_cvt_pk_bf16_f32 v32, v56, v57
    s_nop 1
    v_mfma_f32_32x32x8_bf16 v[64:79], v[32:33], v[36:37], v[64:79]
    s_setprio 0
    s_xor_b32 s88, s89, 19
    s_add_u32 m0, s100, 4096
    s_mul_i32 s88, s88, 14336
    s_add_u32 s88, s88, s58
    buffer_load_dwordx4 v2, s[20:23], s88 offen lds
    buffer_load_dwordx4 v3, s[20:23], s88 offen offset:1024 lds
    s_nop 4
    v_mul_f32 v48, v64, v64
    v_mul_f32 v49, v65, v65
    v_mul_f32 v50, v66, v66
    v_mul_f32 v51, v67, v67
    v_fma_f32 v48, v48, v39, v38
    v_fma_f32 v49, v49, v39, v38
    v_fma_f32 v50, v50, v39, v38
    v_fma_f32 v51, v51, v39, v38
    v_mul_f32 v48, v64, v48
    v_mul_f32 v49, v65, v49
    v_mul_f32 v50, v66, v50
    v_mul_f32 v51, v67, v51
    v_exp_f32 v48, v48
    v_exp_f32 v49, v49
    v_exp_f32 v50, v50
    v_exp_f32 v51, v51
    v_fma_f32 v48, v48, v40, v40
    v_fma_f32 v49, v49, v40, v40
    v_fma_f32 v50, v50, v40, v40
    v_fma_f32 v51, v51, v40, v40
    v_rcp_f32 v48, v48
    v_rcp_f32 v49, v49
    v_rcp_f32 v50, v50
    v_rcp_f32 v51, v51
    v_mul_f32 v64, v64, v48
    v_mul_f32 v65, v65, v49
    v_mul_f32 v66, v66, v50
    v_mul_f32 v67, v67, v51
    v_cvt_pk_bf16_f32 v64, v64, v65
    v_cvt_pk_bf16_f32 v65, v66, v67
    v_mul_f32 v48, v68, v68
    v_mul_f32 v49, v69, v69
    v_mul_f32 v50, v70, v70
    v_mul_f32 v51, v71, v71
    v_fma_f32 v48, v48, v39, v38
    v_fma_f32 v49, v49, v39, v38
    v_fma_f32 v50, v50, v39, v38
    v_fma_f32 v51, v51, v39, v38
    v_mul_f32 v48, v68, v48
    v_mul_f32 v49, v69, v49
    v_mul_f32 v50, v70, v50
    v_mul_f32 v51, v71, v51
    v_exp_f32 v48, v48
    v_exp_f32 v49, v49
    v_exp_f32 v50, v50
    v_exp_f32 v51, v51
    v_fma_f32 v48, v48, v40, v40
    v_fma_f32 v49, v49, v40, v40
    v_fma_f32 v50, v50, v40, v40
    v_fma_f32 v51, v51, v40, v40
    v_rcp_f32 v48, v48
    v_rcp_f32 v49, v49
    v_rcp_f32 v50, v50
    v_rcp_f32 v51, v51
    v_mul_f32 v68, v68, v48
    v_xor_b32 v20, 0, v126
    v_mul_f32 v69, v69, v49
    v_mul_f32 v70, v70, v50
    v_mul_f32 v71, v71, v51
    v_cvt_pk_bf16_f32 v66, v68, v69
    v_xor_b32 v21, 1024, v126
    v_cvt_pk_bf16_f32 v67, v70, v71
    buffer_store_dwordx4 v[64:67], v1, s[16:19], s90 offen offset:0 sc1
    v_mul_f32 v48, v72, v72
    v_mul_f32 v49, v73, v73
    v_xor_b32 v22, 2048, v126
    v_mul_f32 v50, v74, v74
    v_mul_f32 v51, v75, v75
    v_fma_f32 v48, v48, v39, v38
    v_xor_b32 v23, 3072, v126
    v_fma_f32 v49, v49, v39, v38
    v_fma_f32 v50, v50, v39, v38
    v_fma_f32 v51, v51, v39, v38
    v_mul_f32 v48, v72, v48
    ds_read_b64_tr_b16 v[240:241], v20 offset:0
    v_mul_f32 v49, v73, v49
    v_mul_f32 v50, v74, v50
    v_mul_f32 v51, v75, v51
    ds_read_b64_tr_b16 v[242:243], v20 offset:256
    v_exp_f32 v48, v48
    v_exp_f32 v49, v49
    v_exp_f32 v50, v50
    v_exp_f32 v51, v51
    ds_read_b64_tr_b16 v[244:245], v21 offset:0
    v_fma_f32 v48, v48, v40, v40
    v_fma_f32 v49, v49, v40, v40
    v_fma_f32 v50, v50, v40, v40
    ds_read_b64_tr_b16 v[246:247], v21 offset:256
    v_fma_f32 v51, v51, v40, v40
    v_rcp_f32 v48, v48
    v_rcp_f32 v49, v49
    v_rcp_f32 v50, v50
    ds_read_b64_tr_b16 v[248:249], v22 offset:0
    v_rcp_f32 v51, v51
    v_mul_f32 v72, v72, v48
    v_mul_f32 v73, v73, v49
    ds_read_b64_tr_b16 v[250:251], v22 offset:256
    v_mul_f32 v74, v74, v50
    v_mul_f32 v75, v75, v51
    v_cvt_pk_bf16_f32 v72, v72, v73
    v_cvt_pk_bf16_f32 v73, v74, v75
    ds_read_b64_tr_b16 v[252:253], v23 offset:0
    v_mul_f32 v48, v76, v76
    v_mul_f32 v49, v77, v77
    v_mul_f32 v50, v78, v78
    v_mul_f32 v51, v79, v79
    ds_read_b64_tr_b16 v[254:255], v23 offset:256
    v_fma_f32 v48, v48, v39, v38
    v_fma_f32 v49, v49, v39, v38
    v_fma_f32 v50, v50, v39, v38
    v_fma_f32 v51, v51, v39, v38
    v_mul_f32 v48, v76, v48
    v_mul_f32 v49, v77, v49
    v_mul_f32 v50, v78, v50
    v_mul_f32 v51, v79, v51
    v_exp_f32 v48, v48
    v_exp_f32 v49, v49
    v_exp_f32 v50, v50
    v_exp_f32 v51, v51
    v_fma_f32 v48, v48, v40, v40
    v_fma_f32 v49, v49, v40, v40
    v_fma_f32 v50, v50, v40, v40
    v_fma_f32 v51, v51, v40, v40
    v_rcp_f32 v48, v48
    v_rcp_f32 v49, v49
    v_rcp_f32 v50, v50
    v_rcp_f32 v51, v51
    v_mul_f32 v76, v76, v48
    v_mul_f32 v77, v77, v49
    v_mul_f32 v78, v78, v50
    v_mul_f32 v79, v79, v51
    v_cvt_pk_bf16_f32 v74, v76, v77
    v_cvt_pk_bf16_f32 v75, v78, v79
    buffer_store_dwordx4 v[72:75], v1, s[16:19], s90 offen offset:1024 sc1
    s_add_u32 s90, s90, 4096
    s_waitcnt vmcnt(6) lgkmcnt(0)
    s_barrier
    buffer_store_dword v47, v46, s[16:19], s91 offen offset:256 sc1
    s_setprio 1
    v_mfma_f32_32x32x16_bf16 v[64:79], v[240:243], v[128:131], 0
    v_mfma_f32_16x16x32_bf16 v[12:15], v[8:11], v[240:243], 0
    ds_read_b64_tr_b16 v[240:241], v20 offset:4096
    ds_read_b64_tr_b16 v[242:243], v20 offset:4352
    v_mfma_f32_32x32x16_bf16 v[64:79], v[244:247], v[132:135], v[64:79]
    ds_read_b64_tr_b16 v[244:245], v21 offset:4096
    ds_read_b64_tr_b16 v[246:247], v21 offset:4352
    s_xor_b32 s88, s89, 7
    s_add_u32 m0, s59, 6144
    s_mul_i32 s88, s88, 14336
    s_add_u32 s88, s88, s58
    buffer_load_dwordx4 v2, s[20:23], s88 offen lds
    v_mfma_f32_32x32x16_bf16 v[64:79], v[248:251], v[136:139], v[64:79]
    ds_read_b64_tr_b16 v[248:249], v22 offset:4096
    ds_read_b64_tr_b16 v[250:251], v22 offset:4352
    v_mfma_f32_32x32x16_bf16 v[64:79], v[252:255], v[140:143], v[64:79]
    ds_read_b64_tr_b16 v[252:253], v23 offset:4096
    ds_read_b64_tr_b16 v[254:255], v23 offset:4352
    s_waitcnt lgkmcnt(4)
    v_mfma_f32_32x32x16_bf16 v[64:79], v[240:243], v[144:147], v[64:79]
    v_mfma_f32_16x16x32_bf16 v[12:15], v[8:11], v[240:243], v[12:15]
    ds_read_b64_tr_b16 v[240:241], v20 offset:8192
    ds_read_b64_tr_b16 v[242:243], v20 offset:8448
    buffer_load_dwordx4 v3, s[20:23], s88 offen offset:1024 lds
    v_mfma_f32_32x32x16_bf16 v[64:79], v[244:247], v[148:151], v[64:79]
    ds_read_b64_tr_b16 v[244:245], v21 offset:8192
    ds_read_b64_tr_b16 v[246:247], v21 offset:8448
    s_waitcnt lgkmcnt(4)
    v_mfma_f32_32x32x16_bf16 v[64:79], v[248:251], v[152:155], v[64:79]
    ds_read_b64_tr_b16 v[248:249], v22 offset:8192
    ds_read_b64_tr_b16 v[250:251], v22 offset:8448
    v_mfma_f32_32x32x16_bf16 v[64:79], v[252:255], v[156:159], v[64:79]
    ds_read_b64_tr_b16 v[252:253], v23 offset:8192
    ds_read_b64_tr_b16 v[254:255], v23 offset:8448
    s_xor_b32 s88, s89, 20
    s_add_u32 m0, s59, 8192
    s_mul_i32 s88, s88, 14336
    s_add_u32 s88, s88, s58
    buffer_load_dwordx4 v2, s[20:23], s88 offen lds
    s_waitcnt lgkmcnt(4)
    v_mfma_f32_32x32x16_bf16 v[64:79], v[240:243], v[160:163], v[64:79]
    v_mfma_f32_16x16x32_bf16 v[12:15], v[8:11], v[240:243], v[12:15]
    ds_read_b64_tr_b16 v[240:241], v20 offset:12288
    ds_read_b64_tr_b16 v[242:243], v20 offset:12544
    v_mfma_f32_32x32x16_bf16 v[64:79], v[244:247], v[164:167], v[64:79]
    ds_read_b64_tr_b16 v[244:245], v21 offset:12288
    ds_read_b64_tr_b16 v[246:247], v21 offset:12544
    s_waitcnt lgkmcnt(4)
    v_mfma_f32_32x32x16_bf16 v[64:79], v[248:251], v[168:171], v[64:79]
    ds_read_b64_tr_b16 v[248:249], v22 offset:12288
    ds_read_b64_tr_b16 v[250:251], v22 offset:12544
    buffer_load_dwordx4 v3, s[20:23], s88 offen offset:1024 lds
    v_mfma_f32_32x32x16_bf16 v[64:79], v[252:255], v[172:175], v[64:79]
    ds_read_b64_tr_b16 v[252:253], v23 offset:12288
    ds_read_b64_tr_b16 v[254:255], v23 offset:12544
    s_waitcnt lgkmcnt(4)
    v_mfma_f32_32x32x16_bf16 v[64:79], v[240:243], v[176:179], v[64:79]
    v_mfma_f32_16x16x32_bf16 v[12:15], v[8:11], v[240:243], v[12:15]
    ds_read_b64_tr_b16 v[240:241], v20 offset:16384
    ds_read_b64_tr_b16 v[242:243], v20 offset:16640
    v_mfma_f32_32x32x16_bf16 v[64:79], v[244:247], v[180:183], v[64:79]
    ds_read_b64_tr_b16 v[244:245], v21 offset:16384
    ds_read_b64_tr_b16 v[246:247], v21 offset:16640
    s_xor_b32 s88, s89, 21
    s_add_u32 m0, s59, 10240
    s_mul_i32 s88, s88, 14336
    s_add_u32 s88, s88, s58
    buffer_load_dwordx4 v2, s[20:23], s88 offen lds
    s_waitcnt lgkmcnt(4)
    v_mfma_f32_32x32x16_bf16 v[64:79], v[248:251], v[184:187], v[64:79]
    ds_read_b64_tr_b16 v[248:249], v22 offset:16384
    ds_read_b64_tr_b16 v[250:251], v22 offset:16640
    v_mfma_f32_32x32x16_bf16 v[64:79], v[252:255], v[188:191], v[64:79]
    ds_read_b64_tr_b16 v[252:253], v23 offset:16384
    ds_read_b64_tr_b16 v[254:255], v23 offset:16640
    s_waitcnt lgkmcnt(4)
    v_mfma_f32_32x32x16_bf16 v[64:79], v[240:243], v[192:195], v[64:79]
    v_mfma_f32_16x16x32_bf16 v[12:15], v[8:11], v[240:243], v[12:15]
    ds_read_b64_tr_b16 v[240:241], v20 offset:20480
    ds_read_b64_tr_b16 v[242:243], v20 offset:20736
    buffer_load_dwordx4 v3, s[20:23], s88 offen offset:1024 lds
    v_mfma_f32_32x32x16_bf16 v[64:79], v[244:247], v[196:199], v[64:79]
    ds_read_b64_tr_b16 v[244:245], v21 offset:20480
    ds_read_b64_tr_b16 v[246:247], v21 offset:20736
    s_waitcnt lgkmcnt(4)
    v_mfma_f32_32x32x16_bf16 v[64:79], v[248:251], v[200:203], v[64:79]
    ds_read_b64_tr_b16 v[248:249], v22 offset:20480
    ds_read_b64_tr_b16 v[250:251], v22 offset:20736
    v_mfma_f32_32x32x16_bf16 v[64:79], v[252:255], v[204:207], v[64:79]
    ds_read_b64_tr_b16 v[252:253], v23 offset:20480
    ds_read_b64_tr_b16 v[254:255], v23 offset:20736
    s_waitcnt lgkmcnt(4)
    v_mfma_f32_32x32x16_bf16 v[64:79], v[240:243], v[208:211], v[64:79]
    v_mfma_f32_16x16x32_bf16 v[12:15], v[8:11], v[240:243], v[12:15]
    ds_read_b64_tr_b16 v[240:241], v20 offset:24576
    ds_read_b64_tr_b16 v[242:243], v20 offset:24832
    v_mfma_f32_32x32x16_bf16 v[64:79], v[244:247], v[212:215], v[64:79]
    ds_read_b64_tr_b16 v[244:245], v21 offset:24576
    ds_read_b64_tr_b16 v[246:247], v21 offset:24832
    s_waitcnt lgkmcnt(4)
    v_mfma_f32_32x32x16_bf16 v[64:79], v[248:251], v[216:219], v[64:79]
    ds_read_b64_tr_b16 v[248:249], v22 offset:24576
    ds_read_b64_tr_b16 v[250:251], v22 offset:24832
    v_mfma_f32_32x32x16_bf16 v[64:79], v[252:255], v[220:223], v[64:79]
    ds_read_b64_tr_b16 v[252:253], v23 offset:24576
    ds_read_b64_tr_b16 v[254:255], v23 offset:24832
    s_waitcnt lgkmcnt(4)
    v_mfma_f32_32x32x16_bf16 v[64:79], v[240:243], v[224:227], v[64:79]
    v_mfma_f32_16x16x32_bf16 v[12:15], v[8:11], v[240:243], v[12:15]
    v_mfma_f32_32x32x16_bf16 v[64:79], v[244:247], v[228:231], v[64:79]
    s_nop 6
    ds_write_b32 v6, v12
    s_waitcnt vmcnt(9) lgkmcnt(0)
    s_barrier
    ds_read_b128 v[80:83], v43
    ds_read_b128 v[84:87], v43 offset:1024
    s_sub_u32 s82, s90, 2048
    s_cmp_eq_u32 s98, 0
    s_cselect_b32 s83, 0, 14336
    s_sub_u32 s90, s90, s83
    s_setprio 2
    ds_read_b128 v[56:59], v7 offset:0
    v_mov_b32 v33, v19
    v_mfma_f32_32x32x16_bf16 v[64:79], v[248:251], v[232:235], v[64:79]
    v_mfma_f32_32x32x16_bf16 v[64:79], v[252:255], v[236:239], v[64:79]
    s_waitcnt lgkmcnt(0)
    v_add_f32 v56, v56, v57
    v_add_f32 v58, v58, v59
    v_add_f32 v56, v56, v58
    v_cvt_pk_bf16_f32 v57, v56, v56
    v_lshlrev_b32 v57, 16, v57
    v_sub_f32 v57, v56, v57
    v_cvt_pk_bf16_f32 v32, v56, v57
    s_nop 1
    v_mfma_f32_32x32x8_bf16 v[64:79], v[32:33], v[36:37], v[64:79]
    buffer_store_dwordx4 v[80:83], v1, s[16:19], s82 offen offset:0 sc1
    buffer_store_dwordx4 v[84:87], v1, s[16:19], s82 offen offset:1024 sc1
    s_nop 9
    v_mul_f32 v48, v64, v64
    v_mul_f32 v49, v65, v65
    v_mul_f32 v50, v66, v66
    v_mul_f32 v51, v67, v67
    v_fma_f32 v48, v48, v39, v38
    v_fma_f32 v49, v49, v39, v38
    v_fma_f32 v50, v50, v39, v38
    v_fma_f32 v51, v51, v39, v38
    v_mul_f32 v48, v64, v48
    v_mul_f32 v49, v65, v49
    v_mul_f32 v50, v66, v50
    v_mul_f32 v51, v67, v51
    v_exp_f32 v48, v48
    v_exp_f32 v49, v49
    v_exp_f32 v50, v50
    v_exp_f32 v51, v51
    v_fma_f32 v48, v48, v40, v40
    v_fma_f32 v49, v49, v40, v40
    v_fma_f32 v50, v50, v40, v40
    v_fma_f32 v51, v51, v40, v40
    v_rcp_f32 v48, v48
    v_rcp_f32 v49, v49
    v_rcp_f32 v50, v50
    v_rcp_f32 v51, v51
    v_mul_f32 v64, v64, v48
    v_mul_f32 v65, v65, v49
    v_mul_f32 v66, v66, v50
    v_mul_f32 v67, v67, v51
    v_cvt_pk_bf16_f32 v64, v64, v65
    v_cvt_pk_bf16_f32 v65, v66, v67
    v_mul_f32 v48, v68, v68
    v_mul_f32 v49, v69, v69
    v_mul_f32 v50, v70, v70
    v_mul_f32 v51, v71, v71
    v_fma_f32 v48, v48, v39, v38
    v_fma_f32 v49, v49, v39, v38
    v_fma_f32 v50, v50, v39, v38
    v_fma_f32 v51, v51, v39, v38
    v_mul_f32 v48, v68, v48
    v_mul_f32 v49, v69, v49
    v_mul_f32 v50, v70, v50
    v_mul_f32 v51, v71, v51
    v_exp_f32 v48, v48
    v_exp_f32 v49, v49
    v_exp_f32 v50, v50
    v_exp_f32 v51, v51
    v_fma_f32 v48, v48, v40, v40
    v_fma_f32 v49, v49, v40, v40
    v_fma_f32 v50, v50, v40, v40
    v_fma_f32 v51, v51, v40, v40
    v_rcp_f32 v48, v48
    v_rcp_f32 v49, v49
    v_rcp_f32 v50, v50
    v_rcp_f32 v51, v51
    v_mul_f32 v68, v68, v48
    v_mul_f32 v69, v69, v49
    v_mul_f32 v70, v70, v50
    v_mul_f32 v71, v71, v51
    v_cvt_pk_bf16_f32 v66, v68, v69
    v_cvt_pk_bf16_f32 v67, v70, v71
    buffer_store_dwordx4 v[64:67], v1, s[16:19], s90 offen offset:0 sc1
    v_mul_f32 v48, v72, v72
    v_mul_f32 v49, v73, v73
    v_mul_f32 v50, v74, v74
    v_mul_f32 v51, v75, v75
    v_fma_f32 v48, v48, v39, v38
    v_fma_f32 v49, v49, v39, v38
    v_fma_f32 v50, v50, v39, v38
    v_fma_f32 v51, v51, v39, v38
    v_mul_f32 v48, v72, v48
    v_mul_f32 v49, v73, v49
    v_mul_f32 v50, v74, v50
    v_mul_f32 v51, v75, v51
    v_exp_f32 v48, v48
    v_exp_f32 v49, v49
    v_exp_f32 v50, v50
    v_exp_f32 v51, v51
    v_fma_f32 v48, v48, v40, v40
    v_fma_f32 v49, v49, v40, v40
    v_fma_f32 v50, v50, v40, v40
    v_fma_f32 v51, v51, v40, v40
    v_rcp_f32 v48, v48
    v_rcp_f32 v49, v49
    v_rcp_f32 v50, v50
    v_rcp_f32 v51, v51
    v_mul_f32 v72, v72, v48
    v_mul_f32 v73, v73, v49
    v_mul_f32 v74, v74, v50
    v_mul_f32 v75, v75, v51
    v_cvt_pk_bf16_f32 v72, v72, v73
    v_cvt_pk_bf16_f32 v73, v74, v75
    v_mul_f32 v48, v76, v76
    v_mul_f32 v49, v77, v77
    v_mul_f32 v50, v78, v78
    v_mul_f32 v51, v79, v79
    v_fma_f32 v48, v48, v39, v38
    v_fma_f32 v49, v49, v39, v38
    v_fma_f32 v50, v50, v39, v38
    v_fma_f32 v51, v51, v39, v38
    v_mul_f32 v48, v76, v48
    v_mul_f32 v49, v77, v49
    v_mul_f32 v50, v78, v50
    v_mul_f32 v51, v79, v51
    v_exp_f32 v48, v48
    v_exp_f32 v49, v49
    v_exp_f32 v50, v50
    v_exp_f32 v51, v51
    v_fma_f32 v48, v48, v40, v40
    v_fma_f32 v49, v49, v40, v40
    v_fma_f32 v50, v50, v40, v40
    v_fma_f32 v51, v51, v40, v40
    v_rcp_f32 v48, v48
    v_rcp_f32 v49, v49
    v_rcp_f32 v50, v50
    v_rcp_f32 v51, v51
    v_mul_f32 v76, v76, v48
    v_mul_f32 v77, v77, v49
    v_mul_f32 v78, v78, v50
    v_mul_f32 v79, v79, v51
    v_cvt_pk_bf16_f32 v74, v76, v77
    v_cvt_pk_bf16_f32 v75, v78, v79
    buffer_store_dwordx4 v[72:75], v1, s[16:19], s90 offen offset:1024 sc1
    s_add_u32 s90, s90, 4096
    s_lshl1_add_u32 s82, s6, s81
    s_lshl_b32 s82, s82, 9
    s_add_u32 s82, s82, s7
    s_lshl_b32 s83, s4, 28
    s_lshl2_add_u32 s82, s82, s83
    s_add_u32 s82, s82, 0x920008
    v_cmp_gt_u32 vcc, 0x100, v1
    v_lshlrev_b32 v31, 3, v1
    s_nop 0
    v_cndmask_b32 v31, v46, v31, vcc
    s_waitcnt vmcnt(0)
    ds_write_b32 v45, v47 offset:0
    v_mov_b32 v56, 157696
L_sy1:
    ds_read_b128 v[48:51], v56 offset:0
    s_add_u32 s94, s94, 1
    s_cmp_gt_u32 s94, 0x10000
    s_cbranch_scc1 L_sz1
    s_waitcnt lgkmcnt(0)
    v_and_b32 v49, v49, v50
    v_and_b32 v48, v48, v49
    v_and_b32 v48, v48, v51
    s_nop 0
    v_readfirstlane_b32 s95, v48
    s_nop 0
    s_cmp_eq_u32 s95, 0
    s_cbranch_scc1 L_sy1
L_sz1:
    s_waitcnt lgkmcnt(0)
    buffer_store_dword v47, v31, s[16:19], s82 offen sc1
    v_mov_b32 v8, v116
    v_lshlrev_b32 v248, 16, v108
    v_and_b32 v249, 0xffff0000, v108
    v_lshlrev_b32 v108, 16, v112
    v_and_b32 v112, 0xffff0000, v112
    v_add_f32 v248, v248, v108
    v_add_f32 v249, v249, v112
    v_lshlrev_b32 v250, 16, v109
    v_and_b32 v251, 0xffff0000, v109
    v_lshlrev_b32 v109, 16, v113
    v_and_b32 v113, 0xffff0000, v113
    v_add_f32 v250, v250, v109
    v_add_f32 v251, v251, v113
    v_lshlrev_b32 v252, 16, v110
    v_and_b32 v253, 0xffff0000, v110
    v_lshlrev_b32 v110, 16, v114
    v_and_b32 v114, 0xffff0000, v114
    v_add_f32 v252, v252, v110
    v_add_f32 v253, v253, v114
    v_lshlrev_b32 v254, 16, v111
    v_and_b32 v255, 0xffff0000, v111
    v_lshlrev_b32 v111, 16, v115
    v_and_b32 v115, 0xffff0000, v115
    v_add_f32 v254, v254, v111
    v_add_f32 v255, v255, v115
    s_branch L_p2a
L_fb:
    s_add_u32 m0, s87, 131072
    s_nop 0
    buffer_load_dwordx4 v3, s[8:11], s67 offen lds
    buffer_load_dwordx4 v4, s[8:11], s67 offen offset:1024 lds
    s_add_u32 m0, s86, 8192
    s_nop 0
    buffer_load_dwordx4 v5, s[12:15], s74 offen lds
    buffer_load_dwordx4 v42, s[12:15], s74 offen offset:1024 lds
    s_mov_b32 s22, 0x188000
    s_mov_b32 s23, 0x20000
    s_mov_b32 s26, 0x62000
    s_mov_b32 s27, 0x20000
    s_mov_b32 s30, 0x1c0000
    s_mov_b32 s31, 0x20000
    s_mov_b32 s38, 0x380
    s_mov_b32 s39, 0x20000
    s_mov_b32 s85, 0x358637bd
    s_mov_b32 s99, 0x3fb8aa3b
    s_mov_b32 s92, 0
    s_mov_b32 s93, -1
    s_mov_b32 s94, 0
    v_and_b32 v52, 7, v52
    v_mul_u32_u24 v2, 896, v49
    v_lshl_add_u32 v2, v52, 4, v2
    s_lshl_b32 s83, s5, 9
    s_add_u32 s83, s83, 159744
    v_lshl_add_u32 v7, v56, 4, s83
    v_lshl_add_u32 v6, s4, 2, v7
    s_lshl2_add_u32 s83, s3, 157696
    v_mov_b32 v45, s83
    ds_write_b32 v45, v33 offset:0
    v_lshlrev_b32 v37, 2, v61
    v_add_u32 v36, 155648, v37
    s_and_b32 s83, s2, 7
    s_lshl2_add_u32 s80, s83, s80
    s_lshl1_add_u32 s83, s80, s7
    s_and_b32 s89, s83, 3
    s_and_b32 s83, s83, 4
    s_lshl2_add_u32 s89, s83, s89
    s_lshl_b32 s83, s7, 7
    s_mul_i32 s58, s4, 401408
    s_add_u32 s58, s58, s83
    s_lshr_b32 s62, s4, 1
    s_mul_i32 s62, s62, 6
    s_add_u32 s62, s62, s4
    s_mul_i32 s62, s62, 25088
    s_add_u32 s62, s62, s83
    s_mul_i32 s63, s80, 57344
    s_add_u32 s63, s63, s83
    s_mul_i32 s59, s4, 12288
    s_mul_i32 s60, s4, 10240
    s_add_u32 s60, s60, 114688
    s_mul_i32 s100, s4, 6144
    s_add_u32 s100, s100, 86016
    s_mul_i32 s61, s80, 294912
    s_lshl2_add_u32 s90, s6, s4
    s_mul_i32 s90, s90, 147456
    s_add_u32 s90, s90, 2048
    s_mul_i32 s83, s82, 32
    s_add_u32 s90, s90, s83
    s_add_u32 s83, s86, 49152
    v_add_u32 v43, s83, v1
    s_mul_i32 s97, s98, -7
    s_add_u32 s97, s97, s82
    s_add_u32 s97, s97, 384
    v_lshrrev_b32 v53, 2, v48
    v_lshl_add_u32 v53, s4, 4, v53
    v_mul_u32_u24 v53, 3584, v53
    v_lshl_add_u32 v125, v59, 4, s97
    v_add_u32 v125, v125, v53
    s_mov_b32 s34, 0xe00
    s_mov_b32 s35, 0x20000
    v_lshlrev_b32 v53, 1, v56
    buffer_load_ushort v16, v53, s[32:35], s82 offen offset:64
    buffer_load_ushort v17, v53, s[32:35], s82 offen offset:192
    buffer_load_ushort v18, v53, s[32:35], s82 offen offset:320
    s_mov_b32 s91, 0x40000000
    s_barrier
    s_setprio 1
    s_add_u32 m0, s87, 65536
    s_nop 0
    buffer_load_dwordx4 v3, s[8:11], s68 offen lds
    buffer_load_dwordx4 v4, s[8:11], s68 offen offset:1024 lds
    s_add_u32 m0, s86, 16384
    s_nop 0
    buffer_load_dwordx4 v5, s[12:15], s75 offen lds
    buffer_load_dwordx4 v42, s[12:15], s75 offen offset:1024 lds
    s_waitcnt vmcnt(11) lgkmcnt(0)
    s_barrier
    v_add_u32 v28, 0x1c000, v28
    v_add_u32 v29, 0x1c000, v29
    v_add_u32 v30, 0x1c000, v30
    v_add_u32 v31, 0x1c000, v31
    ds_read_b128 v[128:131], v28 offset:0
    ds_read_b128 v[132:135], v29 offset:0
    ds_read_b128 v[136:139], v30 offset:0
    s_add_u32 m0, s87, 81920
    ds_read_b128 v[140:143], v31 offset:0
    buffer_load_dwordx4 v3, s[8:11], s69 offen lds
    buffer_load_dwordx4 v4, s[8:11], s69 offen offset:1024 lds
    s_add_u32 m0, s86, 24576
    s_nop 0
    buffer_load_dwordx4 v5, s[12:15], s76 offen lds
    buffer_load_dwordx4 v42, s[12:15], s76 offen offset:1024 lds
    s_waitcnt lgkmcnt(3)
    v_dot2c_f32_bf16 v38, s84, v128
    v_dot2c_f32_bf16 v40, v128, v128
    v_dot2c_f32_bf16 v39, s84, v129
    v_dot2c_f32_bf16 v41, v129, v129
    v_dot2c_f32_bf16 v38, s84, v130
    v_dot2c_f32_bf16 v40, v130, v130
    v_dot2c_f32_bf16 v39, s84, v131
    v_dot2c_f32_bf16 v41, v131, v131
    s_waitcnt lgkmcnt(2)
    v_dot2c_f32_bf16 v38, s84, v132
    v_dot2c_f32_bf16 v40, v132, v132
    v_dot2c_f32_bf16 v39, s84, v133
    v_dot2c_f32_bf16 v41, v133, v133
    v_dot2c_f32_bf16 v38, s84, v134
    v_dot2c_f32_bf16 v40, v134, v134
    v_dot2c_f32_bf16 v39, s84, v135
    v_dot2c_f32_bf16 v41, v135, v135
    s_waitcnt lgkmcnt(1)
    v_dot2c_f32_bf16 v38, s84, v136
    v_dot2c_f32_bf16 v40, v136, v136
    v_dot2c_f32_bf16 v39, s84, v137
    v_dot2c_f32_bf16 v41, v137, v137
    v_dot2c_f32_bf16 v38, s84, v138
    v_dot2c_f32_bf16 v40, v138, v138
    v_dot2c_f32_bf16 v39, s84, v139
    v_dot2c_f32_bf16 v41, v139, v139
    s_waitcnt lgkmcnt(0)
    v_dot2c_f32_bf16 v38, s84, v140
    v_dot2c_f32_bf16 v40, v140, v140
    v_dot2c_f32_bf16 v39, s84, v141
    v_dot2c_f32_bf16 v41, v141, v141
    v_dot2c_f32_bf16 v38, s84, v142
    v_dot2c_f32_bf16 v40, v142, v142
    v_dot2c_f32_bf16 v39, s84, v143
    v_dot2c_f32_bf16 v41, v143, v143
    s_waitcnt vmcnt(11) lgkmcnt(0)
    s_barrier
    ds_read_b128 v[144:147], v28 offset:16384
    ds_read_b128 v[148:151], v29 offset:16384
    ds_read_b128 v[152:155], v30 offset:16384
    s_add_u32 m0, s87, 98304
    ds_read_b128 v[156:159], v31 offset:16384
    buffer_load_dwordx4 v3, s[8:11], s70 offen lds
    buffer_load_dwordx4 v4, s[8:11], s70 offen offset:1024 lds
    s_add_u32 m0, s86, 32768
    s_nop 0
    buffer_load_dwordx4 v5, s[12:15], s77 offen lds
    buffer_load_dwordx4 v42, s[12:15], s77 offen offset:1024 lds
    s_waitcnt lgkmcnt(3)
    v_dot2c_f32_bf16 v38, s84, v144
    v_dot2c_f32_bf16 v40, v144, v144
    v_dot2c_f32_bf16 v39, s84, v145
    v_dot2c_f32_bf16 v41, v145, v145
    v_dot2c_f32_bf16 v38, s84, v146
    v_dot2c_f32_bf16 v40, v146, v146
    v_dot2c_f32_bf16 v39, s84, v147
    v_dot2c_f32_bf16 v41, v147, v147
    s_waitcnt lgkmcnt(2)
    v_dot2c_f32_bf16 v38, s84, v148
    v_dot2c_f32_bf16 v40, v148, v148
    v_dot2c_f32_bf16 v39, s84, v149
    v_dot2c_f32_bf16 v41, v149, v149
    v_dot2c_f32_bf16 v38, s84, v150
    v_dot2c_f32_bf16 v40, v150, v150
    v_dot2c_f32_bf16 v39, s84, v151
    v_dot2c_f32_bf16 v41, v151, v151
    s_waitcnt lgkmcnt(1)
    v_dot2c_f32_bf16 v38, s84, v152
    v_dot2c_f32_bf16 v40, v152, v152
    v_dot2c_f32_bf16 v39, s84, v153
    v_dot2c_f32_bf16 v41, v153, v153
    v_dot2c_f32_bf16 v38, s84, v154
    v_dot2c_f32_bf16 v40, v154, v154
    v_dot2c_f32_bf16 v39, s84, v155
    v_dot2c_f32_bf16 v41, v155, v155
    s_waitcnt lgkmcnt(0)
    v_dot2c_f32_bf16 v38, s84, v156
    v_dot2c_f32_bf16 v40, v156, v156
    v_dot2c_f32_bf16 v39, s84, v157
    v_dot2c_f32_bf16 v41, v157, v157
    v_dot2c_f32_bf16 v38, s84, v158
    v_dot2c_f32_bf16 v40, v158, v158
    v_dot2c_f32_bf16 v39, s84, v159
    v_dot2c_f32_bf16 v41, v159, v159
    s_waitcnt vmcnt(8) lgkmcnt(0)
    s_barrier
    v_add_u32 v28, 0xffff4000, v28
    v_add_u32 v29, 0xffff4000, v29
    v_add_u32 v30, 0xffff4000, v30
    v_add_u32 v31, 0xffff4000, v31
    ds_read_b128 v[160:163], v28 offset:0
    ds_read_b128 v[164:167], v29 offset:0
    ds_read_b128 v[168:171], v30 offset:0
    s_add_u32 m0, s87, 114688
    ds_read_b128 v[172:175], v31 offset:0
    buffer_load_dwordx4 v3, s[8:11], s71 offen lds
    buffer_load_dwordx4 v4, s[8:11], s71 offen offset:1024 lds
    s_add_u32 m0, s86, 40960
    s_nop 0
    buffer_load_dwordx4 v5, s[12:15], s78 offen lds
    buffer_load_dwordx4 v42, s[12:15], s78 offen offset:1024 lds
    s_waitcnt lgkmcnt(3)
    v_dot2c_f32_bf16 v38, s84, v160
    v_dot2c_f32_bf16 v40, v160, v160
    v_dot2c_f32_bf16 v39, s84, v161
    v_dot2c_f32_bf16 v41, v161, v161
    v_dot2c_f32_bf16 v38, s84, v162
    v_dot2c_f32_bf16 v40, v162, v162
    v_dot2c_f32_bf16 v39, s84, v163
    v_dot2c_f32_bf16 v41, v163, v163
    s_waitcnt lgkmcnt(2)
    v_dot2c_f32_bf16 v38, s84, v164
    v_dot2c_f32_bf16 v40, v164, v164
    v_dot2c_f32_bf16 v39, s84, v165
    v_dot2c_f32_bf16 v41, v165, v165
    v_dot2c_f32_bf16 v38, s84, v166
    v_dot2c_f32_bf16 v40, v166, v166
    v_dot2c_f32_bf16 v39, s84, v167
    v_dot2c_f32_bf16 v41, v167, v167
    s_waitcnt lgkmcnt(1)
    v_dot2c_f32_bf16 v38, s84, v168
    v_dot2c_f32_bf16 v40, v168, v168
    v_dot2c_f32_bf16 v39, s84, v169
    v_dot2c_f32_bf16 v41, v169, v169
    v_dot2c_f32_bf16 v38, s84, v170
    v_dot2c_f32_bf16 v40, v170, v170
    v_dot2c_f32_bf16 v39, s84, v171
    v_dot2c_f32_bf16 v41, v171, v171
    s_waitcnt lgkmcnt(0)
    v_dot2c_f32_bf16 v38, s84, v172
    v_dot2c_f32_bf16 v40, v172, v172
    v_dot2c_f32_bf16 v39, s84, v173
    v_dot2c_f32_bf16 v41, v173, v173
    v_dot2c_f32_bf16 v38, s84, v174
    v_dot2c_f32_bf16 v40, v174, v174
    v_dot2c_f32_bf16 v39, s84, v175
    v_dot2c_f32_bf16 v41, v175, v175
    s_waitcnt vmcnt(8) lgkmcnt(0)
    s_barrier
    ds_read_b128 v[176:179], v28 offset:16384
    ds_read_b128 v[180:183], v29 offset:16384
    ds_read_b128 v[184:187], v30 offset:16384
    s_add_u32 m0, s87, 131072
    ds_read_b128 v[188:191], v31 offset:16384
    buffer_load_dwordx4 v3, s[8:11], s72 offen lds
    buffer_load_dwordx4 v4, s[8:11], s72 offen offset:1024 lds
    s_add_u32 m0, s86, 49152
    s_nop 0
    buffer_load_dwordx4 v5, s[12:15], s79 offen lds
    buffer_load_dwordx4 v42, s[12:15], s79 offen offset:1024 lds
    s_waitcnt lgkmcnt(3)
    v_dot2c_f32_bf16 v38, s84, v176
    v_dot2c_f32_bf16 v40, v176, v176
    v_dot2c_f32_bf16 v39, s84, v177
    v_dot2c_f32_bf16 v41, v177, v177
    v_dot2c_f32_bf16 v38, s84, v178
    v_dot2c_f32_bf16 v40, v178, v178
    v_dot2c_f32_bf16 v39, s84, v179
    v_dot2c_f32_bf16 v41, v179, v179
    s_waitcnt lgkmcnt(2)
    v_dot2c_f32_bf16 v38, s84, v180
    v_dot2c_f32_bf16 v40, v180, v180
    v_dot2c_f32_bf16 v39, s84, v181
    v_dot2c_f32_bf16 v41, v181, v181
    v_dot2c_f32_bf16 v38, s84, v182
    v_dot2c_f32_bf16 v40, v182, v182
    v_dot2c_f32_bf16 v39, s84, v183
    v_dot2c_f32_bf16 v41, v183, v183
    s_waitcnt lgkmcnt(1)
    v_dot2c_f32_bf16 v38, s84, v184
    v_dot2c_f32_bf16 v40, v184, v184
    v_dot2c_f32_bf16 v39, s84, v185
    v_dot2c_f32_bf16 v41, v185, v185
    v_dot2c_f32_bf16 v38, s84, v186
    v_dot2c_f32_bf16 v40, v186, v186
    v_dot2c_f32_bf16 v39, s84, v187
    v_dot2c_f32_bf16 v41, v187, v187
    s_waitcnt lgkmcnt(0)
    v_dot2c_f32_bf16 v38, s84, v188
    v_dot2c_f32_bf16 v40, v188, v188
    v_dot2c_f32_bf16 v39, s84, v189
    v_dot2c_f32_bf16 v41, v189, v189
    v_dot2c_f32_bf16 v38, s84, v190
    v_dot2c_f32_bf16 v40, v190, v190
    v_dot2c_f32_bf16 v39, s84, v191
    v_dot2c_f32_bf16 v41, v191, v191
    s_waitcnt vmcnt(8) lgkmcnt(0)
    s_barrier
    ds_read_b128 v[192:195], v28 offset:32768
    ds_read_b128 v[196:199], v29 offset:32768
    ds_read_b128 v[200:203], v30 offset:32768
    ds_read_b128 v[204:207], v31 offset:32768
    v_add_u32 v5, 128, v5
    s_add_u32 m0, s86, 57344
    v_add_u32 v42, 128, v42
    buffer_load_dwordx4 v5, s[12:15], s73 offen lds
    buffer_load_dwordx4 v42, s[12:15], s73 offen offset:1024 lds
    s_and_b32 s95, s7, 3
    s_lshl2_add_u32 s95, s6, s95
    s_lshl3_add_u32 s95, s95, s3
    s_mul_i32 s95, s95, 3584
    s_mul_i32 s88, s81, 1792
    s_add_u32 s95, s95, s88
    v_min_u32 v50, 13, v48
    v_lshlrev_b32 v50, 7, v50
    buffer_load_dword v127, v50, s[12:15], s95 offen
    ds_read_b64_tr_b16 v[240:241], v20 offset:0
    ds_read_b64_tr_b16 v[242:243], v20 offset:512
    ds_read_b64_tr_b16 v[244:245], v21 offset:0
    ds_read_b64_tr_b16 v[246:247], v21 offset:512
    ds_read_b64_tr_b16 v[248:249], v22 offset:0
    ds_read_b64_tr_b16 v[250:251], v22 offset:512
    ds_read_b64_tr_b16 v[252:253], v23 offset:0
    ds_read_b64_tr_b16 v[254:255], v23 offset:512
    s_waitcnt lgkmcnt(11)
    v_dot2c_f32_bf16 v38, s84, v192
    v_dot2c_f32_bf16 v40, v192, v192
    v_dot2c_f32_bf16 v39, s84, v193
    v_dot2c_f32_bf16 v41, v193, v193
    v_dot2c_f32_bf16 v38, s84, v194
    v_dot2c_f32_bf16 v40, v194, v194
    v_dot2c_f32_bf16 v39, s84, v195
    v_dot2c_f32_bf16 v41, v195, v195
    s_waitcnt lgkmcnt(10)
    v_dot2c_f32_bf16 v38, s84, v196
    v_dot2c_f32_bf16 v40, v196, v196
    v_dot2c_f32_bf16 v39, s84, v197
    v_dot2c_f32_bf16 v41, v197, v197
    v_dot2c_f32_bf16 v38, s84, v198
    v_dot2c_f32_bf16 v40, v198, v198
    v_dot2c_f32_bf16 v39, s84, v199
    v_dot2c_f32_bf16 v41, v199, v199
    s_waitcnt lgkmcnt(9)
    v_dot2c_f32_bf16 v38, s84, v200
    v_dot2c_f32_bf16 v40, v200, v200
    v_dot2c_f32_bf16 v39, s84, v201
    v_dot2c_f32_bf16 v41, v201, v201
    v_dot2c_f32_bf16 v38, s84, v202
    v_dot2c_f32_bf16 v40, v202, v202
    v_dot2c_f32_bf16 v39, s84, v203
    v_dot2c_f32_bf16 v41, v203, v203
    s_waitcnt lgkmcnt(8)
    v_dot2c_f32_bf16 v38, s84, v204
    v_dot2c_f32_bf16 v40, v204, v204
    v_dot2c_f32_bf16 v39, s84, v205
    v_dot2c_f32_bf16 v41, v205, v205
    v_dot2c_f32_bf16 v38, s84, v206
    v_dot2c_f32_bf16 v40, v206, v206
    v_dot2c_f32_bf16 v39, s84, v207
    v_dot2c_f32_bf16 v41, v207, v207
    s_waitcnt vmcnt(7) lgkmcnt(0)
    s_barrier
    ds_read_b128 v[208:211], v28 offset:49152
    ds_read_b128 v[212:215], v29 offset:49152
    ds_read_b128 v[216:219], v30 offset:49152
    s_add_u32 m0, s86, 65536
    ds_read_b128 v[220:223], v31 offset:49152
    buffer_load_dwordx4 v5, s[12:15], s74 offen lds
    buffer_load_dwordx4 v42, s[12:15], s74 offen offset:1024 lds
    v_add_u32 v3, 6144, v2
    s_waitcnt lgkmcnt(3)
    v_dot2c_f32_bf16 v38, s84, v208
    v_dot2c_f32_bf16 v40, v208, v208
    v_dot2c_f32_bf16 v39, s84, v209
    v_dot2c_f32_bf16 v41, v209, v209
    v_dot2c_f32_bf16 v38, s84, v210
    v_dot2c_f32_bf16 v40, v210, v210
    v_dot2c_f32_bf16 v39, s84, v211
    v_dot2c_f32_bf16 v41, v211, v211
    s_waitcnt lgkmcnt(2)
    v_dot2c_f32_bf16 v38, s84, v212
    v_dot2c_f32_bf16 v40, v212, v212
    v_dot2c_f32_bf16 v39, s84, v213
    v_dot2c_f32_bf16 v41, v213, v213
    v_dot2c_f32_bf16 v38, s84, v214
    v_dot2c_f32_bf16 v40, v214, v214
    v_dot2c_f32_bf16 v39, s84, v215
    v_dot2c_f32_bf16 v41, v215, v215
    s_waitcnt lgkmcnt(1)
    v_dot2c_f32_bf16 v38, s84, v216
    v_dot2c_f32_bf16 v40, v216, v216
    v_dot2c_f32_bf16 v39, s84, v217
    v_dot2c_f32_bf16 v41, v217, v217
    v_dot2c_f32_bf16 v38, s84, v218
    v_dot2c_f32_bf16 v40, v218, v218
    v_dot2c_f32_bf16 v39, s84, v219
    v_dot2c_f32_bf16 v41, v219, v219
    s_waitcnt lgkmcnt(0)
    v_dot2c_f32_bf16 v38, s84, v220
    v_dot2c_f32_bf16 v40, v220, v220
    v_dot2c_f32_bf16 v39, s84, v221
    v_dot2c_f32_bf16 v41, v221, v221
    v_dot2c_f32_bf16 v38, s84, v222
    v_dot2c_f32_bf16 v40, v222, v222
    v_dot2c_f32_bf16 v39, s84, v223
    v_dot2c_f32_bf16 v41, v223, v223
    s_waitcnt vmcnt(5) lgkmcnt(0)
    s_barrier
    v_add_u32 v28, 0x10000, v28
    v_add_u32 v29, 0x10000, v29
    v_add_u32 v30, 0x10000, v30
    v_add_u32 v31, 0x10000, v31
    ds_read_b128 v[224:227], v28 offset:0
    ds_read_b128 v[228:231], v29 offset:0
    ds_read_b128 v[232:235], v30 offset:0
    ds_read_b128 v[236:239], v31 offset:0
    s_waitcnt lgkmcnt(3)
    v_dot2c_f32_bf16 v38, s84, v224
    v_dot2c_f32_bf16 v40, v224, v224
    v_dot2c_f32_bf16 v39, s84, v225
    v_dot2c_f32_bf16 v41, v225, v225
    v_dot2c_f32_bf16 v38, s84, v226
    v_dot2c_f32_bf16 v40, v226, v226
    v_dot2c_f32_bf16 v39, s84, v227
    v_dot2c_f32_bf16 v41, v227, v227
    s_waitcnt lgkmcnt(2)
    v_dot2c_f32_bf16 v38, s84, v228
    v_dot2c_f32_bf16 v40, v228, v228
    v_dot2c_f32_bf16 v39, s84, v229
    v_dot2c_f32_bf16 v41, v229, v229
    v_dot2c_f32_bf16 v38, s84, v230
    v_dot2c_f32_bf16 v40, v230, v230
    v_dot2c_f32_bf16 v39, s84, v231
    v_dot2c_f32_bf16 v41, v231, v231
    s_waitcnt lgkmcnt(1)
    v_dot2c_f32_bf16 v38, s84, v232
    v_dot2c_f32_bf16 v40, v232, v232
    v_dot2c_f32_bf16 v39, s84, v233
    v_dot2c_f32_bf16 v41, v233, v233
    v_dot2c_f32_bf16 v38, s84, v234
    v_dot2c_f32_bf16 v40, v234, v234
    v_dot2c_f32_bf16 v39, s84, v235
    v_dot2c_f32_bf16 v41, v235, v235
    s_waitcnt lgkmcnt(0)
    v_dot2c_f32_bf16 v38, s84, v236
    v_dot2c_f32_bf16 v40, v236, v236
    v_dot2c_f32_bf16 v39, s84, v237
    v_dot2c_f32_bf16 v41, v237, v237
    v_dot2c_f32_bf16 v38, s84, v238
    v_dot2c_f32_bf16 v40, v238, v238
    v_dot2c_f32_bf16 v39, s84, v239
    v_dot2c_f32_bf16 v41, v239, v239
    s_barrier
    s_nop 0
    v_add_f32 v48, v38, v39
    v_add_f32 v50, v38, v39
    v_add_f32 v49, v40, v41
    v_add_f32 v51, v40, v41
    v_permlane32_swap_b32 v48, v50
    s_nop 0
    v_permlane32_swap_b32 v49, v51
    v_add_f32 v48, v48, v50
    v_add_f32 v49, v49, v51
    v_mul_f32 v48, 0x3b124925, v48
    v_mul_f32 v49, 0x3b124925, v49
    v_fma_f32 v49, -v48, v48, v49
    v_max_f32 v49, 0, v49
    v_cvt_pk_bf16_f32 v49, v49, v49
    v_lshlrev_b32 v49, 16, v49
    v_add_f32 v49, 0x3727c5ac, v49
    v_cvt_pk_bf16_f32 v49, v49, v49
    v_lshlrev_b32 v49, 16, v49
    v_sqrt_f32 v49, v49
    s_nop 0
    v_cvt_pk_bf16_f32 v48, -v48, v49
    s_add_u32 m0, s86, 73728
    ds_write_b32 v36, v48
    buffer_load_dwordx4 v5, s[12:15], s75 offen lds
    buffer_load_dwordx4 v42, s[12:15], s75 offen offset:1024 lds
    v_and_b32 v40, 0xffff0000, v48
    v_rcp_f32 v41, v40
    v_cndmask_b32 v48, v48, 0, s[92:93]
    v_and_b32 v49, 0xffff, v48
    v_lshl_or_b32 v36, v48, 16, v49
    v_lshrrev_b32 v37, 16, v48
    v_mul_f32 v38, 0xc0135761, v41
    v_mul_f32 v48, v41, v41
    v_mul_f32 v39, 0xbdd2d3e8, v41
    v_mul_f32 v39, v48, v39
    s_waitcnt vmcnt(5) lgkmcnt(0)
    s_barrier
    s_setprio 1
    v_mfma_f32_32x32x16_bf16 v[64:79], v[240:243], v[128:131], 0
    v_mfma_f32_16x16x32_bf16 v[12:15], v[8:11], v[240:243], 0
    ds_read_b64_tr_b16 v[240:241], v20 offset:8192
    ds_read_b64_tr_b16 v[242:243], v20 offset:8704
    v_mfma_f32_32x32x16_bf16 v[64:79], v[244:247], v[132:135], v[64:79]
    ds_read_b64_tr_b16 v[244:245], v21 offset:8192
    s_add_u32 m0, s86, 90112
    ds_read_b64_tr_b16 v[246:247], v21 offset:8704
    buffer_load_dwordx4 v5, s[12:15], s77 offen lds
    v_mfma_f32_32x32x16_bf16 v[64:79], v[248:251], v[136:139], v[64:79]
    ds_read_b64_tr_b16 v[248:249], v22 offset:8192
    ds_read_b64_tr_b16 v[250:251], v22 offset:8704
    v_mfma_f32_32x32x16_bf16 v[64:79], v[252:255], v[140:143], v[64:79]
    ds_read_b64_tr_b16 v[252:253], v23 offset:8192
    ds_read_b64_tr_b16 v[254:255], v23 offset:8704
    s_waitcnt lgkmcnt(4)
    v_mfma_f32_32x32x16_bf16 v[64:79], v[240:243], v[144:147], v[64:79]
    v_mfma_f32_16x16x32_bf16 v[12:15], v[8:11], v[240:243], v[12:15]
    ds_read_b64_tr_b16 v[240:241], v20 offset:16384
    ds_read_b64_tr_b16 v[242:243], v20 offset:16896
    buffer_load_dwordx4 v42, s[12:15], s77 offen offset:1024 lds
    v_mfma_f32_32x32x16_bf16 v[64:79], v[244:247], v[148:151], v[64:79]
    ds_read_b64_tr_b16 v[244:245], v21 offset:16384
    ds_read_b64_tr_b16 v[246:247], v21 offset:16896
    s_waitcnt lgkmcnt(4)
    v_mfma_f32_32x32x16_bf16 v[64:79], v[248:251], v[152:155], v[64:79]
    ds_read_b64_tr_b16 v[248:249], v22 offset:16384
    ds_read_b64_tr_b16 v[250:251], v22 offset:16896
    v_mfma_f32_32x32x16_bf16 v[64:79], v[252:255], v[156:159], v[64:79]
    ds_read_b64_tr_b16 v[252:253], v23 offset:16384
    s_add_u32 m0, s86, 98304
    ds_read_b64_tr_b16 v[254:255], v23 offset:16896
    buffer_load_dwordx4 v5, s[12:15], s78 offen lds
    s_waitcnt lgkmcnt(4)
    v_mfma_f32_32x32x16_bf16 v[64:79], v[240:243], v[160:163], v[64:79]
    v_mfma_f32_16x16x32_bf16 v[12:15], v[8:11], v[240:243], v[12:15]
    ds_read_b64_tr_b16 v[240:241], v20 offset:24576
    ds_read_b64_tr_b16 v[242:243], v20 offset:25088
    v_mfma_f32_32x32x16_bf16 v[64:79], v[244:247], v[164:167], v[64:79]
    ds_read_b64_tr_b16 v[244:245], v21 offset:24576
    ds_read_b64_tr_b16 v[246:247], v21 offset:25088
    s_waitcnt lgkmcnt(4)
    v_mfma_f32_32x32x16_bf16 v[64:79], v[248:251], v[168:171], v[64:79]
    ds_read_b64_tr_b16 v[248:249], v22 offset:24576
    ds_read_b64_tr_b16 v[250:251], v22 offset:25088
    buffer_load_dwordx4 v42, s[12:15], s78 offen offset:1024 lds
    v_mfma_f32_32x32x16_bf16 v[64:79], v[252:255], v[172:175], v[64:79]
    ds_read_b64_tr_b16 v[252:253], v23 offset:24576
    ds_read_b64_tr_b16 v[254:255], v23 offset:25088
    s_waitcnt lgkmcnt(4)
    v_mfma_f32_32x32x16_bf16 v[64:79], v[240:243], v[176:179], v[64:79]
    v_mfma_f32_16x16x32_bf16 v[12:15], v[8:11], v[240:243], v[12:15]
    ds_read_b64_tr_b16 v[240:241], v20 offset:32768
    ds_read_b64_tr_b16 v[242:243], v20 offset:33280
    v_mfma_f32_32x32x16_bf16 v[64:79], v[244:247], v[180:183], v[64:79]
    ds_read_b64_tr_b16 v[244:245], v21 offset:32768
    s_add_u32 m0, s86, 106496
    ds_read_b64_tr_b16 v[246:247], v21 offset:33280
    buffer_load_dwordx4 v5, s[12:15], s79 offen lds
    s_waitcnt lgkmcnt(4)
    v_mfma_f32_32x32x16_bf16 v[64:79], v[248:251], v[184:187], v[64:79]
    ds_read_b64_tr_b16 v[248:249], v22 offset:32768
    ds_read_b64_tr_b16 v[250:251], v22 offset:33280
    v_mfma_f32_32x32x16_bf16 v[64:79], v[252:255], v[188:191], v[64:79]
    ds_read_b64_tr_b16 v[252:253], v23 offset:32768
    ds_read_b64_tr_b16 v[254:255], v23 offset:33280
    s_waitcnt lgkmcnt(4)
    v_mfma_f32_32x32x16_bf16 v[64:79], v[240:243], v[192:195], v[64:79]
    v_mfma_f32_16x16x32_bf16 v[12:15], v[8:11], v[240:243], v[12:15]
    ds_read_b64_tr_b16 v[240:241], v20 offset:40960
    ds_read_b64_tr_b16 v[242:243], v20 offset:41472
    buffer_load_dwordx4 v42, s[12:15], s79 offen offset:1024 lds
    v_mfma_f32_32x32x16_bf16 v[64:79], v[244:247], v[196:199], v[64:79]
    ds_read_b64_tr_b16 v[244:245], v21 offset:40960
    ds_read_b64_tr_b16 v[246:247], v21 offset:41472
    s_waitcnt lgkmcnt(4)
    v_mfma_f32_32x32x16_bf16 v[64:79], v[248:251], v[200:203], v[64:79]
    ds_read_b64_tr_b16 v[248:249], v22 offset:40960
    ds_read_b64_tr_b16 v[250:251], v22 offset:41472
    v_mfma_f32_32x32x16_bf16 v[64:79], v[252:255], v[204:207], v[64:79]
    ds_read_b64_tr_b16 v[252:253], v23 offset:40960
    ds_read_b64_tr_b16 v[254:255], v23 offset:41472
    v_lshrrev_b32 v116, 3, v0
    v_and_b32 v117, 0x70, v1
    v_mul_u32_u24 v116, 896, v116
    s_lshl_b32 s95, s7, 7
    v_add_u32 v116, v116, v117
    buffer_load_dwordx4 v[108:111], v116, s[8:11], s63 offen
    s_waitcnt lgkmcnt(4)
    v_mfma_f32_32x32x16_bf16 v[64:79], v[240:243], v[208:211], v[64:79]
    v_mfma_f32_16x16x32_bf16 v[12:15], v[8:11], v[240:243], v[12:15]
    ds_read_b64_tr_b16 v[240:241], v20 offset:49152
    ds_read_b64_tr_b16 v[242:243], v20 offset:49664
    v_mfma_f32_32x32x16_bf16 v[64:79], v[244:247], v[212:215], v[64:79]
    ds_read_b64_tr_b16 v[244:245], v21 offset:49152
    ds_read_b64_tr_b16 v[246:247], v21 offset:49664
    s_waitcnt lgkmcnt(4)
    v_mfma_f32_32x32x16_bf16 v[64:79], v[248:251], v[216:219], v[64:79]
    ds_read_b64_tr_b16 v[248:249], v22 offset:49152
    ds_read_b64_tr_b16 v[250:251], v22 offset:49664
    buffer_load_dwordx4 v[112:115], v117, s[36:39], s95 offen
    v_mfma_f32_32x32x16_bf16 v[64:79], v[252:255], v[220:223], v[64:79]
    ds_read_b64_tr_b16 v[252:253], v23 offset:49152
    ds_read_b64_tr_b16 v[254:255], v23 offset:49664
    s_waitcnt lgkmcnt(4)
    v_mfma_f32_32x32x16_bf16 v[64:79], v[240:243], v[224:227], v[64:79]
    v_mfma_f32_16x16x32_bf16 v[12:15], v[8:11], v[240:243], v[12:15]
    v_mfma_f32_32x32x16_bf16 v[64:79], v[244:247], v[228:231], v[64:79]
    s_nop 6
    ds_write_b32 v6, v12
    s_waitcnt vmcnt(2) lgkmcnt(0)
    s_barrier
    s_setprio 2
    ds_read_b128 v[56:59], v7 offset:0
    v_mov_b32 v33, v16
    v_mfma_f32_32x32x16_bf16 v[64:79], v[248:251], v[232:235], v[64:79]
    v_mfma_f32_32x32x16_bf16 v[64:79], v[252:255], v[236:239], v[64:79]
    s_waitcnt lgkmcnt(0)
    v_add_f32 v56, v56, v57
    v_add_f32 v58, v58, v59
    v_add_f32 v56, v56, v58
    v_cvt_pk_bf16_f32 v57, v56, v56
    v_lshlrev_b32 v57, 16, v57
    v_sub_f32 v57, v56, v57
    v_cvt_pk_bf16_f32 v32, v56, v57
    s_nop 1
    v_mfma_f32_32x32x8_bf16 v[64:79], v[32:33], v[36:37], v[64:79]
    s_setprio 0
    v_add_u32 v5, 128, v5
    s_add_u32 m0, s86, 0
    v_add_u32 v42, 128, v42
    buffer_load_dwordx4 v5, s[12:15], s73 offen lds
    buffer_load_dwordx4 v42, s[12:15], s73 offen offset:1024 lds
    s_nop 5
    v_mul_f32 v48, v64, v64
    v_mul_f32 v49, v65, v65
    v_mul_f32 v50, v66, v66
    v_mul_f32 v51, v67, v67
    v_fma_f32 v48, v48, v39, v38
    v_fma_f32 v49, v49, v39, v38
    v_fma_f32 v50, v50, v39, v38
    v_fma_f32 v51, v51, v39, v38
    v_mul_f32 v48, v64, v48
    v_mul_f32 v49, v65, v49
    v_mul_f32 v50, v66, v50
    v_mul_f32 v51, v67, v51
    v_exp_f32 v48, v48
    v_exp_f32 v49, v49
    v_exp_f32 v50, v50
    v_exp_f32 v51, v51
    v_fma_f32 v48, v48, v40, v40
    v_fma_f32 v49, v49, v40, v40
    v_fma_f32 v50, v50, v40, v40
    v_fma_f32 v51, v51, v40, v40
    v_rcp_f32 v48, v48
    v_rcp_f32 v49, v49
    v_rcp_f32 v50, v50
    v_rcp_f32 v51, v51
    v_mul_f32 v64, v64, v48
    v_mul_f32 v65, v65, v49
    v_mul_f32 v66, v66, v50
    v_mul_f32 v67, v67, v51
    v_cvt_pk_bf16_f32 v64, v64, v65
    v_cvt_pk_bf16_f32 v65, v66, v67
    v_mul_f32 v48, v68, v68
    v_mul_f32 v49, v69, v69
    v_mul_f32 v50, v70, v70
    v_mul_f32 v51, v71, v71
    v_fma_f32 v48, v48, v39, v38
    v_fma_f32 v49, v49, v39, v38
    v_fma_f32 v50, v50, v39, v38
    v_fma_f32 v51, v51, v39, v38
    v_mul_f32 v48, v68, v48
    v_mul_f32 v49, v69, v49
    v_mul_f32 v50, v70, v50
    v_mul_f32 v51, v71, v51
    v_exp_f32 v48, v48
    v_exp_f32 v49, v49
    v_exp_f32 v50, v50
    v_exp_f32 v51, v51
    v_fma_f32 v48, v48, v40, v40
    v_fma_f32 v49, v49, v40, v40
    v_fma_f32 v50, v50, v40, v40
    v_fma_f32 v51, v51, v40, v40
    v_rcp_f32 v48, v48
    v_rcp_f32 v49, v49
    v_rcp_f32 v50, v50
    v_rcp_f32 v51, v51
    v_mul_f32 v68, v68, v48
    ds_read_b64_tr_b16 v[240:241], v20 offset:57344
    v_mul_f32 v69, v69, v49
    v_mul_f32 v70, v70, v50
    v_mul_f32 v71, v71, v51
    v_cvt_pk_bf16_f32 v66, v68, v69
    v_cvt_pk_bf16_f32 v67, v70, v71
    buffer_store_dwordx4 v[64:67], v1, s[16:19], s90 offen offset:0 sc1
    ds_read_b64_tr_b16 v[242:243], v20 offset:57856
    v_mul_f32 v48, v72, v72
    v_mul_f32 v49, v73, v73
    v_mul_f32 v50, v74, v74
    v_mul_f32 v51, v75, v75
    v_fma_f32 v48, v48, v39, v38
    ds_read_b64_tr_b16 v[244:245], v21 offset:57344
    v_fma_f32 v49, v49, v39, v38
    v_fma_f32 v50, v50, v39, v38
    v_fma_f32 v51, v51, v39, v38
    v_mul_f32 v48, v72, v48
    v_mul_f32 v49, v73, v49
    ds_read_b64_tr_b16 v[246:247], v21 offset:57856
    v_mul_f32 v50, v74, v50
    v_mul_f32 v51, v75, v51
    v_exp_f32 v48, v48
    v_exp_f32 v49, v49
    v_exp_f32 v50, v50
    v_exp_f32 v51, v51
    ds_read_b64_tr_b16 v[248:249], v22 offset:57344
    v_fma_f32 v48, v48, v40, v40
    v_fma_f32 v49, v49, v40, v40
    v_fma_f32 v50, v50, v40, v40
    v_fma_f32 v51, v51, v40, v40
    v_rcp_f32 v48, v48
    ds_read_b64_tr_b16 v[250:251], v22 offset:57856
    v_rcp_f32 v49, v49
    v_rcp_f32 v50, v50
    v_rcp_f32 v51, v51
    v_mul_f32 v72, v72, v48
    v_mul_f32 v73, v73, v49
    ds_read_b64_tr_b16 v[252:253], v23 offset:57344
    v_mul_f32 v74, v74, v50
    v_mul_f32 v75, v75, v51
    v_cvt_pk_bf16_f32 v72, v72, v73
    v_cvt_pk_bf16_f32 v73, v74, v75
    v_mul_f32 v48, v76, v76
    v_mul_f32 v49, v77, v77
    ds_read_b64_tr_b16 v[254:255], v23 offset:57856
    v_mul_f32 v50, v78, v78
    v_mul_f32 v51, v79, v79
    v_fma_f32 v48, v48, v39, v38
    v_fma_f32 v49, v49, v39, v38
    v_fma_f32 v50, v50, v39, v38
    v_fma_f32 v51, v51, v39, v38
    v_mul_f32 v48, v76, v48
    v_mul_f32 v49, v77, v49
    v_mul_f32 v50, v78, v50
    v_mul_f32 v51, v79, v51
    v_exp_f32 v48, v48
    v_exp_f32 v49, v49
    v_exp_f32 v50, v50
    v_exp_f32 v51, v51
    v_fma_f32 v48, v48, v40, v40
    v_fma_f32 v49, v49, v40, v40
    v_fma_f32 v50, v50, v40, v40
    v_fma_f32 v51, v51, v40, v40
    v_rcp_f32 v48, v48
    v_rcp_f32 v49, v49
    v_rcp_f32 v50, v50
    v_rcp_f32 v51, v51
    v_mul_f32 v76, v76, v48
    v_mul_f32 v77, v77, v49
    v_mul_f32 v78, v78, v50
    v_mul_f32 v79, v79, v51
    v_cvt_pk_bf16_f32 v74, v76, v77
    v_cvt_pk_bf16_f32 v75, v78, v79
    buffer_store_dwordx4 v[72:75], v1, s[16:19], s90 offen offset:1024 sc1
    s_add_u32 s90, s90, 4096
    s_waitcnt vmcnt(2) lgkmcnt(0)
    s_barrier
    s_setprio 1
    v_mfma_f32_32x32x16_bf16 v[64:79], v[240:243], v[128:131], 0
    v_mfma_f32_16x16x32_bf16 v[12:15], v[8:11], v[240:243], 0
    v_add_u32 v20, 0x10000, v20
    v_add_u32 v21, 0x10000, v21
    v_add_u32 v22, 0x10000, v22
    v_add_u32 v23, 0x10000, v23
    ds_read_b64_tr_b16 v[240:241], v20 offset:0
    ds_read_b64_tr_b16 v[242:243], v20 offset:512
    v_mfma_f32_32x32x16_bf16 v[64:79], v[244:247], v[132:135], v[64:79]
    ds_read_b64_tr_b16 v[244:245], v21 offset:0
    s_add_u32 m0, s86, 40960
    ds_read_b64_tr_b16 v[246:247], v21 offset:512
    buffer_load_dwordx4 v5, s[12:15], s78 offen lds
    v_mfma_f32_32x32x16_bf16 v[64:79], v[248:251], v[136:139], v[64:79]
    ds_read_b64_tr_b16 v[248:249], v22 offset:0
    ds_read_b64_tr_b16 v[250:251], v22 offset:512
    v_mfma_f32_32x32x16_bf16 v[64:79], v[252:255], v[140:143], v[64:79]
    ds_read_b64_tr_b16 v[252:253], v23 offset:0
    ds_read_b64_tr_b16 v[254:255], v23 offset:512
    s_waitcnt lgkmcnt(4)
    v_mfma_f32_32x32x16_bf16 v[64:79], v[240:243], v[144:147], v[64:79]
    v_mfma_f32_16x16x32_bf16 v[12:15], v[8:11], v[240:243], v[12:15]
    ds_read_b64_tr_b16 v[240:241], v20 offset:8192
    ds_read_b64_tr_b16 v[242:243], v20 offset:8704
    buffer_load_dwordx4 v42, s[12:15], s78 offen offset:1024 lds
    v_mfma_f32_32x32x16_bf16 v[64:79], v[244:247], v[148:151], v[64:79]
    ds_read_b64_tr_b16 v[244:245], v21 offset:8192
    ds_read_b64_tr_b16 v[246:247], v21 offset:8704
    s_waitcnt lgkmcnt(4)
    v_mfma_f32_32x32x16_bf16 v[64:79], v[248:251], v[152:155], v[64:79]
    ds_read_b64_tr_b16 v[248:249], v22 offset:8192
    ds_read_b64_tr_b16 v[250:251], v22 offset:8704
    v_mfma_f32_32x32x16_bf16 v[64:79], v[252:255], v[156:159], v[64:79]
    ds_read_b64_tr_b16 v[252:253], v23 offset:8192
    s_add_u32 m0, s86, 49152
    ds_read_b64_tr_b16 v[254:255], v23 offset:8704
    buffer_load_dwordx4 v5, s[12:15], s79 offen lds
    s_waitcnt lgkmcnt(4)
    v_mfma_f32_32x32x16_bf16 v[64:79], v[240:243], v[160:163], v[64:79]
    v_mfma_f32_16x16x32_bf16 v[12:15], v[8:11], v[240:243], v[12:15]
    ds_read_b64_tr_b16 v[240:241], v20 offset:16384
    ds_read_b64_tr_b16 v[242:243], v20 offset:16896
    v_mfma_f32_32x32x16_bf16 v[64:79], v[244:247], v[164:167], v[64:79]
    ds_read_b64_tr_b16 v[244:245], v21 offset:16384
    ds_read_b64_tr_b16 v[246:247], v21 offset:16896
    s_waitcnt lgkmcnt(4)
    v_mfma_f32_32x32x16_bf16 v[64:79], v[248:251], v[168:171], v[64:79]
    ds_read_b64_tr_b16 v[248:249], v22 offset:16384
    ds_read_b64_tr_b16 v[250:251], v22 offset:16896
    buffer_load_dwordx4 v42, s[12:15], s79 offen offset:1024 lds
    v_mfma_f32_32x32x16_bf16 v[64:79], v[252:255], v[172:175], v[64:79]
    ds_read_b64_tr_b16 v[252:253], v23 offset:16384
    ds_read_b64_tr_b16 v[254:255], v23 offset:16896
    s_waitcnt lgkmcnt(4)
    v_mfma_f32_32x32x16_bf16 v[64:79], v[240:243], v[176:179], v[64:79]
    v_mfma_f32_16x16x32_bf16 v[12:15], v[8:11], v[240:243], v[12:15]
    ds_read_b64_tr_b16 v[240:241], v20 offset:24576
    ds_read_b64_tr_b16 v[242:243], v20 offset:25088
    v_mfma_f32_32x32x16_bf16 v[64:79], v[244:247], v[180:183], v[64:79]
    ds_read_b64_tr_b16 v[244:245], v21 offset:24576
    ds_read_b64_tr_b16 v[246:247], v21 offset:25088
    s_xor_b32 s88, s89, 0
    s_add_u32 m0, s60, 0
    s_mul_i32 s88, s88, 14336
    s_add_u32 s88, s88, s58
    buffer_load_dwordx4 v2, s[20:23], s88 offen lds
    s_waitcnt lgkmcnt(4)
    v_mfma_f32_32x32x16_bf16 v[64:79], v[248:251], v[184:187], v[64:79]
    ds_read_b64_tr_b16 v[248:249], v22 offset:24576
    ds_read_b64_tr_b16 v[250:251], v22 offset:25088
    v_mfma_f32_32x32x16_bf16 v[64:79], v[252:255], v[188:191], v[64:79]
    ds_read_b64_tr_b16 v[252:253], v23 offset:24576
    ds_read_b64_tr_b16 v[254:255], v23 offset:25088
    s_waitcnt lgkmcnt(4)
    v_mfma_f32_32x32x16_bf16 v[64:79], v[240:243], v[192:195], v[64:79]
    v_mfma_f32_16x16x32_bf16 v[12:15], v[8:11], v[240:243], v[12:15]
    ds_read_b64_tr_b16 v[240:241], v20 offset:32768
    ds_read_b64_tr_b16 v[242:243], v20 offset:33280
    buffer_load_dwordx4 v3, s[20:23], s88 offen offset:1024 lds
    v_mfma_f32_32x32x16_bf16 v[64:79], v[244:247], v[196:199], v[64:79]
    ds_read_b64_tr_b16 v[244:245], v21 offset:32768
    ds_read_b64_tr_b16 v[246:247], v21 offset:33280
    s_waitcnt lgkmcnt(4)
    v_mfma_f32_32x32x16_bf16 v[64:79], v[248:251], v[200:203], v[64:79]
    ds_read_b64_tr_b16 v[248:249], v22 offset:32768
    ds_read_b64_tr_b16 v[250:251], v22 offset:33280
    v_mfma_f32_32x32x16_bf16 v[64:79], v[252:255], v[204:207], v[64:79]
    ds_read_b64_tr_b16 v[252:253], v23 offset:32768
    ds_read_b64_tr_b16 v[254:255], v23 offset:33280
    s_xor_b32 s88, s89, 1
    s_add_u32 m0, s60, 2048
    s_mul_i32 s88, s88, 14336
    s_add_u32 s88, s88, s58
    buffer_load_dwordx4 v2, s[20:23], s88 offen lds
    s_waitcnt lgkmcnt(4)
    v_mfma_f32_32x32x16_bf16 v[64:79], v[240:243], v[208:211], v[64:79]
    v_mfma_f32_16x16x32_bf16 v[12:15], v[8:11], v[240:243], v[12:15]
    ds_read_b64_tr_b16 v[240:241], v20 offset:40960
    ds_read_b64_tr_b16 v[242:243], v20 offset:41472
    v_mfma_f32_32x32x16_bf16 v[64:79], v[244:247], v[212:215], v[64:79]
    ds_read_b64_tr_b16 v[244:245], v21 offset:40960
    ds_read_b64_tr_b16 v[246:247], v21 offset:41472
    s_waitcnt lgkmcnt(4)
    v_mfma_f32_32x32x16_bf16 v[64:79], v[248:251], v[216:219], v[64:79]
    ds_read_b64_tr_b16 v[248:249], v22 offset:40960
    ds_read_b64_tr_b16 v[250:251], v22 offset:41472
    buffer_load_dwordx4 v3, s[20:23], s88 offen offset:1024 lds
    v_mfma_f32_32x32x16_bf16 v[64:79], v[252:255], v[220:223], v[64:79]
    ds_read_b64_tr_b16 v[252:253], v23 offset:40960
    ds_read_b64_tr_b16 v[254:255], v23 offset:41472
    s_waitcnt lgkmcnt(4)
    v_mfma_f32_32x32x16_bf16 v[64:79], v[240:243], v[224:227], v[64:79]
    v_mfma_f32_16x16x32_bf16 v[12:15], v[8:11], v[240:243], v[12:15]
    v_mfma_f32_32x32x16_bf16 v[64:79], v[244:247], v[228:231], v[64:79]
    s_nop 6
    ds_write_b32 v6, v12
    s_waitcnt vmcnt(4) lgkmcnt(0)
    s_barrier
    s_setprio 2
    ds_read_b128 v[56:59], v7 offset:0
    v_mov_b32 v33, v17
    v_mfma_f32_32x32x16_bf16 v[64:79], v[248:251], v[232:235], v[64:79]
    v_mfma_f32_32x32x16_bf16 v[64:79], v[252:255], v[236:239], v[64:79]
    s_waitcnt lgkmcnt(0)
    v_add_f32 v56, v56, v57
    v_add_f32 v58, v58, v59
    v_add_f32 v56, v56, v58
    v_cvt_pk_bf16_f32 v57, v56, v56
    v_lshlrev_b32 v57, 16, v57
    v_sub_f32 v57, v56, v57
    v_cvt_pk_bf16_f32 v32, v56, v57
    s_nop 1
    v_mfma_f32_32x32x8_bf16 v[64:79], v[32:33], v[36:37], v[64:79]
    s_setprio 0
    s_lshr_b32 s86, s86, 1
    s_add_u32 m0, s86, 57344
    s_nop 0
    buffer_load_dwordx4 v125, s[12:15], s73 offen lds
    s_xor_b32 s88, s89, 2
    s_add_u32 m0, s60, 4096
    s_mul_i32 s88, s88, 14336
    s_add_u32 s88, s88, s58
    buffer_load_dwordx4 v2, s[20:23], s88 offen lds
    s_nop 1
    v_mul_f32 v48, v64, v64
    v_mul_f32 v49, v65, v65
    v_mul_f32 v50, v66, v66
    v_mul_f32 v51, v67, v67
    v_fma_f32 v48, v48, v39, v38
    v_fma_f32 v49, v49, v39, v38
    v_fma_f32 v50, v50, v39, v38
    v_fma_f32 v51, v51, v39, v38
    v_mul_f32 v48, v64, v48
    v_mul_f32 v49, v65, v49
    v_mul_f32 v50, v66, v50
    v_mul_f32 v51, v67, v51
    v_exp_f32 v48, v48
    v_exp_f32 v49, v49
    v_exp_f32 v50, v50
    v_exp_f32 v51, v51
    v_fma_f32 v48, v48, v40, v40
    v_fma_f32 v49, v49, v40, v40
    v_fma_f32 v50, v50, v40, v40
    v_fma_f32 v51, v51, v40, v40
    v_rcp_f32 v48, v48
    v_rcp_f32 v49, v49
    v_rcp_f32 v50, v50
    v_rcp_f32 v51, v51
    v_mul_f32 v64, v64, v48
    buffer_load_dwordx4 v3, s[20:23], s88 offen offset:1024 lds
    v_mul_f32 v65, v65, v49
    v_mul_f32 v66, v66, v50
    v_mul_f32 v67, v67, v51
    v_cvt_pk_bf16_f32 v64, v64, v65
    v_cvt_pk_bf16_f32 v65, v66, v67
    v_mul_f32 v48, v68, v68
    v_mul_f32 v49, v69, v69
    v_mul_f32 v50, v70, v70
    v_mul_f32 v51, v71, v71
    v_fma_f32 v48, v48, v39, v38
    v_fma_f32 v49, v49, v39, v38
    v_fma_f32 v50, v50, v39, v38
    v_fma_f32 v51, v51, v39, v38
    v_mul_f32 v48, v68, v48
    v_mul_f32 v49, v69, v49
    v_mul_f32 v50, v70, v50
    v_mul_f32 v51, v71, v51
    v_exp_f32 v48, v48
    v_exp_f32 v49, v49
    v_exp_f32 v50, v50
    v_exp_f32 v51, v51
    v_fma_f32 v48, v48, v40, v40
    v_fma_f32 v49, v49, v40, v40
    v_fma_f32 v50, v50, v40, v40
    v_fma_f32 v51, v51, v40, v40
    v_rcp_f32 v48, v48
    v_rcp_f32 v49, v49
    v_rcp_f32 v50, v50
    v_rcp_f32 v51, v51
    v_mul_f32 v68, v68, v48
    v_add_u32 v20, 0xffff0000, v20
    v_mul_f32 v69, v69, v49
    v_mul_f32 v70, v70, v50
    v_mul_f32 v71, v71, v51
    v_add_u32 v21, 0xffff0000, v21
    v_cvt_pk_bf16_f32 v66, v68, v69
    v_cvt_pk_bf16_f32 v67, v70, v71
    buffer_store_dwordx4 v[64:67], v1, s[16:19], s90 offen offset:0 sc1
    v_mul_f32 v48, v72, v72
    v_add_u32 v22, 0xffff0000, v22
    v_mul_f32 v49, v73, v73
    v_mul_f32 v50, v74, v74
    v_mul_f32 v51, v75, v75
    v_fma_f32 v48, v48, v39, v38
    v_add_u32 v23, 0xffff0000, v23
    v_fma_f32 v49, v49, v39, v38
    v_fma_f32 v50, v50, v39, v38
    v_fma_f32 v51, v51, v39, v38
    ds_read_b64_tr_b16 v[240:241], v20 offset:0
    v_mul_f32 v48, v72, v48
    v_mul_f32 v49, v73, v49
    v_mul_f32 v50, v74, v50
    v_mul_f32 v51, v75, v51
    ds_read_b64_tr_b16 v[242:243], v20 offset:512
    v_exp_f32 v48, v48
    v_exp_f32 v49, v49
    v_exp_f32 v50, v50
    ds_read_b64_tr_b16 v[244:245], v21 offset:0
    v_exp_f32 v51, v51
    v_fma_f32 v48, v48, v40, v40
    v_fma_f32 v49, v49, v40, v40
    v_fma_f32 v50, v50, v40, v40
    ds_read_b64_tr_b16 v[246:247], v21 offset:512
    v_fma_f32 v51, v51, v40, v40
    v_rcp_f32 v48, v48
    v_rcp_f32 v49, v49
    v_rcp_f32 v50, v50
    ds_read_b64_tr_b16 v[248:249], v22 offset:0
    v_rcp_f32 v51, v51
    v_mul_f32 v72, v72, v48
    v_mul_f32 v73, v73, v49
    ds_read_b64_tr_b16 v[250:251], v22 offset:512
    v_mul_f32 v74, v74, v50
    v_mul_f32 v75, v75, v51
    v_cvt_pk_bf16_f32 v72, v72, v73
    v_cvt_pk_bf16_f32 v73, v74, v75
    ds_read_b64_tr_b16 v[252:253], v23 offset:0
    v_mul_f32 v48, v76, v76
    v_mul_f32 v49, v77, v77
    v_mul_f32 v50, v78, v78
    ds_read_b64_tr_b16 v[254:255], v23 offset:512
    v_mul_f32 v51, v79, v79
    v_fma_f32 v48, v48, v39, v38
    v_fma_f32 v49, v49, v39, v38
    v_fma_f32 v50, v50, v39, v38
    v_fma_f32 v51, v51, v39, v38
    v_mul_f32 v48, v76, v48
    v_mul_f32 v49, v77, v49
    v_mul_f32 v50, v78, v50
    v_mul_f32 v51, v79, v51
    v_exp_f32 v48, v48
    v_exp_f32 v49, v49
    v_exp_f32 v50, v50
    v_exp_f32 v51, v51
    v_fma_f32 v48, v48, v40, v40
    v_fma_f32 v49, v49, v40, v40
    v_fma_f32 v50, v50, v40, v40
    v_fma_f32 v51, v51, v40, v40
    v_rcp_f32 v48, v48
    v_rcp_f32 v49, v49
    v_rcp_f32 v50, v50
    v_rcp_f32 v51, v51
    v_mul_f32 v76, v76, v48
    v_mul_f32 v77, v77, v49
    v_mul_f32 v78, v78, v50
    v_mul_f32 v79, v79, v51
    v_cvt_pk_bf16_f32 v74, v76, v77
    v_cvt_pk_bf16_f32 v75, v78, v79
    buffer_store_dwordx4 v[72:75], v1, s[16:19], s90 offen offset:1024 sc1
    s_add_u32 s90, s90, 4096
    s_waitcnt vmcnt(4) lgkmcnt(0)
    s_barrier
    s_setprio 1
    v_mfma_f32_32x32x16_bf16 v[64:79], v[240:243], v[128:131], 0
    v_mfma_f32_16x16x32_bf16 v[12:15], v[8:11], v[240:243], 0
    ds_read_b64_tr_b16 v[240:241], v20 offset:8192
    ds_read_b64_tr_b16 v[242:243], v20 offset:8704
    v_mfma_f32_32x32x16_bf16 v[64:79], v[244:247], v[132:135], v[64:79]
    ds_read_b64_tr_b16 v[244:245], v21 offset:8192
    s_add_u32 m0, s86, 77824
    ds_read_b64_tr_b16 v[246:247], v21 offset:8704
    buffer_load_dwordx4 v125, s[12:15], s78 offen lds
    v_mfma_f32_32x32x16_bf16 v[64:79], v[248:251], v[136:139], v[64:79]
    ds_read_b64_tr_b16 v[248:249], v22 offset:8192
    ds_read_b64_tr_b16 v[250:251], v22 offset:8704
    v_mfma_f32_32x32x16_bf16 v[64:79], v[252:255], v[140:143], v[64:79]
    ds_read_b64_tr_b16 v[252:253], v23 offset:8192
    ds_read_b64_tr_b16 v[254:255], v23 offset:8704
    s_waitcnt lgkmcnt(4)
    v_mfma_f32_32x32x16_bf16 v[64:79], v[240:243], v[144:147], v[64:79]
    v_mfma_f32_16x16x32_bf16 v[12:15], v[8:11], v[240:243], v[12:15]
    ds_read_b64_tr_b16 v[240:241], v20 offset:16384
    s_add_u32 m0, s86, 81920
    ds_read_b64_tr_b16 v[242:243], v20 offset:16896
    buffer_load_dwordx4 v125, s[12:15], s79 offen lds
    v_mfma_f32_32x32x16_bf16 v[64:79], v[244:247], v[148:151], v[64:79]
    ds_read_b64_tr_b16 v[244:245], v21 offset:16384
    ds_read_b64_tr_b16 v[246:247], v21 offset:16896
    s_waitcnt lgkmcnt(4)
    v_mfma_f32_32x32x16_bf16 v[64:79], v[248:251], v[152:155], v[64:79]
    ds_read_b64_tr_b16 v[248:249], v22 offset:16384
    ds_read_b64_tr_b16 v[250:251], v22 offset:16896
    v_mfma_f32_32x32x16_bf16 v[64:79], v[252:255], v[156:159], v[64:79]
    ds_read_b64_tr_b16 v[252:253], v23 offset:16384
    ds_read_b64_tr_b16 v[254:255], v23 offset:16896
    s_lshr_b32 s73, s80, 1
    s_lshl2_add_u32 s73, s73, s4
    s_mul_i32 s73, s73, 896
    s_add_u32 s73, s73, 0x911000
    v_cmp_gt_u32 vcc, 32, v1
    v_lshlrev_b32 v31, 3, v1
    s_nop 0
    v_cndmask_b32 v31, v46, v31, vcc
    buffer_load_dword v44, v31, s[16:19], s73 offen offset:0 sc1
    s_waitcnt lgkmcnt(4)
    v_mfma_f32_32x32x16_bf16 v[64:79], v[240:243], v[160:163], v[64:79]
    v_mfma_f32_16x16x32_bf16 v[12:15], v[8:11], v[240:243], v[12:15]
    ds_read_b64_tr_b16 v[240:241], v20 offset:24576
    ds_read_b64_tr_b16 v[242:243], v20 offset:25088
    v_mfma_f32_32x32x16_bf16 v[64:79], v[244:247], v[164:167], v[64:79]
    ds_read_b64_tr_b16 v[244:245], v21 offset:24576
    ds_read_b64_tr_b16 v[246:247], v21 offset:25088
    s_waitcnt lgkmcnt(4)
    v_mfma_f32_32x32x16_bf16 v[64:79], v[248:251], v[168:171], v[64:79]
    ds_read_b64_tr_b16 v[248:249], v22 offset:24576
    ds_read_b64_tr_b16 v[250:251], v22 offset:25088
    s_xor_b32 s88, s89, 3
    s_add_u32 m0, s60, 6144
    s_mul_i32 s88, s88, 14336
    s_add_u32 s88, s88, s58
    buffer_load_dwordx4 v2, s[20:23], s88 offen lds
    v_mfma_f32_32x32x16_bf16 v[64:79], v[252:255], v[172:175], v[64:79]
    ds_read_b64_tr_b16 v[252:253], v23 offset:24576
    ds_read_b64_tr_b16 v[254:255], v23 offset:25088
    s_waitcnt lgkmcnt(4)
    v_mfma_f32_32x32x16_bf16 v[64:79], v[240:243], v[176:179], v[64:79]
    v_mfma_f32_16x16x32_bf16 v[12:15], v[8:11], v[240:243], v[12:15]
    ds_read_b64_tr_b16 v[240:241], v20 offset:32768
    ds_read_b64_tr_b16 v[242:243], v20 offset:33280
    v_mfma_f32_32x32x16_bf16 v[64:79], v[244:247], v[180:183], v[64:79]
    ds_read_b64_tr_b16 v[244:245], v21 offset:32768
    ds_read_b64_tr_b16 v[246:247], v21 offset:33280
    buffer_load_dwordx4 v3, s[20:23], s88 offen offset:1024 lds
    s_waitcnt lgkmcnt(4)
    v_mfma_f32_32x32x16_bf16 v[64:79], v[248:251], v[184:187], v[64:79]
    ds_read_b64_tr_b16 v[248:249], v22 offset:32768
    ds_read_b64_tr_b16 v[250:251], v22 offset:33280
    v_mfma_f32_32x32x16_bf16 v[64:79], v[252:255], v[188:191], v[64:79]
    ds_read_b64_tr_b16 v[252:253], v23 offset:32768
    ds_read_b64_tr_b16 v[254:255], v23 offset:33280
    s_waitcnt lgkmcnt(4)
    v_mfma_f32_32x32x16_bf16 v[64:79], v[240:243], v[192:195], v[64:79]
    v_mfma_f32_16x16x32_bf16 v[12:15], v[8:11], v[240:243], v[12:15]
    ds_read_b64_tr_b16 v[240:241], v20 offset:40960
    ds_read_b64_tr_b16 v[242:243], v20 offset:41472
    s_xor_b32 s88, s89, 16
    s_add_u32 m0, s60, 8192
    s_mul_i32 s88, s88, 14336
    s_add_u32 s88, s88, s58
    buffer_load_dwordx4 v2, s[20:23], s88 offen lds
    v_mfma_f32_32x32x16_bf16 v[64:79], v[244:247], v[196:199], v[64:79]
    ds_read_b64_tr_b16 v[244:245], v21 offset:40960
    ds_read_b64_tr_b16 v[246:247], v21 offset:41472
    s_waitcnt lgkmcnt(4)
    v_mfma_f32_32x32x16_bf16 v[64:79], v[248:251], v[200:203], v[64:79]
    ds_read_b64_tr_b16 v[248:249], v22 offset:40960
    ds_read_b64_tr_b16 v[250:251], v22 offset:41472
    v_mfma_f32_32x32x16_bf16 v[64:79], v[252:255], v[204:207], v[64:79]
    ds_read_b64_tr_b16 v[252:253], v23 offset:40960
    ds_read_b64_tr_b16 v[254:255], v23 offset:41472
    buffer_load_dwordx4 v3, s[20:23], s88 offen offset:1024 lds
    s_waitcnt lgkmcnt(4)
    v_mfma_f32_32x32x16_bf16 v[64:79], v[240:243], v[208:211], v[64:79]
    v_mfma_f32_16x16x32_bf16 v[12:15], v[8:11], v[240:243], v[12:15]
    ds_read_b64_tr_b16 v[240:241], v20 offset:49152
    ds_read_b64_tr_b16 v[242:243], v20 offset:49664
    v_mfma_f32_32x32x16_bf16 v[64:79], v[244:247], v[212:215], v[64:79]
    ds_read_b64_tr_b16 v[244:245], v21 offset:49152
    ds_read_b64_tr_b16 v[246:247], v21 offset:49664
    s_waitcnt lgkmcnt(4)
    v_mfma_f32_32x32x16_bf16 v[64:79], v[248:251], v[216:219], v[64:79]
    ds_read_b64_tr_b16 v[248:249], v22 offset:49152
    ds_read_b64_tr_b16 v[250:251], v22 offset:49664
    s_xor_b32 s88, s89, 18
    s_add_u32 m0, s100, 2048
    s_mul_i32 s88, s88, 14336
    s_add_u32 s88, s88, s58
    buffer_load_dwordx4 v2, s[20:23], s88 offen lds
    v_mfma_f32_32x32x16_bf16 v[64:79], v[252:255], v[220:223], v[64:79]
    ds_read_b64_tr_b16 v[252:253], v23 offset:49152
    ds_read_b64_tr_b16 v[254:255], v23 offset:49664
    s_waitcnt lgkmcnt(4)
    v_mfma_f32_32x32x16_bf16 v[64:79], v[240:243], v[224:227], v[64:79]
    v_mfma_f32_16x16x32_bf16 v[12:15], v[8:11], v[240:243], v[12:15]
    buffer_load_dwordx4 v3, s[20:23], s88 offen offset:1024 lds
    v_mfma_f32_32x32x16_bf16 v[64:79], v[244:247], v[228:231], v[64:79]
    s_nop 5
    ds_write_b32 v6, v12
    s_waitcnt vmcnt(7) lgkmcnt(0)
    s_barrier
    s_setprio 2
    ds_read_b128 v[56:59], v7 offset:0
    v_mov_b32 v33, v18
    v_mfma_f32_32x32x16_bf16 v[64:79], v[248:251], v[232:235], v[64:79]
    v_mfma_f32_32x32x16_bf16 v[64:79], v[252:255], v[236:239], v[64:79]
    s_waitcnt lgkmcnt(0)
    v_add_f32 v56, v56, v57
    v_add_f32 v58, v58, v59
    v_add_f32 v56, v56, v58
    v_cvt_pk_bf16_f32 v57, v56, v56
    v_lshlrev_b32 v57, 16, v57
    v_sub_f32 v57, v56, v57
    v_cvt_pk_bf16_f32 v32, v56, v57
    s_nop 1
    v_mfma_f32_32x32x8_bf16 v[64:79], v[32:33], v[36:37], v[64:79]
    s_setprio 0
    v_add_u32 v12, 147456, v1
    s_mul_i32 s82, s4, 7168
    s_add_u32 s96, s61, s82
    s_add_u32 s96, s96, 114688
    s_add_u32 s68, s96, 4096
    s_mul_i32 s82, s4, 28672
    s_add_u32 s61, s61, s82
    s_waitcnt vmcnt(6)
    v_cmp_ne_u32 vcc, 0, v44
    s_nop 0
    s_andn2_b32 s95, 3, vcc_lo
    s_cbranch_scc1 L_slow2
L_ret2:
    s_xor_b32 s82, s89, 0
    s_lshl_b32 s82, s82, 10
    s_add_u32 s82, s82, s61
    buffer_load_dwordx4 v[128:131], v1, s[16:19], s82 offen sc1
    buffer_load_dwordx4 v[132:135], v12, s[16:19], s82 offen sc1
    v_mul_f32 v48, v64, v64
    v_mul_f32 v49, v65, v65
    v_mul_f32 v50, v66, v66
    v_mul_f32 v51, v67, v67
    s_xor_b32 s82, s89, 1
    s_lshl_b32 s82, s82, 10
    s_add_u32 s82, s82, s61
    buffer_load_dwordx4 v[136:139], v1, s[16:19], s82 offen sc1
    v_fma_f32 v48, v48, v39, v38
    v_fma_f32 v49, v49, v39, v38
    v_fma_f32 v50, v50, v39, v38
    v_fma_f32 v51, v51, v39, v38
    v_mul_f32 v48, v64, v48
    v_mul_f32 v49, v65, v49
    v_mul_f32 v50, v66, v50
    v_mul_f32 v51, v67, v51
    v_exp_f32 v48, v48
    v_exp_f32 v49, v49
    v_exp_f32 v50, v50
    v_exp_f32 v51, v51
    v_fma_f32 v48, v48, v40, v40
    v_fma_f32 v49, v49, v40, v40
    v_fma_f32 v50, v50, v40, v40
    buffer_load_dwordx4 v[140:143], v12, s[16:19], s82 offen sc1
    v_fma_f32 v51, v51, v40, v40
    v_rcp_f32 v48, v48
    v_rcp_f32 v49, v49
    v_rcp_f32 v50, v50
    v_rcp_f32 v51, v51
    v_mul_f32 v64, v64, v48
    v_mul_f32 v65, v65, v49
    v_mul_f32 v66, v66, v50
    v_mul_f32 v67, v67, v51
    v_cvt_pk_bf16_f32 v64, v64, v65
    v_cvt_pk_bf16_f32 v65, v66, v67
    v_mul_f32 v48, v68, v68
    v_mul_f32 v49, v69, v69
    v_mul_f32 v50, v70, v70
    v_mul_f32 v51, v71, v71
    s_xor_b32 s82, s89, 2
    s_lshl_b32 s82, s82, 10
    s_add_u32 s82, s82, s61
    buffer_load_dwordx4 v[144:147], v1, s[16:19], s82 offen sc1
    v_fma_f32 v48, v48, v39, v38
    v_fma_f32 v49, v49, v39, v38
    v_fma_f32 v50, v50, v39, v38
    v_fma_f32 v51, v51, v39, v38
    v_mul_f32 v48, v68, v48
    v_mul_f32 v49, v69, v49
    v_mul_f32 v50, v70, v50
    v_mul_f32 v51, v71, v51
    v_exp_f32 v48, v48
    v_exp_f32 v49, v49
    v_exp_f32 v50, v50
    v_exp_f32 v51, v51
    v_fma_f32 v48, v48, v40, v40
    v_fma_f32 v49, v49, v40, v40
    v_fma_f32 v50, v50, v40, v40
    buffer_load_dwordx4 v[148:151], v12, s[16:19], s82 offen sc1
    v_fma_f32 v51, v51, v40, v40
    v_rcp_f32 v48, v48
    v_rcp_f32 v49, v49
    v_rcp_f32 v50, v50
    v_rcp_f32 v51, v51
    v_mul_f32 v68, v68, v48
    v_mul_f32 v69, v69, v49
    v_mul_f32 v70, v70, v50
    v_mul_f32 v71, v71, v51
    v_cvt_pk_bf16_f32 v66, v68, v69
    v_cvt_pk_bf16_f32 v67, v70, v71
    ds_write_b128 v43, v[64:67] offset:0
    v_mul_f32 v48, v72, v72
    v_mul_f32 v49, v73, v73
    s_xor_b32 s82, s89, 3
    s_lshl_b32 s82, s82, 10
    s_add_u32 s82, s82, s61
    buffer_load_dwordx4 v[152:155], v1, s[16:19], s82 offen sc1
    v_mul_f32 v50, v74, v74
    v_mul_f32 v51, v75, v75
    v_fma_f32 v48, v48, v39, v38
    v_fma_f32 v49, v49, v39, v38
    v_fma_f32 v50, v50, v39, v38
    v_fma_f32 v51, v51, v39, v38
    v_mul_f32 v48, v72, v48
    v_mul_f32 v49, v73, v49
    v_mul_f32 v50, v74, v50
    v_mul_f32 v51, v75, v51
    v_exp_f32 v48, v48
    v_exp_f32 v49, v49
    v_exp_f32 v50, v50
    v_exp_f32 v51, v51
    v_fma_f32 v48, v48, v40, v40
    buffer_load_dwordx4 v[156:159], v12, s[16:19], s82 offen sc1
    v_fma_f32 v49, v49, v40, v40
    v_fma_f32 v50, v50, v40, v40
    v_fma_f32 v51, v51, v40, v40
    v_rcp_f32 v48, v48
    v_rcp_f32 v49, v49
    v_rcp_f32 v50, v50
    v_rcp_f32 v51, v51
    v_mul_f32 v72, v72, v48
    v_mul_f32 v73, v73, v49
    v_mul_f32 v74, v74, v50
    v_mul_f32 v75, v75, v51
    v_cvt_pk_bf16_f32 v72, v72, v73
    v_cvt_pk_bf16_f32 v73, v74, v75
    v_mul_f32 v48, v76, v76
    v_mul_f32 v49, v77, v77
    s_xor_b32 s82, s89, 16
    s_lshl_b32 s82, s82, 10
    s_add_u32 s82, s82, s61
    buffer_load_dwordx4 v[160:163], v1, s[16:19], s82 offen sc1
    v_mul_f32 v50, v78, v78
    v_mul_f32 v51, v79, v79
    v_fma_f32 v48, v48, v39, v38
    v_fma_f32 v49, v49, v39, v38
    v_fma_f32 v50, v50, v39, v38
    v_fma_f32 v51, v51, v39, v38
    v_mul_f32 v48, v76, v48
    v_mul_f32 v49, v77, v49
    v_mul_f32 v50, v78, v50
    v_mul_f32 v51, v79, v51
    v_exp_f32 v48, v48
    v_exp_f32 v49, v49
    v_exp_f32 v50, v50
    v_exp_f32 v51, v51
    v_fma_f32 v48, v48, v40, v40
    buffer_load_dwordx4 v[164:167], v12, s[16:19], s82 offen sc1
    v_fma_f32 v49, v49, v40, v40
    v_fma_f32 v50, v50, v40, v40
    v_fma_f32 v51, v51, v40, v40
    v_rcp_f32 v48, v48
    v_rcp_f32 v49, v49
    v_rcp_f32 v50, v50
    v_rcp_f32 v51, v51
    v_mul_f32 v76, v76, v48
    v_mul_f32 v77, v77, v49
    v_mul_f32 v78, v78, v50
    v_mul_f32 v79, v79, v51
    v_cvt_pk_bf16_f32 v74, v76, v77
    v_cvt_pk_bf16_f32 v75, v78, v79
    ds_write_b128 v43, v[72:75] offset:1024
    s_add_u32 s90, s90, 4096
    s_waitcnt lgkmcnt(0)
    s_barrier
    s_branch L_p2f
L_kv:
    s_mul_i32 s96, s81, 3
    s_add_u32 s96, s96, s7
    s_sub_u32 s96, s96, 4
    s_lshl_b32 s83, s96, 2
    s_lshr_b32 s97, 0xdb8630, s83
    s_and_b32 s97, s97, 15
    s_lshr_b32 s98, 0x323233, s83
    s_and_b32 s98, s98, 15
    s_add_u32 s83, s97, s5
    s_mul_i32 s83, s83, 56
    s_lshl_b32 s82, s96, 7
    s_sub_u32 s83, s83, s82
    s_add_u32 s82, s5, 1
    s_cmp_lt_u32 s82, s98
    s_cselect_b32 s82, 56, 0
    v_cmp_eq_u32 vcc, 7, v62
    v_mov_b32 v53, 0x20000
    s_nop 0
    v_cndmask_b32 v62, v62, v53, vcc
    v_lshl_add_u32 v53, v62, 3, s83
    v_lshlrev_b32 v54, 6, v58
    v_xor_b32 v59, v53, v54
    v_lshl_add_u32 v20, v60, 8, v59
    v_xor_b32 v21, 4096, v20
    v_xor_b32 v22, 8192, v20
    v_xor_b32 v23, 12288, v20
    v_add_u32 v53, s82, v53
    v_xor_b32 v59, v53, v54
    v_lshl_add_u32 v24, v60, 8, v59
    v_xor_b32 v25, 4096, v24
    v_xor_b32 v26, 8192, v24
    v_xor_b32 v27, 12288, v24
    s_mov_b32 s18, 0x10000000
    s_mov_b32 s19, 0x20000
    s_mov_b32 s42, 0x100
    s_mov_b32 s43, 0x20000
    s_add_u32 m0, s87, 98304
    s_nop 0
    buffer_load_dwordx4 v3, s[8:11], s67 offen lds
    buffer_load_dwordx4 v4, s[8:11], s67 offen offset:1024 lds
    s_add_u32 m0, s87, 114688
    s_nop 0
    buffer_load_dwordx4 v5, s[12:15], s74 offen lds
    buffer_load_dwordx4 v42, s[12:15], s74 offen offset:1024 lds
    s_mov_b32 s22, 0x188000
    s_mov_b32 s23, 0x20000
    s_mov_b32 s26, 0x62000
    s_mov_b32 s27, 0x20000
    s_mov_b32 s30, 0x1c0000
    s_mov_b32 s31, 0x20000
    s_mov_b32 s38, 0x380
    s_mov_b32 s39, 0x20000
    s_mov_b32 s85, 0x358637bd
    s_mov_b32 s99, 0x3fb8aa3b
    s_mov_b32 s92, 0
    s_mov_b32 s93, -1
    s_mov_b32 s100, 0xf0000000
    s_mov_b32 s101, 0xf0000000
    v_mov_b32 v35, 0
    s_mov_b32 s94, 0
    v_and_b32 v52, 7, v52
    v_mul_u32_u24 v2, 896, v49
    v_lshl_add_u32 v2, v52, 4, v2
    s_mov_b32 s83, 159744
    v_lshl_add_u32 v7, v56, 4, s83
    v_lshl_add_u32 v6, s4, 2, v7
    s_lshl2_add_u32 s83, s3, 157696
    v_mov_b32 v45, s83
    ds_write_b32 v45, v33 offset:0
    ds_write_b32 v45, v33 offset:128
    ds_write_b32 v45, v33 offset:160
    ds_write_b32 v45, v33 offset:192
    ds_write_b32 v45, v33 offset:224
    s_and_b32 s83, s2, 7
    s_lshl2_add_u32 s80, s83, s80
    s_lshl1_add_u32 s83, s80, s7
    s_and_b32 s89, s83, 3
    s_and_b32 s83, s83, 4
    s_lshl2_add_u32 s89, s83, s89
    s_lshl_b32 s83, s7, 7
    s_mul_i32 s58, s4, 401408
    s_add_u32 s58, s58, s83
    s_lshr_b32 s62, s4, 1
    s_mul_i32 s62, s62, 6
    s_add_u32 s62, s62, s4
    s_mul_i32 s62, s62, 25088
    s_add_u32 s62, s62, s83
    s_mul_i32 s63, s80, 57344
    s_add_u32 s63, s63, s83
    s_mul_i32 s59, s4, 12288
    s_mul_i32 s60, s4, 10240
    s_add_u32 s60, s60, 114688
    s_mul_i32 s61, s80, 294912
    s_lshl1_add_u32 s90, s6, s81
    s_lshl3_add_u32 s90, s90, s4
    s_lshl_b32 s90, s90, 7
    s_add_u32 s90, s90, 0x938000
    v_lshlrev_b32 v39, 2, v56
    s_lshl_b32 s82, s4, 7
    s_add_u32 s82, s82, 162816
    v_lshl_add_u32 v43, v57, 4, s82
    v_add_u32 v40, s82, v39
    v_mov_b32 v53, 157824
    v_cndmask_b32 v41, v43, v53, s[100:101]
    v_mov_b32 v37, 0
    s_waitcnt lgkmcnt(0)
    s_lshl2_add_u32 s83, s5, s98
    s_cmp_eq_u32 s83, 6
    s_cbranch_scc1 L_kc
    s_cmp_eq_u32 s5, 1
    s_cbranch_scc1 L_kb
    s_setprio 1
    s_waitcnt vmcnt(4) lgkmcnt(0)
    s_barrier
    v_add_u32 v20, 0x14000, v20
    v_add_u32 v21, 0x14000, v21
    v_add_u32 v22, 0x14000, v22
    v_add_u32 v23, 0x14000, v23
    ds_read_b64_tr_b16 v[240:241], v20 offset:0
    ds_read_b64_tr_b16 v[242:243], v20 offset:1024
    v_add_u32 v28, 0x10000, v28
    v_add_u32 v29, 0x10000, v29
    v_add_u32 v30, 0x10000, v30
    v_add_u32 v31, 0x10000, v31
    ds_read_b128 v[128:131], v28 offset:0
    ds_read_b64_tr_b16 v[244:245], v21 offset:0
    ds_read_b64_tr_b16 v[246:247], v21 offset:1024
    ds_read_b128 v[132:135], v29 offset:0
    ds_read_b64_tr_b16 v[248:249], v22 offset:0
    ds_read_b64_tr_b16 v[250:251], v22 offset:1024
    ds_read_b128 v[136:139], v30 offset:0
    ds_read_b64_tr_b16 v[252:253], v23 offset:0
    ds_read_b64_tr_b16 v[254:255], v23 offset:1024
    s_add_u32 m0, s87, 131072
    ds_read_b128 v[140:143], v31 offset:0
    buffer_load_dwordx4 v3, s[8:11], s68 offen lds
    buffer_load_dwordx4 v4, s[8:11], s68 offen offset:1024 lds
    s_add_u32 m0, s87, 0
    s_nop 0
    buffer_load_dwordx4 v5, s[12:15], s75 offen lds
    buffer_load_dwordx4 v42, s[12:15], s75 offen offset:1024 lds
    s_waitcnt vmcnt(4) lgkmcnt(0)
    s_barrier
    s_add_u32 m0, s87, 16384
    s_nop 0
    buffer_load_dwordx4 v3, s[8:11], s69 offen lds
    buffer_load_dwordx4 v4, s[8:11], s69 offen offset:1024 lds
    s_add_u32 m0, s87, 32768
    s_nop 0
    buffer_load_dwordx4 v5, s[12:15], s76 offen lds
    buffer_load_dwordx4 v42, s[12:15], s76 offen offset:1024 lds
    v_mfma_f32_32x32x16_bf16 v[64:79], v[128:131], v[240:243], 0
    v_mfma_f32_16x16x32_bf16 v[12:15], v[8:11], v[240:243], 0
    ds_read_b64_tr_b16 v[240:241], v20 offset:32768
    ds_read_b64_tr_b16 v[242:243], v20 offset:33792
    ds_read_b128 v[144:147], v28 offset:32768
    v_mfma_f32_32x32x16_bf16 v[64:79], v[132:135], v[244:247], v[64:79]
    ds_read_b64_tr_b16 v[244:245], v21 offset:32768
    ds_read_b64_tr_b16 v[246:247], v21 offset:33792
    ds_read_b128 v[148:151], v29 offset:32768
    v_mfma_f32_32x32x16_bf16 v[64:79], v[136:139], v[248:251], v[64:79]
    ds_read_b64_tr_b16 v[248:249], v22 offset:32768
    ds_read_b64_tr_b16 v[250:251], v22 offset:33792
    ds_read_b128 v[152:155], v30 offset:32768
    v_mfma_f32_32x32x16_bf16 v[64:79], v[140:143], v[252:255], v[64:79]
    ds_read_b64_tr_b16 v[252:253], v23 offset:32768
    ds_read_b64_tr_b16 v[254:255], v23 offset:33792
    ds_read_b128 v[156:159], v31 offset:32768
    s_waitcnt vmcnt(4) lgkmcnt(0)
    s_barrier
    s_add_u32 m0, s87, 49152
    s_nop 0
    buffer_load_dwordx4 v3, s[8:11], s70 offen lds
    buffer_load_dwordx4 v4, s[8:11], s70 offen offset:1024 lds
    s_add_u32 m0, s87, 65536
    s_nop 0
    buffer_load_dwordx4 v5, s[12:15], s77 offen lds
    buffer_load_dwordx4 v42, s[12:15], s77 offen offset:1024 lds
    v_mfma_f32_32x32x16_bf16 v[64:79], v[144:147], v[240:243], v[64:79]
    v_mfma_f32_16x16x32_bf16 v[12:15], v[8:11], v[240:243], v[12:15]
    v_add_u32 v20, 0xfffec000, v20
    v_add_u32 v21, 0xfffec000, v21
    v_add_u32 v22, 0xfffec000, v22
    v_add_u32 v23, 0xfffec000, v23
    ds_read_b64_tr_b16 v[240:241], v20 offset:0
    ds_read_b64_tr_b16 v[242:243], v20 offset:1024
    v_add_u32 v28, 0x10000, v28
    v_add_u32 v29, 0x10000, v29
    v_add_u32 v30, 0x10000, v30
    v_add_u32 v31, 0x10000, v31
    ds_read_b128 v[160:163], v28 offset:0
    v_mfma_f32_32x32x16_bf16 v[64:79], v[148:151], v[244:247], v[64:79]
    ds_read_b64_tr_b16 v[244:245], v21 offset:0
    ds_read_b64_tr_b16 v[246:247], v21 offset:1024
    ds_read_b128 v[164:167], v29 offset:0
    v_mfma_f32_32x32x16_bf16 v[64:79], v[152:155], v[248:251], v[64:79]
    ds_read_b64_tr_b16 v[248:249], v22 offset:0
    ds_read_b64_tr_b16 v[250:251], v22 offset:1024
    ds_read_b128 v[168:171], v30 offset:0
    v_mfma_f32_32x32x16_bf16 v[64:79], v[156:159], v[252:255], v[64:79]
    ds_read_b64_tr_b16 v[252:253], v23 offset:0
    ds_read_b64_tr_b16 v[254:255], v23 offset:1024
    ds_read_b128 v[172:175], v31 offset:0
    s_waitcnt vmcnt(4) lgkmcnt(0)
    s_barrier
    s_add_u32 m0, s87, 81920
    s_nop 0
    buffer_load_dwordx4 v3, s[8:11], s71 offen lds
    buffer_load_dwordx4 v4, s[8:11], s71 offen offset:1024 lds
    s_add_u32 m0, s87, 98304
    s_nop 0
    buffer_load_dwordx4 v5, s[12:15], s78 offen lds
    buffer_load_dwordx4 v42, s[12:15], s78 offen offset:1024 lds
    v_mfma_f32_32x32x16_bf16 v[64:79], v[160:163], v[240:243], v[64:79]
    v_mfma_f32_16x16x32_bf16 v[12:15], v[8:11], v[240:243], v[12:15]
    ds_read_b64_tr_b16 v[240:241], v20 offset:32768
    ds_read_b64_tr_b16 v[242:243], v20 offset:33792
    v_add_u32 v28, 0xfffe4000, v28
    v_add_u32 v29, 0xfffe4000, v29
    v_add_u32 v30, 0xfffe4000, v30
    v_add_u32 v31, 0xfffe4000, v31
    ds_read_b128 v[176:179], v28 offset:0
    v_mfma_f32_32x32x16_bf16 v[64:79], v[164:167], v[244:247], v[64:79]
    ds_read_b64_tr_b16 v[244:245], v21 offset:32768
    ds_read_b64_tr_b16 v[246:247], v21 offset:33792
    ds_read_b128 v[180:183], v29 offset:0
    v_mfma_f32_32x32x16_bf16 v[64:79], v[168:171], v[248:251], v[64:79]
    ds_read_b64_tr_b16 v[248:249], v22 offset:32768
    ds_read_b64_tr_b16 v[250:251], v22 offset:33792
    ds_read_b128 v[184:187], v30 offset:0
    v_mfma_f32_32x32x16_bf16 v[64:79], v[172:175], v[252:255], v[64:79]
    ds_read_b64_tr_b16 v[252:253], v23 offset:32768
    ds_read_b64_tr_b16 v[254:255], v23 offset:33792
    ds_read_b128 v[188:191], v31 offset:0
    s_waitcnt vmcnt(4) lgkmcnt(0)
    s_barrier
    s_add_u32 m0, s87, 114688
    s_nop 0
    buffer_load_dwordx4 v3, s[8:11], s72 offen lds
    buffer_load_dwordx4 v4, s[8:11], s72 offen offset:1024 lds
    s_add_u32 m0, s87, 131072
    s_nop 0
    buffer_load_dwordx4 v5, s[12:15], s79 offen lds
    buffer_load_dwordx4 v42, s[12:15], s79 offen offset:1024 lds
    v_mfma_f32_32x32x16_bf16 v[64:79], v[176:179], v[240:243], v[64:79]
    v_mfma_f32_16x16x32_bf16 v[12:15], v[8:11], v[240:243], v[12:15]
    v_add_u32 v20, 0x10000, v20
    v_add_u32 v21, 0x10000, v21
    v_add_u32 v22, 0x10000, v22
    v_add_u32 v23, 0x10000, v23
    ds_read_b64_tr_b16 v[240:241], v20 offset:0
    ds_read_b64_tr_b16 v[242:243], v20 offset:1024
    ds_read_b128 v[192:195], v28 offset:32768
    v_mfma_f32_32x32x16_bf16 v[64:79], v[180:183], v[244:247], v[64:79]
    ds_read_b64_tr_b16 v[244:245], v21 offset:0
    ds_read_b64_tr_b16 v[246:247], v21 offset:1024
    ds_read_b128 v[196:199], v29 offset:32768
    v_mfma_f32_32x32x16_bf16 v[64:79], v[184:187], v[248:251], v[64:79]
    ds_read_b64_tr_b16 v[248:249], v22 offset:0
    ds_read_b64_tr_b16 v[250:251], v22 offset:1024
    ds_read_b128 v[200:203], v30 offset:32768
    v_mfma_f32_32x32x16_bf16 v[64:79], v[188:191], v[252:255], v[64:79]
    ds_read_b64_tr_b16 v[252:253], v23 offset:0
    ds_read_b64_tr_b16 v[254:255], v23 offset:1024
    ds_read_b128 v[204:207], v31 offset:32768
    s_waitcnt vmcnt(4) lgkmcnt(0)
    s_barrier
    v_add_u32 v5, 896, v5
    s_add_u32 m0, s87, 0
    v_add_u32 v42, 896, v42
    buffer_load_dwordx4 v5, s[12:15], s73 offen lds
    buffer_load_dwordx4 v42, s[12:15], s73 offen offset:1024 lds
    s_add_u32 m0, s87, 16384
    v_add_u32 v3, 6144, v2
    buffer_load_dwordx4 v5, s[12:15], s74 offen lds
    buffer_load_dwordx4 v42, s[12:15], s74 offen offset:1024 lds
    v_mfma_f32_32x32x16_bf16 v[64:79], v[192:195], v[240:243], v[64:79]
    v_mfma_f32_16x16x32_bf16 v[12:15], v[8:11], v[240:243], v[12:15]
    ds_read_b64_tr_b16 v[240:241], v20 offset:32768
    ds_read_b64_tr_b16 v[242:243], v20 offset:33792
    v_add_u32 v28, 0x10000, v28
    v_add_u32 v29, 0x10000, v29
    v_add_u32 v30, 0x10000, v30
    v_add_u32 v31, 0x10000, v31
    ds_read_b128 v[208:211], v28 offset:0
    v_mfma_f32_32x32x16_bf16 v[64:79], v[196:199], v[244:247], v[64:79]
    ds_read_b64_tr_b16 v[244:245], v21 offset:32768
    ds_read_b64_tr_b16 v[246:247], v21 offset:33792
    ds_read_b128 v[212:215], v29 offset:0
    v_mfma_f32_32x32x16_bf16 v[64:79], v[200:203], v[248:251], v[64:79]
    ds_read_b64_tr_b16 v[248:249], v22 offset:32768
    ds_read_b64_tr_b16 v[250:251], v22 offset:33792
    ds_read_b128 v[216:219], v30 offset:0
    v_mfma_f32_32x32x16_bf16 v[64:79], v[204:207], v[252:255], v[64:79]
    ds_read_b64_tr_b16 v[252:253], v23 offset:32768
    ds_read_b64_tr_b16 v[254:255], v23 offset:33792
    ds_read_b128 v[220:223], v31 offset:0
    s_waitcnt vmcnt(4) lgkmcnt(0)
    s_barrier
    s_add_u32 m0, s87, 32768
    s_nop 0
    buffer_load_dwordx4 v5, s[12:15], s75 offen lds
    buffer_load_dwordx4 v42, s[12:15], s75 offen offset:1024 lds
    s_add_u32 m0, s87, 49152
    s_nop 0
    buffer_load_dwordx4 v5, s[12:15], s76 offen lds
    buffer_load_dwordx4 v42, s[12:15], s76 offen offset:1024 lds
    v_mfma_f32_32x32x16_bf16 v[64:79], v[208:211], v[240:243], v[64:79]
    v_mfma_f32_16x16x32_bf16 v[12:15], v[8:11], v[240:243], v[12:15]
    v_add_u32 v20, 0x10000, v20
    v_add_u32 v21, 0x10000, v21
    v_add_u32 v22, 0x10000, v22
    v_add_u32 v23, 0x10000, v23
    ds_read_b64_tr_b16 v[240:241], v20 offset:0
    ds_read_b64_tr_b16 v[242:243], v20 offset:1024
    ds_read_b128 v[224:227], v28 offset:32768
    v_mfma_f32_32x32x16_bf16 v[64:79], v[212:215], v[244:247], v[64:79]
    ds_read_b64_tr_b16 v[244:245], v21 offset:0
    ds_read_b64_tr_b16 v[246:247], v21 offset:1024
    ds_read_b128 v[228:231], v29 offset:32768
    v_mfma_f32_32x32x16_bf16 v[64:79], v[216:219], v[248:251], v[64:79]
    ds_read_b64_tr_b16 v[248:249], v22 offset:0
    ds_read_b64_tr_b16 v[250:251], v22 offset:1024
    ds_read_b128 v[232:235], v30 offset:32768
    v_mfma_f32_32x32x16_bf16 v[64:79], v[220:223], v[252:255], v[64:79]
    ds_read_b64_tr_b16 v[252:253], v23 offset:0
    ds_read_b64_tr_b16 v[254:255], v23 offset:1024
    ds_read_b128 v[236:239], v31 offset:32768
    s_waitcnt vmcnt(6) lgkmcnt(0)
    s_barrier
    s_add_u32 m0, s87, 65536
    s_nop 0
    buffer_load_dwordx4 v5, s[12:15], s77 offen lds
    buffer_load_dwordx4 v42, s[12:15], s77 offen offset:1024 lds
    ds_read_b64_tr_b16 v[112:113], v24 offset:0
    ds_read_b64_tr_b16 v[114:115], v24 offset:1024
    ds_read_b64_tr_b16 v[116:117], v25 offset:0
    ds_read_b64_tr_b16 v[118:119], v25 offset:1024
    ds_read_b64_tr_b16 v[120:121], v26 offset:0
    ds_read_b64_tr_b16 v[122:123], v26 offset:1024
    ds_read_b64_tr_b16 v[124:125], v27 offset:0
    ds_read_b64_tr_b16 v[126:127], v27 offset:1024
    v_mfma_f32_32x32x16_bf16 v[64:79], v[224:227], v[240:243], v[64:79]
    v_mfma_f32_16x16x32_bf16 v[12:15], v[8:11], v[240:243], v[12:15]
    v_add_u32 v20, 0xfffe0000, v20
    v_add_u32 v21, 0xfffe0000, v21
    v_add_u32 v22, 0xfffe0000, v22
    v_add_u32 v23, 0xfffe0000, v23
    ds_read_b64_tr_b16 v[240:241], v20 offset:0
    ds_read_b64_tr_b16 v[242:243], v20 offset:1024
    v_mfma_f32_32x32x16_bf16 v[64:79], v[228:231], v[244:247], v[64:79]
    ds_read_b64_tr_b16 v[244:245], v21 offset:0
    ds_read_b64_tr_b16 v[246:247], v21 offset:1024
    v_mfma_f32_32x32x16_bf16 v[64:79], v[232:235], v[248:251], v[64:79]
    ds_read_b64_tr_b16 v[248:249], v22 offset:0
    ds_read_b64_tr_b16 v[250:251], v22 offset:1024
    ds_write_b32 v6, v12 offset:0
    v_mfma_f32_32x32x16_bf16 v[64:79], v[236:239], v[252:255], v[64:79]
    ds_read_b64_tr_b16 v[252:253], v23 offset:0
    ds_read_b64_tr_b16 v[254:255], v23 offset:1024
    s_waitcnt vmcnt(4) lgkmcnt(0)
    s_barrier
    v_mfma_f32_32x32x16_bf16 v[80:95], v[128:131], v[240:243], 0
    v_mfma_f32_16x16x32_bf16 v[12:15], v[8:11], v[240:243], 0
    ds_read_b64_tr_b16 v[240:241], v20 offset:16384
    ds_read_b64_tr_b16 v[242:243], v20 offset:17408
    v_mfma_f32_32x32x16_bf16 v[96:111], v[128:131], v[112:115], 0
    v_mfma_f32_16x16x32_bf16 v[16:19], v[8:11], v[112:115], 0
    ds_read_b64_tr_b16 v[112:113], v24 offset:16384
    ds_read_b64_tr_b16 v[114:115], v24 offset:17408
    v_mfma_f32_32x32x16_bf16 v[80:95], v[132:135], v[244:247], v[80:95]
    ds_read_b64_tr_b16 v[244:245], v21 offset:16384
    ds_read_b64_tr_b16 v[246:247], v21 offset:17408
    v_mfma_f32_32x32x16_bf16 v[96:111], v[132:135], v[116:119], v[96:111]
    ds_read_b64_tr_b16 v[116:117], v25 offset:16384
    s_add_u32 m0, s87, 81920
    ds_read_b64_tr_b16 v[118:119], v25 offset:17408
    buffer_load_dwordx4 v5, s[12:15], s78 offen lds
    v_mfma_f32_32x32x16_bf16 v[80:95], v[136:139], v[248:251], v[80:95]
    ds_read_b64_tr_b16 v[248:249], v22 offset:16384
    ds_read_b64_tr_b16 v[250:251], v22 offset:17408
    v_mfma_f32_32x32x16_bf16 v[96:111], v[136:139], v[120:123], v[96:111]
    ds_read_b64_tr_b16 v[120:121], v26 offset:16384
    ds_read_b64_tr_b16 v[122:123], v26 offset:17408
    buffer_load_dwordx4 v42, s[12:15], s78 offen offset:1024 lds
    v_mfma_f32_32x32x16_bf16 v[80:95], v[140:143], v[252:255], v[80:95]
    ds_read_b64_tr_b16 v[252:253], v23 offset:16384
    ds_read_b64_tr_b16 v[254:255], v23 offset:17408
    v_mfma_f32_32x32x16_bf16 v[96:111], v[140:143], v[124:127], v[96:111]
    ds_read_b64_tr_b16 v[124:125], v27 offset:16384
    ds_read_b64_tr_b16 v[126:127], v27 offset:17408
    s_waitcnt lgkmcnt(12)
    v_mfma_f32_32x32x16_bf16 v[80:95], v[144:147], v[240:243], v[80:95]
    v_mfma_f32_16x16x32_bf16 v[12:15], v[8:11], v[240:243], v[12:15]
    ds_read_b64_tr_b16 v[240:241], v20 offset:32768
    ds_read_b64_tr_b16 v[242:243], v20 offset:33792
    v_mfma_f32_32x32x16_bf16 v[96:111], v[144:147], v[112:115], v[96:111]
    v_mfma_f32_16x16x32_bf16 v[16:19], v[8:11], v[112:115], v[16:19]
    ds_read_b64_tr_b16 v[112:113], v24 offset:32768
    ds_read_b64_tr_b16 v[114:115], v24 offset:33792
    s_waitcnt lgkmcnt(12)
    v_mfma_f32_32x32x16_bf16 v[80:95], v[148:151], v[244:247], v[80:95]
    ds_read_b64_tr_b16 v[244:245], v21 offset:32768
    ds_read_b64_tr_b16 v[246:247], v21 offset:33792
    v_mfma_f32_32x32x16_bf16 v[96:111], v[148:151], v[116:119], v[96:111]
    ds_read_b64_tr_b16 v[116:117], v25 offset:32768
    s_add_u32 m0, s87, 98304
    ds_read_b64_tr_b16 v[118:119], v25 offset:33792
    buffer_load_dwordx4 v5, s[12:15], s79 offen lds
    s_waitcnt lgkmcnt(12)
    v_mfma_f32_32x32x16_bf16 v[80:95], v[152:155], v[248:251], v[80:95]
    ds_read_b64_tr_b16 v[248:249], v22 offset:32768
    ds_read_b64_tr_b16 v[250:251], v22 offset:33792
    v_mfma_f32_32x32x16_bf16 v[96:111], v[152:155], v[120:123], v[96:111]
    ds_read_b64_tr_b16 v[120:121], v26 offset:32768
    ds_read_b64_tr_b16 v[122:123], v26 offset:33792
    buffer_load_dwordx4 v42, s[12:15], s79 offen offset:1024 lds
    s_waitcnt lgkmcnt(12)
    v_mfma_f32_32x32x16_bf16 v[80:95], v[156:159], v[252:255], v[80:95]
    ds_read_b64_tr_b16 v[252:253], v23 offset:32768
    ds_read_b64_tr_b16 v[254:255], v23 offset:33792
    v_mfma_f32_32x32x16_bf16 v[96:111], v[156:159], v[124:127], v[96:111]
    ds_read_b64_tr_b16 v[124:125], v27 offset:32768
    ds_read_b64_tr_b16 v[126:127], v27 offset:33792
    s_waitcnt vmcnt(4) lgkmcnt(0)
    s_barrier
    v_mfma_f32_32x32x16_bf16 v[80:95], v[160:163], v[240:243], v[80:95]
    v_mfma_f32_16x16x32_bf16 v[12:15], v[8:11], v[240:243], v[12:15]
    ds_read_b64_tr_b16 v[240:241], v20 offset:49152
    ds_read_b64_tr_b16 v[242:243], v20 offset:50176
    v_mfma_f32_32x32x16_bf16 v[96:111], v[160:163], v[112:115], v[96:111]
    v_mfma_f32_16x16x32_bf16 v[16:19], v[8:11], v[112:115], v[16:19]
    ds_read_b64_tr_b16 v[112:113], v24 offset:49152
    ds_read_b64_tr_b16 v[114:115], v24 offset:50176
    v_mfma_f32_32x32x16_bf16 v[80:95], v[164:167], v[244:247], v[80:95]
    ds_read_b64_tr_b16 v[244:245], v21 offset:49152
    ds_read_b64_tr_b16 v[246:247], v21 offset:50176
    v_mfma_f32_32x32x16_bf16 v[96:111], v[164:167], v[116:119], v[96:111]
    ds_read_b64_tr_b16 v[116:117], v25 offset:49152
    ds_read_b64_tr_b16 v[118:119], v25 offset:50176
    buffer_load_dword v38, v39, s[16:19], s90 offen sc1
    v_mfma_f32_32x32x16_bf16 v[80:95], v[168:171], v[248:251], v[80:95]
    ds_read_b64_tr_b16 v[248:249], v22 offset:49152
    ds_read_b64_tr_b16 v[250:251], v22 offset:50176
    v_mfma_f32_32x32x16_bf16 v[96:111], v[168:171], v[120:123], v[96:111]
    ds_read_b64_tr_b16 v[120:121], v26 offset:49152
    ds_read_b64_tr_b16 v[122:123], v26 offset:50176
    v_mfma_f32_32x32x16_bf16 v[80:95], v[172:175], v[252:255], v[80:95]
    ds_read_b64_tr_b16 v[252:253], v23 offset:49152
    ds_read_b64_tr_b16 v[254:255], v23 offset:50176
    v_mfma_f32_32x32x16_bf16 v[96:111], v[172:175], v[124:127], v[96:111]
    ds_read_b64_tr_b16 v[124:125], v27 offset:49152
    ds_read_b64_tr_b16 v[126:127], v27 offset:50176
    s_waitcnt lgkmcnt(12)
    v_mfma_f32_32x32x16_bf16 v[80:95], v[176:179], v[240:243], v[80:95]
    v_mfma_f32_16x16x32_bf16 v[12:15], v[8:11], v[240:243], v[12:15]
    v_add_u32 v20, 0x10000, v20
    v_add_u32 v21, 0x10000, v21
    v_add_u32 v22, 0x10000, v22
    v_add_u32 v23, 0x10000, v23
    ds_read_b64_tr_b16 v[240:241], v20 offset:0
    ds_read_b64_tr_b16 v[242:243], v20 offset:1024
    v_mfma_f32_32x32x16_bf16 v[96:111], v[176:179], v[112:115], v[96:111]
    v_mfma_f32_16x16x32_bf16 v[16:19], v[8:11], v[112:115], v[16:19]
    v_add_u32 v24, 0x10000, v24
    v_add_u32 v25, 0x10000, v25
    v_add_u32 v26, 0x10000, v26
    v_add_u32 v27, 0x10000, v27
    ds_read_b64_tr_b16 v[112:113], v24 offset:0
    ds_read_b64_tr_b16 v[114:115], v24 offset:1024
    s_waitcnt lgkmcnt(12)
    v_mfma_f32_32x32x16_bf16 v[80:95], v[180:183], v[244:247], v[80:95]
    ds_read_b64_tr_b16 v[244:245], v21 offset:0
    ds_read_b64_tr_b16 v[246:247], v21 offset:1024
    v_mfma_f32_32x32x16_bf16 v[96:111], v[180:183], v[116:119], v[96:111]
    ds_read_b64_tr_b16 v[116:117], v25 offset:0
    ds_read_b64_tr_b16 v[118:119], v25 offset:1024
    s_xor_b32 s88, s89, 0
    s_add_u32 m0, s60, 0
    s_mul_i32 s88, s88, 14336
    s_add_u32 s88, s88, s58
    buffer_load_dwordx4 v2, s[20:23], s88 offen lds
    s_waitcnt lgkmcnt(12)
    v_mfma_f32_32x32x16_bf16 v[80:95], v[184:187], v[248:251], v[80:95]
    ds_read_b64_tr_b16 v[248:249], v22 offset:0
    ds_read_b64_tr_b16 v[250:251], v22 offset:1024
    v_mfma_f32_32x32x16_bf16 v[96:111], v[184:187], v[120:123], v[96:111]
    ds_read_b64_tr_b16 v[120:121], v26 offset:0
    ds_read_b64_tr_b16 v[122:123], v26 offset:1024
    s_waitcnt lgkmcnt(12)
    v_mfma_f32_32x32x16_bf16 v[80:95], v[188:191], v[252:255], v[80:95]
    ds_read_b64_tr_b16 v[252:253], v23 offset:0
    ds_read_b64_tr_b16 v[254:255], v23 offset:1024
    v_mfma_f32_32x32x16_bf16 v[96:111], v[188:191], v[124:127], v[96:111]
    ds_read_b64_tr_b16 v[124:125], v27 offset:0
    ds_read_b64_tr_b16 v[126:127], v27 offset:1024
    buffer_load_dwordx4 v3, s[20:23], s88 offen offset:1024 lds
    s_waitcnt vmcnt(3) lgkmcnt(0)
    s_barrier
    v_mfma_f32_32x32x16_bf16 v[80:95], v[192:195], v[240:243], v[80:95]
    v_mfma_f32_16x16x32_bf16 v[12:15], v[8:11], v[240:243], v[12:15]
    ds_read_b64_tr_b16 v[240:241], v20 offset:16384
    ds_read_b64_tr_b16 v[242:243], v20 offset:17408
    v_mfma_f32_32x32x16_bf16 v[96:111], v[192:195], v[112:115], v[96:111]
    v_mfma_f32_16x16x32_bf16 v[16:19], v[8:11], v[112:115], v[16:19]
    ds_read_b64_tr_b16 v[112:113], v24 offset:16384
    ds_read_b64_tr_b16 v[114:115], v24 offset:17408
    v_mfma_f32_32x32x16_bf16 v[80:95], v[196:199], v[244:247], v[80:95]
    ds_read_b64_tr_b16 v[244:245], v21 offset:16384
    ds_read_b64_tr_b16 v[246:247], v21 offset:17408
    v_mfma_f32_32x32x16_bf16 v[96:111], v[196:199], v[116:119], v[96:111]
    ds_read_b64_tr_b16 v[116:117], v25 offset:16384
    ds_read_b64_tr_b16 v[118:119], v25 offset:17408
    s_xor_b32 s88, s89, 1
    s_add_u32 m0, s60, 2048
    s_mul_i32 s88, s88, 14336
    s_add_u32 s88, s88, s58
    buffer_load_dwordx4 v2, s[20:23], s88 offen lds
    v_mfma_f32_32x32x16_bf16 v[80:95], v[200:203], v[248:251], v[80:95]
    ds_read_b64_tr_b16 v[248:249], v22 offset:16384
    ds_read_b64_tr_b16 v[250:251], v22 offset:17408
    v_mfma_f32_32x32x16_bf16 v[96:111], v[200:203], v[120:123], v[96:111]
    ds_read_b64_tr_b16 v[120:121], v26 offset:16384
    ds_read_b64_tr_b16 v[122:123], v26 offset:17408
    v_mfma_f32_32x32x16_bf16 v[80:95], v[204:207], v[252:255], v[80:95]
    ds_read_b64_tr_b16 v[252:253], v23 offset:16384
    ds_read_b64_tr_b16 v[254:255], v23 offset:17408
    v_mfma_f32_32x32x16_bf16 v[96:111], v[204:207], v[124:127], v[96:111]
    ds_read_b64_tr_b16 v[124:125], v27 offset:16384
    ds_read_b64_tr_b16 v[126:127], v27 offset:17408
    buffer_load_dwordx4 v3, s[20:23], s88 offen offset:1024 lds
    s_waitcnt lgkmcnt(12)
    v_mfma_f32_32x32x16_bf16 v[80:95], v[208:211], v[240:243], v[80:95]
    v_mfma_f32_16x16x32_bf16 v[12:15], v[8:11], v[240:243], v[12:15]
    ds_read_b64_tr_b16 v[240:241], v20 offset:32768
    ds_read_b64_tr_b16 v[242:243], v20 offset:33792
    v_mfma_f32_32x32x16_bf16 v[96:111], v[208:211], v[112:115], v[96:111]
    v_mfma_f32_16x16x32_bf16 v[16:19], v[8:11], v[112:115], v[16:19]
    ds_read_b64_tr_b16 v[112:113], v24 offset:32768
    ds_read_b64_tr_b16 v[114:115], v24 offset:33792
    s_waitcnt lgkmcnt(12)
    v_mfma_f32_32x32x16_bf16 v[80:95], v[212:215], v[244:247], v[80:95]
    ds_read_b64_tr_b16 v[244:245], v21 offset:32768
    ds_read_b64_tr_b16 v[246:247], v21 offset:33792
    v_mfma_f32_32x32x16_bf16 v[96:111], v[212:215], v[116:119], v[96:111]
    ds_read_b64_tr_b16 v[116:117], v25 offset:32768
    ds_read_b64_tr_b16 v[118:119], v25 offset:33792
    s_xor_b32 s88, s89, 2
    s_add_u32 m0, s60, 4096
    s_mul_i32 s88, s88, 14336
    s_add_u32 s88, s88, s58
    buffer_load_dwordx4 v2, s[20:23], s88 offen lds
    s_mul_i32 s82, s4, 10240
    s_add_u32 s82, s82, 122880
    v_add_u32 v28, s82, v1
    s_waitcnt lgkmcnt(12)
    v_mfma_f32_32x32x16_bf16 v[80:95], v[216:219], v[248:251], v[80:95]
    ds_read_b64_tr_b16 v[248:249], v22 offset:32768
    ds_read_b64_tr_b16 v[250:251], v22 offset:33792
    v_mfma_f32_32x32x16_bf16 v[96:111], v[216:219], v[120:123], v[96:111]
    ds_read_b64_tr_b16 v[120:121], v26 offset:32768
    ds_read_b64_tr_b16 v[122:123], v26 offset:33792
    s_waitcnt lgkmcnt(12)
    v_mfma_f32_32x32x16_bf16 v[80:95], v[220:223], v[252:255], v[80:95]
    ds_read_b64_tr_b16 v[252:253], v23 offset:32768
    ds_read_b64_tr_b16 v[254:255], v23 offset:33792
    v_mfma_f32_32x32x16_bf16 v[96:111], v[220:223], v[124:127], v[96:111]
    ds_read_b64_tr_b16 v[124:125], v27 offset:32768
    ds_read_b64_tr_b16 v[126:127], v27 offset:33792
    buffer_load_dwordx4 v3, s[20:23], s88 offen offset:1024 lds
    s_waitcnt vmcnt(6)
    v_and_b32 v48, 0xffff, v38
    v_lshl_or_b32 v48, v38, 16, v48
    v_cndmask_b32 v36, v48, 0, s[92:93]
    s_waitcnt lgkmcnt(12)
    v_mfma_f32_32x32x16_bf16 v[80:95], v[224:227], v[240:243], v[80:95]
    v_mfma_f32_16x16x32_bf16 v[12:15], v[8:11], v[240:243], v[12:15]
    v_mfma_f32_32x32x16_bf16 v[96:111], v[224:227], v[112:115], v[96:111]
    v_mfma_f32_16x16x32_bf16 v[16:19], v[8:11], v[112:115], v[16:19]
    s_waitcnt lgkmcnt(8)
    v_mfma_f32_32x32x16_bf16 v[80:95], v[228:231], v[244:247], v[80:95]
    v_mfma_f32_32x32x16_bf16 v[96:111], v[228:231], v[116:119], v[96:111]
    s_xor_b32 s88, s89, 3
    s_add_u32 m0, s60, 6144
    s_mul_i32 s88, s88, 14336
    s_add_u32 s88, s88, s58
    buffer_load_dwordx4 v2, s[20:23], s88 offen lds
    s_waitcnt lgkmcnt(4)
    v_mfma_f32_32x32x16_bf16 v[80:95], v[232:235], v[248:251], v[80:95]
    v_mfma_f32_32x32x16_bf16 v[96:111], v[232:235], v[120:123], v[96:111]
    ds_write_b32 v6, v12 offset:1536
    ds_write_b32 v6, v16 offset:2048
    s_waitcnt lgkmcnt(2)
    v_mfma_f32_32x32x16_bf16 v[80:95], v[236:239], v[252:255], v[80:95]
    v_mfma_f32_32x32x16_bf16 v[96:111], v[236:239], v[124:127], v[96:111]
    buffer_load_dwordx4 v3, s[20:23], s88 offen offset:1024 lds
    s_waitcnt lgkmcnt(0)
    s_barrier
    s_setprio 0
    v_mov_b32 v13, 0
    ds_read_b128 v[52:55], v7 offset:2048
    ds_read_b128 v[56:59], v7 offset:0
    ds_read_b128 v[60:63], v7 offset:1536
    ds_read_b128 v[240:243], v41 offset:0
    ds_read_b128 v[244:247], v41 offset:32
    ds_read_b128 v[248:251], v41 offset:64
    ds_read_b128 v[252:255], v41 offset:96
    v_cndmask_b32 v29, 0, 1.0, s[100:101]
    s_lshl_b32 s82, s4, 12
    s_add_u32 s82, s82, 49152
    v_add_u32 v30, s82, v1
    ds_read_b128 v[176:179], v28 offset:0
    ds_read_b128 v[180:183], v28 offset:1024
    ds_read_b128 v[192:195], v43 offset:0
    ds_read_b128 v[196:199], v43 offset:32
    ds_read_b128 v[200:203], v43 offset:64
    ds_read_b128 v[204:207], v43 offset:96
    s_waitcnt lgkmcnt(12)
    v_add_f32 v52, v52, v53
    v_add_f32 v54, v54, v55
    v_add_f32 v52, v52, v54
    v_cvt_pk_bf16_f32 v53, v52, v52
    v_lshlrev_b32 v53, 16, v53
    v_sub_f32 v53, v52, v53
    v_cvt_pk_bf16_f32 v32, v52, v53
    s_waitcnt lgkmcnt(11)
    v_add_f32 v56, v56, v57
    v_add_f32 v58, v58, v59
    v_add_f32 v56, v56, v58
    v_cvt_pk_bf16_f32 v57, v56, v56
    v_lshlrev_b32 v57, 16, v57
    v_sub_f32 v57, v56, v57
    v_cvt_pk_bf16_f32 v34, v56, v57
    s_waitcnt lgkmcnt(10)
    v_add_f32 v60, v60, v61
    v_add_f32 v62, v62, v63
    v_add_f32 v60, v60, v62
    v_cvt_pk_bf16_f32 v61, v60, v60
    v_lshlrev_b32 v61, 16, v61
    v_sub_f32 v61, v60, v61
    v_cvt_pk_bf16_f32 v12, v60, v61
    s_setprio 2
    v_mfma_f32_32x32x8_bf16 v[96:111], v[36:37], v[32:33], v[96:111]
    v_mfma_f32_32x32x8_bf16 v[64:79], v[36:37], v[34:35], v[64:79]
    v_mfma_f32_32x32x8_bf16 v[80:95], v[36:37], v[12:13], v[80:95]
    s_setprio 0
    v_lshrrev_b32 v220, 3, v0
    v_and_b32 v221, 0x70, v1
    v_mul_u32_u24 v220, 896, v220
    s_lshl_b32 s95, s7, 7
    v_add_u32 v220, v220, v221
    buffer_load_dwordx4 v[212:215], v220, s[8:11], s63 offen
    buffer_load_dwordx4 v[216:219], v221, s[36:39], s95 offen
    s_lshl_b32 s83, s4, 10
    s_add_u32 s83, s83, 49152
    v_add_u32 v10, s83, v1
    s_cmp_eq_u32 s4, 3
    s_cselect_b64 vcc, s[92:93], 0
    v_lshrrev_b32 v11, 2, v1
    v_cndmask_b32 v11, v11, v46, vcc
    s_lshl2_add_u32 s90, s97, s4
    s_lshl_b32 s90, s90, 10
    s_add_u32 s90, s90, 0x900000
    s_waitcnt lgkmcnt(4)
    v_fma_f32 v96, v96, v240, v29
    v_fma_f32 v97, v97, v241, v29
    v_fma_f32 v98, v98, v242, v29
    v_fma_f32 v99, v99, v243, v29
    v_fma_f32 v100, v100, v244, v29
    v_fma_f32 v101, v101, v245, v29
    v_fma_f32 v102, v102, v246, v29
    v_fma_f32 v103, v103, v247, v29
    v_cvt_pk_bf16_f32 v96, v96, v97
    v_cvt_pk_bf16_f32 v97, v98, v99
    v_cvt_pk_bf16_f32 v98, v100, v101
    v_cvt_pk_bf16_f32 v99, v102, v103
    v_fma_f32 v104, v104, v248, v29
    v_fma_f32 v105, v105, v249, v29
    v_fma_f32 v106, v106, v250, v29
    v_fma_f32 v107, v107, v251, v29
    v_fma_f32 v108, v108, v252, v29
    v_fma_f32 v109, v109, v253, v29
    v_fma_f32 v110, v110, v254, v29
    v_fma_f32 v111, v111, v255, v29
    v_cvt_pk_bf16_f32 v104, v104, v105
    v_cvt_pk_bf16_f32 v105, v106, v107
    v_cvt_pk_bf16_f32 v106, v108, v109
    v_cvt_pk_bf16_f32 v107, v110, v111
    s_setprio 2
    v_mfma_f32_32x32x16_bf16 v[144:159], v[176:179], v[96:99], 0
    v_mfma_f32_32x32x16_bf16 v[144:159], v[180:183], v[104:107], v[144:159]
    s_setprio 0
    s_waitcnt lgkmcnt(0)
    v_fma_f32 v64, v64, v192, s85
    v_fma_f32 v65, v65, v193, s85
    v_fma_f32 v66, v66, v194, s85
    v_fma_f32 v67, v67, v195, s85
    v_mul_f32 v48, s99, v64
    v_mul_f32 v49, s99, v65
    v_mul_f32 v50, s99, v66
    v_mul_f32 v51, s99, v67
    s_waitcnt lgkmcnt(0)
    s_barrier
    ds_write_b128 v30, v[144:147] offset:0
    v_exp_f32_e64 v48, v48 clamp
    v_exp_f32_e64 v49, v49 clamp
    v_exp_f32_e64 v50, v50 clamp
    v_exp_f32_e64 v51, v51 clamp
    v_max_f32 v64, s85, v64
    v_max_f32 v65, s85, v65
    v_max_f32 v66, s85, v66
    v_max_f32 v67, s85, v67
    v_add_f32 v64, v64, v48
    v_add_f32 v65, v65, v49
    ds_write_b128 v30, v[148:151] offset:1024
    v_add_f32 v66, v66, v50
    v_add_f32 v67, v67, v51
    v_cvt_pk_bf16_f32 v64, v64, v65
    v_cvt_pk_bf16_f32 v65, v66, v67
    v_fma_f32 v68, v68, v196, s85
    v_fma_f32 v69, v69, v197, s85
    v_fma_f32 v70, v70, v198, s85
    v_fma_f32 v71, v71, v199, s85
    v_mul_f32 v48, s99, v68
    v_mul_f32 v49, s99, v69
    ds_write_b128 v30, v[152:155] offset:2048
    v_mul_f32 v50, s99, v70
    v_mul_f32 v51, s99, v71
    v_exp_f32_e64 v48, v48 clamp
    v_exp_f32_e64 v49, v49 clamp
    v_exp_f32_e64 v50, v50 clamp
    v_exp_f32_e64 v51, v51 clamp
    v_max_f32 v68, s85, v68
    v_max_f32 v69, s85, v69
    v_max_f32 v70, s85, v70
    v_max_f32 v71, s85, v71
    ds_write_b128 v30, v[156:159] offset:3072
    v_add_f32 v68, v68, v48
    v_add_f32 v69, v69, v49
    v_add_f32 v70, v70, v50
    v_add_f32 v71, v71, v51
    v_cvt_pk_bf16_f32 v66, v68, v69
    v_cvt_pk_bf16_f32 v67, v70, v71
    v_fma_f32 v72, v72, v200, s85
    v_fma_f32 v73, v73, v201, s85
    v_fma_f32 v74, v74, v202, s85
    v_fma_f32 v75, v75, v203, s85
    s_xor_b32 s88, s89, 16
    s_add_u32 m0, s60, 8192
    s_mul_i32 s88, s88, 14336
    s_add_u32 s88, s88, s58
    buffer_load_dwordx4 v2, s[20:23], s88 offen lds
    v_mul_f32 v48, s99, v72
    v_mul_f32 v49, s99, v73
    v_mul_f32 v50, s99, v74
    v_mul_f32 v51, s99, v75
    v_exp_f32_e64 v48, v48 clamp
    v_exp_f32_e64 v49, v49 clamp
    v_exp_f32_e64 v50, v50 clamp
    v_exp_f32_e64 v51, v51 clamp
    v_max_f32 v72, s85, v72
    v_max_f32 v73, s85, v73
    buffer_load_dwordx4 v3, s[20:23], s88 offen offset:1024 lds
    v_max_f32 v74, s85, v74
    v_max_f32 v75, s85, v75
    v_add_f32 v72, v72, v48
    v_add_f32 v73, v73, v49
    v_add_f32 v74, v74, v50
    v_add_f32 v75, v75, v51
    v_cvt_pk_bf16_f32 v68, v72, v73
    v_cvt_pk_bf16_f32 v69, v74, v75
    v_fma_f32 v76, v76, v204, s85
    v_fma_f32 v77, v77, v205, s85
    s_xor_b32 s88, s89, 17
    s_add_u32 m0, s59, 0
    s_mul_i32 s88, s88, 14336
    s_add_u32 s88, s88, s58
    buffer_load_dwordx4 v2, s[20:23], s88 offen lds
    v_fma_f32 v78, v78, v206, s85
    v_fma_f32 v79, v79, v207, s85
    v_mul_f32 v48, s99, v76
    v_mul_f32 v49, s99, v77
    v_mul_f32 v50, s99, v78
    v_mul_f32 v51, s99, v79
    v_exp_f32_e64 v48, v48 clamp
    v_exp_f32_e64 v49, v49 clamp
    v_exp_f32_e64 v50, v50 clamp
    v_exp_f32_e64 v51, v51 clamp
    buffer_load_dwordx4 v3, s[20:23], s88 offen offset:1024 lds
    v_max_f32 v76, s85, v76
    v_max_f32 v77, s85, v77
    v_max_f32 v78, s85, v78
    v_max_f32 v79, s85, v79
    v_add_f32 v76, v76, v48
    v_add_f32 v77, v77, v49
    v_add_f32 v78, v78, v50
    v_add_f32 v79, v79, v51
    v_cvt_pk_bf16_f32 v70, v76, v77
    v_cvt_pk_bf16_f32 v71, v78, v79
    v_fma_f32 v80, v80, v240, v29
    v_fma_f32 v81, v81, v241, v29
    v_fma_f32 v82, v82, v242, v29
    s_waitcnt lgkmcnt(0)
    s_barrier
    v_fma_f32 v83, v83, v243, v29
    v_fma_f32 v84, v84, v244, v29
    v_fma_f32 v85, v85, v245, v29
    v_fma_f32 v86, v86, v246, v29
    v_fma_f32 v87, v87, v247, v29
    v_cvt_pk_bf16_f32 v80, v80, v81
    v_cvt_pk_bf16_f32 v81, v82, v83
    v_cvt_pk_bf16_f32 v82, v84, v85
    v_cvt_pk_bf16_f32 v83, v86, v87
    v_fma_f32 v88, v88, v248, v29
    v_fma_f32 v89, v89, v249, v29
    v_fma_f32 v90, v90, v250, v29
    v_fma_f32 v91, v91, v251, v29
    v_fma_f32 v92, v92, v252, v29
    v_fma_f32 v93, v93, v253, v29
    v_fma_f32 v94, v94, v254, v29
    v_fma_f32 v95, v95, v255, v29
    v_cvt_pk_bf16_f32 v88, v88, v89
    v_cvt_pk_bf16_f32 v89, v90, v91
    v_cvt_pk_bf16_f32 v90, v92, v93
    v_cvt_pk_bf16_f32 v91, v94, v95
    s_setprio 2
    v_mfma_f32_32x32x16_bf16 v[128:143], v[64:67], v[80:83], 0
    v_mfma_f32_32x32x16_bf16 v[128:143], v[68:71], v[88:91], v[128:143]
    s_add_u32 s96, s90, 4096
    s_add_u32 s81, s90, 8192
    s_cmp_eq_u32 s98, 3
    s_cselect_b32 s81, s81, 0x40000000
    s_nop 7
    ds_write_b128 v30, v[128:131] offset:16384
    ds_write_b128 v30, v[132:135] offset:17408
    ds_write_b128 v30, v[136:139] offset:18432
    ds_write_b128 v30, v[140:143] offset:19456
    s_waitcnt vmcnt(0) lgkmcnt(0)
    s_barrier
    ds_read_b128 v[160:163], v10 offset:16384
    ds_read_b128 v[164:167], v10 offset:20480
    ds_read_b128 v[168:171], v10 offset:24576
    ds_read_b128 v[172:175], v10 offset:28672
    ds_read_b128 v[176:179], v10 offset:0
    ds_read_b128 v[180:183], v10 offset:4096
    ds_read_b128 v[184:187], v10 offset:8192
    ds_read_b128 v[188:191], v10 offset:12288
    ds_read_b128 v[192:195], v10 offset:32768
    ds_read_b128 v[196:199], v10 offset:36864
    ds_read_b128 v[200:203], v10 offset:40960
    ds_read_b128 v[204:207], v10 offset:45056
    s_waitcnt lgkmcnt(8)
    v_pk_add_f32 v[160:161], v[160:161], v[164:165]
    v_pk_add_f32 v[168:169], v[168:169], v[172:173]
    v_pk_add_f32 v[160:161], v[160:161], v[168:169]
    v_pk_add_f32 v[162:163], v[162:163], v[166:167]
    v_pk_add_f32 v[170:171], v[170:171], v[174:175]
    v_pk_add_f32 v[162:163], v[162:163], v[170:171]
    buffer_atomic_add_f32 v160, v11, s[16:19], s90 offen offset:0 sc1
    buffer_atomic_add_f32 v161, v11, s[16:19], s90 offen offset:256 sc1
    buffer_atomic_add_f32 v162, v11, s[16:19], s90 offen offset:512 sc1
    buffer_atomic_add_f32 v163, v11, s[16:19], s90 offen offset:768 sc1
    s_waitcnt lgkmcnt(4)
    v_pk_add_f32 v[176:177], v[176:177], v[180:181]
    v_pk_add_f32 v[184:185], v[184:185], v[188:189]
    v_pk_add_f32 v[176:177], v[176:177], v[184:185]
    v_pk_add_f32 v[178:179], v[178:179], v[182:183]
    v_pk_add_f32 v[186:187], v[186:187], v[190:191]
    v_pk_add_f32 v[178:179], v[178:179], v[186:187]
    buffer_atomic_add_f32 v176, v11, s[16:19], s96 offen offset:0 sc1
    buffer_atomic_add_f32 v177, v11, s[16:19], s96 offen offset:256 sc1
    buffer_atomic_add_f32 v178, v11, s[16:19], s96 offen offset:512 sc1
    buffer_atomic_add_f32 v179, v11, s[16:19], s96 offen offset:768 sc1
    s_waitcnt lgkmcnt(0)
    v_pk_add_f32 v[192:193], v[192:193], v[196:197]
    v_pk_add_f32 v[200:201], v[200:201], v[204:205]
    v_pk_add_f32 v[192:193], v[192:193], v[200:201]
    v_pk_add_f32 v[194:195], v[194:195], v[198:199]
    v_pk_add_f32 v[202:203], v[202:203], v[206:207]
    v_pk_add_f32 v[194:195], v[194:195], v[202:203]
    buffer_atomic_add_f32 v192, v11, s[16:19], s81 offen offset:0 sc1
    buffer_atomic_add_f32 v193, v11, s[16:19], s81 offen offset:256 sc1
    buffer_atomic_add_f32 v194, v11, s[16:19], s81 offen offset:512 sc1
    buffer_atomic_add_f32 v195, v11, s[16:19], s81 offen offset:768 sc1
    s_lshl_b32 s91, s97, 7
    s_lshl_b32 s83, s4, 28
    s_add_u32 s91, s91, s83
    s_add_u32 s91, s91, 0x910000
    s_lshl_b32 s83, s98, 4
    v_cmp_gt_u32 vcc, s83, v1
    v_lshlrev_b32 v31, 3, v1
    s_nop 0
    v_cndmask_b32 v31, v46, v31, vcc
    s_waitcnt vmcnt(0)
    ds_write_b32 v45, v47 offset:0
    v_mov_b32 v56, 157696
L_sy5:
    ds_read_b128 v[48:51], v56 offset:0
    s_add_u32 s94, s94, 1
    s_cmp_gt_u32 s94, 0x10000
    s_cbranch_scc1 L_sz5
    s_waitcnt lgkmcnt(0)
    v_and_b32 v49, v49, v50
    v_and_b32 v48, v48, v49
    v_and_b32 v48, v48, v51
    s_nop 0
    v_readfirstlane_b32 s95, v48
    s_nop 0
    s_cmp_eq_u32 s95, 0
    s_cbranch_scc1 L_sy5
L_sz5:
    s_waitcnt lgkmcnt(0)
    buffer_atomic_add v47, v31, s[16:19], s91 offen sc1
    v_mov_b32 v8, v220
    v_lshlrev_b32 v248, 16, v212
    v_and_b32 v249, 0xffff0000, v212
    v_lshlrev_b32 v212, 16, v216
    v_and_b32 v216, 0xffff0000, v216
    v_add_f32 v248, v248, v212
    v_add_f32 v249, v249, v216
    v_lshlrev_b32 v250, 16, v213
    v_and_b32 v251, 0xffff0000, v213
    v_lshlrev_b32 v213, 16, v217
    v_and_b32 v217, 0xffff0000, v217
    v_add_f32 v250, v250, v213
    v_add_f32 v251, v251, v217
    v_lshlrev_b32 v252, 16, v214
    v_and_b32 v253, 0xffff0000, v214
    v_lshlrev_b32 v214, 16, v218
    v_and_b32 v218, 0xffff0000, v218
    v_add_f32 v252, v252, v214
    v_add_f32 v253, v253, v218
    v_lshlrev_b32 v254, 16, v215
    v_and_b32 v255, 0xffff0000, v215
    v_lshlrev_b32 v215, 16, v219
    v_and_b32 v219, 0xffff0000, v219
    v_add_f32 v254, v254, v215
    v_add_f32 v255, v255, v219
    s_branch L_p2a
L_kb:
    s_waitcnt vmcnt(4) lgkmcnt(0)
    s_barrier
    v_add_u32 v20, 0x14000, v20
    v_add_u32 v21, 0x14000, v21
    v_add_u32 v22, 0x14000, v22
    v_add_u32 v23, 0x14000, v23
    ds_read_b64_tr_b16 v[112:113], v20 offset:0
    ds_read_b64_tr_b16 v[114:115], v20 offset:1024
    v_add_u32 v24, 0x14000, v24
    v_add_u32 v25, 0x14000, v25
    v_add_u32 v26, 0x14000, v26
    v_add_u32 v27, 0x14000, v27
    ds_read_b64_tr_b16 v[240:241], v24 offset:0
    ds_read_b64_tr_b16 v[242:243], v24 offset:1024
    v_add_u32 v28, 0x10000, v28
    v_add_u32 v29, 0x10000, v29
    v_add_u32 v30, 0x10000, v30
    v_add_u32 v31, 0x10000, v31
    ds_read_b128 v[128:131], v28 offset:0
    ds_read_b64_tr_b16 v[116:117], v21 offset:0
    ds_read_b64_tr_b16 v[118:119], v21 offset:1024
    ds_read_b64_tr_b16 v[244:245], v25 offset:0
    ds_read_b64_tr_b16 v[246:247], v25 offset:1024
    ds_read_b128 v[132:135], v29 offset:0
    ds_read_b64_tr_b16 v[120:121], v22 offset:0
    ds_read_b64_tr_b16 v[122:123], v22 offset:1024
    ds_read_b64_tr_b16 v[248:249], v26 offset:0
    ds_read_b64_tr_b16 v[250:251], v26 offset:1024
    ds_read_b128 v[136:139], v30 offset:0
    ds_read_b64_tr_b16 v[124:125], v23 offset:0
    ds_read_b64_tr_b16 v[126:127], v23 offset:1024
    ds_read_b64_tr_b16 v[252:253], v27 offset:0
    ds_read_b64_tr_b16 v[254:255], v27 offset:1024
    s_add_u32 m0, s87, 131072
    ds_read_b128 v[140:143], v31 offset:0
    buffer_load_dwordx4 v3, s[8:11], s68 offen lds
    buffer_load_dwordx4 v4, s[8:11], s68 offen offset:1024 lds
    s_add_u32 m0, s87, 0
    s_nop 0
    buffer_load_dwordx4 v5, s[12:15], s75 offen lds
    buffer_load_dwordx4 v42, s[12:15], s75 offen offset:1024 lds
    s_waitcnt vmcnt(4) lgkmcnt(0)
    s_barrier
    v_mfma_f32_32x32x16_bf16 v[64:79], v[128:131], v[112:115], 0
    v_mfma_f32_16x16x32_bf16 v[12:15], v[8:11], v[112:115], 0
    ds_read_b64_tr_b16 v[112:113], v20 offset:32768
    ds_read_b64_tr_b16 v[114:115], v20 offset:33792
    v_mfma_f32_32x32x16_bf16 v[80:95], v[128:131], v[240:243], 0
    v_mfma_f32_16x16x32_bf16 v[16:19], v[8:11], v[240:243], 0
    ds_read_b64_tr_b16 v[240:241], v24 offset:32768
    ds_read_b64_tr_b16 v[242:243], v24 offset:33792
    ds_read_b128 v[144:147], v28 offset:32768
    v_mfma_f32_32x32x16_bf16 v[64:79], v[132:135], v[116:119], v[64:79]
    ds_read_b64_tr_b16 v[116:117], v21 offset:32768
    ds_read_b64_tr_b16 v[118:119], v21 offset:33792
    v_mfma_f32_32x32x16_bf16 v[80:95], v[132:135], v[244:247], v[80:95]
    ds_read_b64_tr_b16 v[244:245], v25 offset:32768
    ds_read_b64_tr_b16 v[246:247], v25 offset:33792
    ds_read_b128 v[148:151], v29 offset:32768
    v_mfma_f32_32x32x16_bf16 v[64:79], v[136:139], v[120:123], v[64:79]
    ds_read_b64_tr_b16 v[120:121], v22 offset:32768
    ds_read_b64_tr_b16 v[122:123], v22 offset:33792
    v_mfma_f32_32x32x16_bf16 v[80:95], v[136:139], v[248:251], v[80:95]
    ds_read_b64_tr_b16 v[248:249], v26 offset:32768
    ds_read_b64_tr_b16 v[250:251], v26 offset:33792
    ds_read_b128 v[152:155], v30 offset:32768
    v_mfma_f32_32x32x16_bf16 v[64:79], v[140:143], v[124:127], v[64:79]
    ds_read_b64_tr_b16 v[124:125], v23 offset:32768
    ds_read_b64_tr_b16 v[126:127], v23 offset:33792
    v_mfma_f32_32x32x16_bf16 v[80:95], v[140:143], v[252:255], v[80:95]
    ds_read_b64_tr_b16 v[252:253], v27 offset:32768
    ds_read_b64_tr_b16 v[254:255], v27 offset:33792
    s_add_u32 m0, s87, 16384
    ds_read_b128 v[156:159], v31 offset:32768
    buffer_load_dwordx4 v3, s[8:11], s69 offen lds
    buffer_load_dwordx4 v4, s[8:11], s69 offen offset:1024 lds
    s_add_u32 m0, s87, 32768
    s_nop 0
    buffer_load_dwordx4 v5, s[12:15], s76 offen lds
    buffer_load_dwordx4 v42, s[12:15], s76 offen offset:1024 lds
    s_waitcnt vmcnt(4) lgkmcnt(0)
    s_barrier
    v_mfma_f32_32x32x16_bf16 v[64:79], v[144:147], v[112:115], v[64:79]
    v_mfma_f32_16x16x32_bf16 v[12:15], v[8:11], v[112:115], v[12:15]
    v_add_u32 v20, 0xfffec000, v20
    v_add_u32 v21, 0xfffec000, v21
    v_add_u32 v22, 0xfffec000, v22
    v_add_u32 v23, 0xfffec000, v23
    ds_read_b64_tr_b16 v[112:113], v20 offset:0
    ds_read_b64_tr_b16 v[114:115], v20 offset:1024
    v_mfma_f32_32x32x16_bf16 v[80:95], v[144:147], v[240:243], v[80:95]
    v_mfma_f32_16x16x32_bf16 v[16:19], v[8:11], v[240:243], v[16:19]
    v_add_u32 v24, 0xfffec000, v24
    v_add_u32 v25, 0xfffec000, v25
    v_add_u32 v26, 0xfffec000, v26
    v_add_u32 v27, 0xfffec000, v27
    ds_read_b64_tr_b16 v[240:241], v24 offset:0
    ds_read_b64_tr_b16 v[242:243], v24 offset:1024
    v_add_u32 v28, 0x10000, v28
    v_add_u32 v29, 0x10000, v29
    v_add_u32 v30, 0x10000, v30
    v_add_u32 v31, 0x10000, v31
    ds_read_b128 v[160:163], v28 offset:0
    v_mfma_f32_32x32x16_bf16 v[64:79], v[148:151], v[116:119], v[64:79]
    ds_read_b64_tr_b16 v[116:117], v21 offset:0
    ds_read_b64_tr_b16 v[118:119], v21 offset:1024
    v_mfma_f32_32x32x16_bf16 v[80:95], v[148:151], v[244:247], v[80:95]
    ds_read_b64_tr_b16 v[244:245], v25 offset:0
    ds_read_b64_tr_b16 v[246:247], v25 offset:1024
    ds_read_b128 v[164:167], v29 offset:0
    v_mfma_f32_32x32x16_bf16 v[64:79], v[152:155], v[120:123], v[64:79]
    ds_read_b64_tr_b16 v[120:121], v22 offset:0
    ds_read_b64_tr_b16 v[122:123], v22 offset:1024
    v_mfma_f32_32x32x16_bf16 v[80:95], v[152:155], v[248:251], v[80:95]
    ds_read_b64_tr_b16 v[248:249], v26 offset:0
    ds_read_b64_tr_b16 v[250:251], v26 offset:1024
    ds_read_b128 v[168:171], v30 offset:0
    v_mfma_f32_32x32x16_bf16 v[64:79], v[156:159], v[124:127], v[64:79]
    ds_read_b64_tr_b16 v[124:125], v23 offset:0
    ds_read_b64_tr_b16 v[126:127], v23 offset:1024
    v_mfma_f32_32x32x16_bf16 v[80:95], v[156:159], v[252:255], v[80:95]
    ds_read_b64_tr_b16 v[252:253], v27 offset:0
    ds_read_b64_tr_b16 v[254:255], v27 offset:1024
    s_add_u32 m0, s87, 49152
    ds_read_b128 v[172:175], v31 offset:0
    buffer_load_dwordx4 v3, s[8:11], s70 offen lds
    buffer_load_dwordx4 v4, s[8:11], s70 offen offset:1024 lds
    s_add_u32 m0, s87, 65536
    s_nop 0
    buffer_load_dwordx4 v5, s[12:15], s77 offen lds
    buffer_load_dwordx4 v42, s[12:15], s77 offen offset:1024 lds
    s_waitcnt vmcnt(4) lgkmcnt(0)
    s_barrier
    v_mfma_f32_32x32x16_bf16 v[64:79], v[160:163], v[112:115], v[64:79]
    v_mfma_f32_16x16x32_bf16 v[12:15], v[8:11], v[112:115], v[12:15]
    ds_read_b64_tr_b16 v[112:113], v20 offset:32768
    ds_read_b64_tr_b16 v[114:115], v20 offset:33792
    v_mfma_f32_32x32x16_bf16 v[80:95], v[160:163], v[240:243], v[80:95]
    v_mfma_f32_16x16x32_bf16 v[16:19], v[8:11], v[240:243], v[16:19]
    ds_read_b64_tr_b16 v[240:241], v24 offset:32768
    ds_read_b64_tr_b16 v[242:243], v24 offset:33792
    v_add_u32 v28, 0xfffe4000, v28
    v_add_u32 v29, 0xfffe4000, v29
    v_add_u32 v30, 0xfffe4000, v30
    v_add_u32 v31, 0xfffe4000, v31
    ds_read_b128 v[176:179], v28 offset:0
    v_mfma_f32_32x32x16_bf16 v[64:79], v[164:167], v[116:119], v[64:79]
    ds_read_b64_tr_b16 v[116:117], v21 offset:32768
    ds_read_b64_tr_b16 v[118:119], v21 offset:33792
    v_mfma_f32_32x32x16_bf16 v[80:95], v[164:167], v[244:247], v[80:95]
    ds_read_b64_tr_b16 v[244:245], v25 offset:32768
    ds_read_b64_tr_b16 v[246:247], v25 offset:33792
    ds_read_b128 v[180:183], v29 offset:0
    v_mfma_f32_32x32x16_bf16 v[64:79], v[168:171], v[120:123], v[64:79]
    ds_read_b64_tr_b16 v[120:121], v22 offset:32768
    ds_read_b64_tr_b16 v[122:123], v22 offset:33792
    v_mfma_f32_32x32x16_bf16 v[80:95], v[168:171], v[248:251], v[80:95]
    ds_read_b64_tr_b16 v[248:249], v26 offset:32768
    ds_read_b64_tr_b16 v[250:251], v26 offset:33792
    ds_read_b128 v[184:187], v30 offset:0
    v_mfma_f32_32x32x16_bf16 v[64:79], v[172:175], v[124:127], v[64:79]
    ds_read_b64_tr_b16 v[124:125], v23 offset:32768
    ds_read_b64_tr_b16 v[126:127], v23 offset:33792
    v_mfma_f32_32x32x16_bf16 v[80:95], v[172:175], v[252:255], v[80:95]
    ds_read_b64_tr_b16 v[252:253], v27 offset:32768
    ds_read_b64_tr_b16 v[254:255], v27 offset:33792
    s_add_u32 m0, s87, 81920
    ds_read_b128 v[188:191], v31 offset:0
    buffer_load_dwordx4 v3, s[8:11], s71 offen lds
    buffer_load_dwordx4 v4, s[8:11], s71 offen offset:1024 lds
    s_add_u32 m0, s87, 98304
    s_nop 0
    buffer_load_dwordx4 v5, s[12:15], s78 offen lds
    buffer_load_dwordx4 v42, s[12:15], s78 offen offset:1024 lds
    s_waitcnt vmcnt(4) lgkmcnt(0)
    s_barrier
    v_mfma_f32_32x32x16_bf16 v[64:79], v[176:179], v[112:115], v[64:79]
    v_mfma_f32_16x16x32_bf16 v[12:15], v[8:11], v[112:115], v[12:15]
    v_add_u32 v20, 0x10000, v20
    v_add_u32 v21, 0x10000, v21
    v_add_u32 v22, 0x10000, v22
    v_add_u32 v23, 0x10000, v23
    ds_read_b64_tr_b16 v[112:113], v20 offset:0
    ds_read_b64_tr_b16 v[114:115], v20 offset:1024
    v_mfma_f32_32x32x16_bf16 v[80:95], v[176:179], v[240:243], v[80:95]
    v_mfma_f32_16x16x32_bf16 v[16:19], v[8:11], v[240:243], v[16:19]
    v_add_u32 v24, 0x10000, v24
    v_add_u32 v25, 0x10000, v25
    v_add_u32 v26, 0x10000, v26
    v_add_u32 v27, 0x10000, v27
    ds_read_b64_tr_b16 v[240:241], v24 offset:0
    ds_read_b64_tr_b16 v[242:243], v24 offset:1024
    ds_read_b128 v[192:195], v28 offset:32768
    v_mfma_f32_32x32x16_bf16 v[64:79], v[180:183], v[116:119], v[64:79]
    ds_read_b64_tr_b16 v[116:117], v21 offset:0
    ds_read_b64_tr_b16 v[118:119], v21 offset:1024
    v_mfma_f32_32x32x16_bf16 v[80:95], v[180:183], v[244:247], v[80:95]
    ds_read_b64_tr_b16 v[244:245], v25 offset:0
    ds_read_b64_tr_b16 v[246:247], v25 offset:1024
    ds_read_b128 v[196:199], v29 offset:32768
    v_mfma_f32_32x32x16_bf16 v[64:79], v[184:187], v[120:123], v[64:79]
    ds_read_b64_tr_b16 v[120:121], v22 offset:0
    ds_read_b64_tr_b16 v[122:123], v22 offset:1024
    v_mfma_f32_32x32x16_bf16 v[80:95], v[184:187], v[248:251], v[80:95]
    ds_read_b64_tr_b16 v[248:249], v26 offset:0
    ds_read_b64_tr_b16 v[250:251], v26 offset:1024
    ds_read_b128 v[200:203], v30 offset:32768
    v_mfma_f32_32x32x16_bf16 v[64:79], v[188:191], v[124:127], v[64:79]
    ds_read_b64_tr_b16 v[124:125], v23 offset:0
    ds_read_b64_tr_b16 v[126:127], v23 offset:1024
    v_mfma_f32_32x32x16_bf16 v[80:95], v[188:191], v[252:255], v[80:95]
    ds_read_b64_tr_b16 v[252:253], v27 offset:0
    ds_read_b64_tr_b16 v[254:255], v27 offset:1024
    ds_read_b128 v[204:207], v31 offset:32768
    buffer_load_dword v44, v46, s[40:43], 0 offen sc1
    s_add_u32 m0, s87, 114688
    s_nop 0
    buffer_load_dwordx4 v3, s[8:11], s72 offen lds
    buffer_load_dwordx4 v4, s[8:11], s72 offen offset:1024 lds
    s_add_u32 m0, s87, 131072
    s_nop 0
    buffer_load_dwordx4 v5, s[12:15], s79 offen lds
    buffer_load_dwordx4 v42, s[12:15], s79 offen offset:1024 lds
    s_waitcnt vmcnt(5) lgkmcnt(0)
    s_barrier
    v_mfma_f32_32x32x16_bf16 v[64:79], v[192:195], v[112:115], v[64:79]
    v_mfma_f32_16x16x32_bf16 v[12:15], v[8:11], v[112:115], v[12:15]
    ds_read_b64_tr_b16 v[112:113], v20 offset:32768
    ds_read_b64_tr_b16 v[114:115], v20 offset:33792
    v_mfma_f32_32x32x16_bf16 v[80:95], v[192:195], v[240:243], v[80:95]
    v_mfma_f32_16x16x32_bf16 v[16:19], v[8:11], v[240:243], v[16:19]
    ds_read_b64_tr_b16 v[240:241], v24 offset:32768
    ds_read_b64_tr_b16 v[242:243], v24 offset:33792
    v_add_u32 v28, 0x10000, v28
    v_add_u32 v29, 0x10000, v29
    v_add_u32 v30, 0x10000, v30
    v_add_u32 v31, 0x10000, v31
    ds_read_b128 v[208:211], v28 offset:0
    v_mfma_f32_32x32x16_bf16 v[64:79], v[196:199], v[116:119], v[64:79]
    ds_read_b64_tr_b16 v[116:117], v21 offset:32768
    ds_read_b64_tr_b16 v[118:119], v21 offset:33792
    v_mfma_f32_32x32x16_bf16 v[80:95], v[196:199], v[244:247], v[80:95]
    ds_read_b64_tr_b16 v[244:245], v25 offset:32768
    ds_read_b64_tr_b16 v[246:247], v25 offset:33792
    ds_read_b128 v[212:215], v29 offset:0
    v_mfma_f32_32x32x16_bf16 v[64:79], v[200:203], v[120:123], v[64:79]
    ds_read_b64_tr_b16 v[120:121], v22 offset:32768
    ds_read_b64_tr_b16 v[122:123], v22 offset:33792
    v_mfma_f32_32x32x16_bf16 v[80:95], v[200:203], v[248:251], v[80:95]
    ds_read_b64_tr_b16 v[248:249], v26 offset:32768
    ds_read_b64_tr_b16 v[250:251], v26 offset:33792
    ds_read_b128 v[216:219], v30 offset:0
    v_mfma_f32_32x32x16_bf16 v[64:79], v[204:207], v[124:127], v[64:79]
    ds_read_b64_tr_b16 v[124:125], v23 offset:32768
    ds_read_b64_tr_b16 v[126:127], v23 offset:33792
    v_mfma_f32_32x32x16_bf16 v[80:95], v[204:207], v[252:255], v[80:95]
    ds_read_b64_tr_b16 v[252:253], v27 offset:32768
    ds_read_b64_tr_b16 v[254:255], v27 offset:33792
    ds_read_b128 v[220:223], v31 offset:0
    v_add_u32 v5, 896, v5
    s_add_u32 m0, s87, 0
    v_add_u32 v42, 896, v42
    buffer_load_dwordx4 v5, s[12:15], s73 offen lds
    buffer_load_dwordx4 v42, s[12:15], s73 offen offset:1024 lds
    s_add_u32 m0, s87, 16384
    v_add_u32 v3, 6144, v2
    buffer_load_dwordx4 v5, s[12:15], s74 offen lds
    buffer_load_dwordx4 v42, s[12:15], s74 offen offset:1024 lds
    s_waitcnt vmcnt(4) lgkmcnt(0)
    s_barrier
    v_mfma_f32_32x32x16_bf16 v[64:79], v[208:211], v[112:115], v[64:79]
    v_mfma_f32_16x16x32_bf16 v[12:15], v[8:11], v[112:115], v[12:15]
    v_add_u32 v20, 0x10000, v20
    v_add_u32 v21, 0x10000, v21
    v_add_u32 v22, 0x10000, v22
    v_add_u32 v23, 0x10000, v23
    ds_read_b64_tr_b16 v[112:113], v20 offset:0
    ds_read_b64_tr_b16 v[114:115], v20 offset:1024
    v_mfma_f32_32x32x16_bf16 v[80:95], v[208:211], v[240:243], v[80:95]
    v_mfma_f32_16x16x32_bf16 v[16:19], v[8:11], v[240:243], v[16:19]
    v_add_u32 v24, 0x10000, v24
    v_add_u32 v25, 0x10000, v25
    v_add_u32 v26, 0x10000, v26
    v_add_u32 v27, 0x10000, v27
    ds_read_b64_tr_b16 v[240:241], v24 offset:0
    ds_read_b64_tr_b16 v[242:243], v24 offset:1024
    ds_read_b128 v[224:227], v28 offset:32768
    v_mfma_f32_32x32x16_bf16 v[64:79], v[212:215], v[116:119], v[64:79]
    ds_read_b64_tr_b16 v[116:117], v21 offset:0
    ds_read_b64_tr_b16 v[118:119], v21 offset:1024
    v_mfma_f32_32x32x16_bf16 v[80:95], v[212:215], v[244:247], v[80:95]
    ds_read_b64_tr_b16 v[244:245], v25 offset:0
    ds_read_b64_tr_b16 v[246:247], v25 offset:1024
    ds_read_b128 v[228:231], v29 offset:32768
    v_mfma_f32_32x32x16_bf16 v[64:79], v[216:219], v[120:123], v[64:79]
    ds_read_b64_tr_b16 v[120:121], v22 offset:0
    ds_read_b64_tr_b16 v[122:123], v22 offset:1024
    v_mfma_f32_32x32x16_bf16 v[80:95], v[216:219], v[248:251], v[80:95]
    ds_read_b64_tr_b16 v[248:249], v26 offset:0
    ds_read_b64_tr_b16 v[250:251], v26 offset:1024
    ds_read_b128 v[232:235], v30 offset:32768
    v_mfma_f32_32x32x16_bf16 v[64:79], v[220:223], v[124:127], v[64:79]
    ds_read_b64_tr_b16 v[124:125], v23 offset:0
    ds_read_b64_tr_b16 v[126:127], v23 offset:1024
    v_mfma_f32_32x32x16_bf16 v[80:95], v[220:223], v[252:255], v[80:95]
    ds_read_b64_tr_b16 v[252:253], v27 offset:0
    ds_read_b64_tr_b16 v[254:255], v27 offset:1024
    ds_read_b128 v[236:239], v31 offset:32768
    v_cmp_le_u32 vcc, 32, v44
    s_nop 0
    s_andn2_b32 s95, 0x1, vcc_lo
    s_cbranch_scc1 L_slow6
L_ret6:
    s_add_u32 m0, s87, 32768
    s_nop 0
    buffer_load_dwordx4 v5, s[12:15], s75 offen lds
    buffer_load_dwordx4 v42, s[12:15], s75 offen offset:1024 lds
    s_add_u32 m0, s87, 49152
    s_nop 0
    buffer_load_dwordx4 v5, s[12:15], s76 offen lds
    buffer_load_dwordx4 v42, s[12:15], s76 offen offset:1024 lds
    s_waitcnt vmcnt(6) lgkmcnt(0)
    s_barrier
    v_mfma_f32_32x32x16_bf16 v[64:79], v[224:227], v[112:115], v[64:79]
    v_mfma_f32_16x16x32_bf16 v[12:15], v[8:11], v[112:115], v[12:15]
    v_mfma_f32_32x32x16_bf16 v[80:95], v[224:227], v[240:243], v[80:95]
    v_mfma_f32_16x16x32_bf16 v[16:19], v[8:11], v[240:243], v[16:19]
    v_mfma_f32_32x32x16_bf16 v[64:79], v[228:231], v[116:119], v[64:79]
    v_mfma_f32_32x32x16_bf16 v[80:95], v[228:231], v[244:247], v[80:95]
    v_mfma_f32_32x32x16_bf16 v[64:79], v[232:235], v[120:123], v[64:79]
    v_mfma_f32_32x32x16_bf16 v[80:95], v[232:235], v[248:251], v[80:95]
    s_nop 1
    ds_write_b32 v6, v12 offset:512
    s_nop 0
    ds_write_b32 v6, v16 offset:1024
    v_mfma_f32_32x32x16_bf16 v[64:79], v[236:239], v[124:127], v[64:79]
    s_add_u32 m0, s87, 65536
    v_mfma_f32_32x32x16_bf16 v[80:95], v[236:239], v[252:255], v[80:95]
    buffer_load_dwordx4 v5, s[12:15], s77 offen lds
    buffer_load_dwordx4 v42, s[12:15], s77 offen offset:1024 lds
    buffer_load_dword v38, v39, s[16:19], s90 offen sc1
    s_waitcnt vmcnt(5) lgkmcnt(0)
    s_barrier
    ds_read_b128 v[52:55], v7 offset:512
    s_add_u32 m0, s87, 81920
    ds_read_b128 v[56:59], v7 offset:1024
    buffer_load_dwordx4 v5, s[12:15], s78 offen lds
    buffer_load_dwordx4 v42, s[12:15], s78 offen offset:1024 lds
    s_waitcnt lgkmcnt(1)
    v_add_f32 v52, v52, v53
    v_add_f32 v54, v54, v55
    v_add_f32 v52, v52, v54
    v_cvt_pk_bf16_f32 v53, v52, v52
    v_lshlrev_b32 v53, 16, v53
    v_sub_f32 v53, v52, v53
    v_cvt_pk_bf16_f32 v32, v52, v53
    s_waitcnt lgkmcnt(0)
    v_add_f32 v56, v56, v57
    v_add_f32 v58, v58, v59
    v_add_f32 v56, v56, v58
    v_cvt_pk_bf16_f32 v57, v56, v56
    v_lshlrev_b32 v57, 16, v57
    v_sub_f32 v57, v56, v57
    s_add_u32 m0, s87, 98304
    v_cvt_pk_bf16_f32 v34, v56, v57
    buffer_load_dwordx4 v5, s[12:15], s79 offen lds
    buffer_load_dwordx4 v42, s[12:15], s79 offen offset:1024 lds
    s_mul_i32 s82, s4, 10240
    s_add_u32 s82, s82, 122880
    v_add_u32 v28, s82, v1
    s_waitcnt vmcnt(4)
    v_cmp_le_u32 vcc, 1, v38
    s_nop 0
    s_andn2_b32 s95, 0xffffffff, vcc_lo
    s_cbranch_scc1 L_slow7
L_ret7:
    v_and_b32 v48, 0xffff, v38
    v_lshl_or_b32 v48, v38, 16, v48
    v_cndmask_b32 v36, v48, 0, s[92:93]
    v_and_b32 v49, 0xffff0000, v38
    v_rcp_f32 v49, v49
    s_setprio 2
    v_mfma_f32_32x32x8_bf16 v[64:79], v[36:37], v[32:33], v[64:79]
    v_mfma_f32_32x32x8_bf16 v[80:95], v[36:37], v[34:35], v[80:95]
    s_setprio 0
    ds_write_b32 v40, v49
    ds_read_b128 v[112:115], v43 offset:0
    ds_read_b128 v[116:119], v43 offset:32
    ds_read_b128 v[120:123], v43 offset:64
    ds_read_b128 v[124:127], v43 offset:96
    s_waitcnt lgkmcnt(0)
    s_nop 3
    v_fma_f32 v64, v64, v112, s85
    v_fma_f32 v65, v65, v113, s85
    v_fma_f32 v66, v66, v114, s85
    v_fma_f32 v67, v67, v115, s85
    v_mul_f32 v48, s99, v64
    v_mul_f32 v49, s99, v65
    v_mul_f32 v50, s99, v66
    v_mul_f32 v51, s99, v67
    v_exp_f32_e64 v48, v48 clamp
    v_exp_f32_e64 v49, v49 clamp
    v_exp_f32_e64 v50, v50 clamp
    v_exp_f32_e64 v51, v51 clamp
    v_max_f32 v64, s85, v64
    v_max_f32 v65, s85, v65
    v_max_f32 v66, s85, v66
    v_max_f32 v67, s85, v67
    v_add_f32 v64, v64, v48
    v_add_f32 v65, v65, v49
    v_add_f32 v66, v66, v50
    v_add_f32 v67, v67, v51
    v_cvt_pk_bf16_f32 v64, v64, v65
    v_cvt_pk_bf16_f32 v65, v66, v67
    v_fma_f32 v68, v68, v116, s85
    s_waitcnt lgkmcnt(0)
    s_barrier
    v_fma_f32 v69, v69, v117, s85
    v_fma_f32 v70, v70, v118, s85
    v_fma_f32 v71, v71, v119, s85
    v_mul_f32 v48, s99, v68
    v_mul_f32 v49, s99, v69
    v_mul_f32 v50, s99, v70
    v_mul_f32 v51, s99, v71
    v_exp_f32_e64 v48, v48 clamp
    v_exp_f32_e64 v49, v49 clamp
    v_exp_f32_e64 v50, v50 clamp
    v_exp_f32_e64 v51, v51 clamp
    v_max_f32 v68, s85, v68
    v_max_f32 v69, s85, v69
    v_max_f32 v70, s85, v70
    v_max_f32 v71, s85, v71
    v_add_f32 v68, v68, v48
    v_add_f32 v69, v69, v49
    v_add_f32 v70, v70, v50
    v_add_f32 v71, v71, v51
    v_cvt_pk_bf16_f32 v66, v68, v69
    v_cvt_pk_bf16_f32 v67, v70, v71
    v_fma_f32 v72, v72, v120, s85
    v_fma_f32 v73, v73, v121, s85
    v_fma_f32 v74, v74, v122, s85
    v_fma_f32 v75, v75, v123, s85
    v_mul_f32 v48, s99, v72
    v_mul_f32 v49, s99, v73
    v_mul_f32 v50, s99, v74
    v_mul_f32 v51, s99, v75
    v_exp_f32_e64 v48, v48 clamp
    v_exp_f32_e64 v49, v49 clamp
    v_exp_f32_e64 v50, v50 clamp
    v_exp_f32_e64 v51, v51 clamp
    v_max_f32 v72, s85, v72
    v_max_f32 v73, s85, v73
    v_max_f32 v74, s85, v74
    v_max_f32 v75, s85, v75
    v_add_f32 v72, v72, v48
    v_add_f32 v73, v73, v49
    v_add_f32 v74, v74, v50
    v_add_f32 v75, v75, v51
    v_cvt_pk_bf16_f32 v68, v72, v73
    v_cvt_pk_bf16_f32 v69, v74, v75
    v_fma_f32 v76, v76, v124, s85
    v_fma_f32 v77, v77, v125, s85
    v_fma_f32 v78, v78, v126, s85
    v_fma_f32 v79, v79, v127, s85
    v_mul_f32 v48, s99, v76
    v_mul_f32 v49, s99, v77
    v_mul_f32 v50, s99, v78
    v_mul_f32 v51, s99, v79
    v_exp_f32_e64 v48, v48 clamp
    v_exp_f32_e64 v49, v49 clamp
    v_exp_f32_e64 v50, v50 clamp
    v_exp_f32_e64 v51, v51 clamp
    v_max_f32 v76, s85, v76
    v_max_f32 v77, s85, v77
    v_max_f32 v78, s85, v78
    v_max_f32 v79, s85, v79
    v_add_f32 v76, v76, v48
    v_add_f32 v77, v77, v49
    v_add_f32 v78, v78, v50
    v_add_f32 v79, v79, v51
    v_cvt_pk_bf16_f32 v70, v76, v77
    v_cvt_pk_bf16_f32 v71, v78, v79
    ds_write_b128 v28, v[64:67] offset:0
    ds_write_b128 v28, v[68:71] offset:1024
    v_add_u32 v24, 0xfffe0000, v24
    v_fma_f32 v80, v80, v112, s85
    v_fma_f32 v81, v81, v113, s85
    v_fma_f32 v82, v82, v114, s85
    v_fma_f32 v83, v83, v115, s85
    v_mul_f32 v48, s99, v80
    v_mul_f32 v49, s99, v81
    v_mul_f32 v50, s99, v82
    v_mul_f32 v51, s99, v83
    v_add_u32 v25, 0xfffe0000, v25
    v_exp_f32_e64 v48, v48 clamp
    v_exp_f32_e64 v49, v49 clamp
    v_exp_f32_e64 v50, v50 clamp
    s_waitcnt vmcnt(0) lgkmcnt(0)
    s_barrier
    v_exp_f32_e64 v51, v51 clamp
    v_max_f32 v80, s85, v80
    v_max_f32 v81, s85, v81
    v_max_f32 v82, s85, v82
    v_add_u32 v26, 0xfffe0000, v26
    v_max_f32 v83, s85, v83
    v_add_f32 v80, v80, v48
    v_add_f32 v81, v81, v49
    v_add_f32 v82, v82, v50
    v_add_f32 v83, v83, v51
    v_cvt_pk_bf16_f32 v80, v80, v81
    v_cvt_pk_bf16_f32 v81, v82, v83
    v_add_u32 v27, 0xfffe0000, v27
    v_fma_f32 v84, v84, v116, s85
    v_fma_f32 v85, v85, v117, s85
    v_fma_f32 v86, v86, v118, s85
    v_fma_f32 v87, v87, v119, s85
    s_mul_i32 s95, s6, 6
    s_add_u32 s95, s95, s96
    s_lshl2_add_u32 s95, s95, s4
    v_min_u32 v56, 512, v1
    s_mul_i32 s88, s95, 4224
    v_lshlrev_b32 v56, 3, v56
    buffer_load_dword v57, v56, s[20:23], s88 offen
    v_mul_f32 v48, s99, v84
    v_mul_f32 v49, s99, v85
    v_mul_f32 v50, s99, v86
    v_mul_f32 v51, s99, v87
    ds_read_b64_tr_b16 v[240:241], v24 offset:0
    v_exp_f32_e64 v48, v48 clamp
    v_exp_f32_e64 v49, v49 clamp
    v_exp_f32_e64 v50, v50 clamp
    v_exp_f32_e64 v51, v51 clamp
    v_max_f32 v84, s85, v84
    v_max_f32 v85, s85, v85
    v_max_f32 v86, s85, v86
    ds_read_b64_tr_b16 v[242:243], v24 offset:1024
    v_max_f32 v87, s85, v87
    v_add_f32 v84, v84, v48
    v_add_f32 v85, v85, v49
    v_add_f32 v86, v86, v50
    v_add_f32 v87, v87, v51
    v_cvt_pk_bf16_f32 v82, v84, v85
    v_cvt_pk_bf16_f32 v83, v86, v87
    ds_read_b64_tr_b16 v[244:245], v25 offset:0
    v_fma_f32 v88, v88, v120, s85
    v_fma_f32 v89, v89, v121, s85
    v_fma_f32 v90, v90, v122, s85
    v_fma_f32 v91, v91, v123, s85
    v_mul_f32 v48, s99, v88
    v_mul_f32 v49, s99, v89
    v_mul_f32 v50, s99, v90
    v_mul_f32 v51, s99, v91
    ds_read_b64_tr_b16 v[246:247], v25 offset:1024
    v_exp_f32_e64 v48, v48 clamp
    v_exp_f32_e64 v49, v49 clamp
    v_exp_f32_e64 v50, v50 clamp
    v_exp_f32_e64 v51, v51 clamp
    v_max_f32 v88, s85, v88
    v_min_u32 v56, 1024, v56
    s_mul_i32 s88, s95, 1152
    buffer_load_dword v57, v56, s[24:27], s88 offen
    v_max_f32 v89, s85, v89
    v_max_f32 v90, s85, v90
    ds_read_b64_tr_b16 v[248:249], v26 offset:0
    v_max_f32 v91, s85, v91
    v_add_f32 v88, v88, v48
    v_add_f32 v89, v89, v49
    v_add_f32 v90, v90, v50
    v_add_f32 v91, v91, v51
    v_cvt_pk_bf16_f32 v84, v88, v89
    v_cvt_pk_bf16_f32 v85, v90, v91
    ds_read_b64_tr_b16 v[250:251], v26 offset:1024
    v_fma_f32 v92, v92, v124, s85
    v_fma_f32 v93, v93, v125, s85
    v_fma_f32 v94, v94, v126, s85
    v_fma_f32 v95, v95, v127, s85
    v_mul_f32 v48, s99, v92
    v_mul_f32 v49, s99, v93
    v_mul_f32 v50, s99, v94
    v_mul_f32 v51, s99, v95
    ds_read_b64_tr_b16 v[252:253], v27 offset:0
    v_exp_f32_e64 v48, v48 clamp
    v_exp_f32_e64 v49, v49 clamp
    v_exp_f32_e64 v50, v50 clamp
    v_exp_f32_e64 v51, v51 clamp
    v_max_f32 v92, s85, v92
    v_max_f32 v93, s85, v93
    v_max_f32 v94, s85, v94
    ds_read_b64_tr_b16 v[254:255], v27 offset:1024
    v_max_f32 v95, s85, v95
    v_add_f32 v92, v92, v48
    v_add_f32 v93, v93, v49
    v_add_f32 v94, v94, v50
    v_add_f32 v95, v95, v51
    v_cvt_pk_bf16_f32 v86, v92, v93
    v_cvt_pk_bf16_f32 v87, v94, v95
    ds_read_b128 v[112:115], v41 offset:0
    ds_read_b128 v[116:119], v41 offset:32
    ds_read_b128 v[120:123], v41 offset:64
    ds_read_b128 v[124:127], v41 offset:96
    v_cndmask_b32 v29, 0, 1.0, s[100:101]
    s_lshl_b32 s82, s4, 12
    s_add_u32 s82, s82, 49152
    v_add_u32 v30, s82, v1
    s_waitcnt lgkmcnt(0)
    s_barrier
    s_setprio 1
    v_mfma_f32_32x32x16_bf16 v[96:111], v[128:131], v[240:243], 0
    v_mfma_f32_16x16x32_bf16 v[16:19], v[8:11], v[240:243], 0
    ds_read_b64_tr_b16 v[240:241], v24 offset:16384
    ds_read_b64_tr_b16 v[242:243], v24 offset:17408
    v_mfma_f32_32x32x16_bf16 v[96:111], v[132:135], v[244:247], v[96:111]
    ds_read_b64_tr_b16 v[244:245], v25 offset:16384
    ds_read_b64_tr_b16 v[246:247], v25 offset:17408
    v_mfma_f32_32x32x16_bf16 v[96:111], v[136:139], v[248:251], v[96:111]
    ds_read_b64_tr_b16 v[248:249], v26 offset:16384
    ds_read_b64_tr_b16 v[250:251], v26 offset:17408
    v_mfma_f32_32x32x16_bf16 v[96:111], v[140:143], v[252:255], v[96:111]
    ds_read_b64_tr_b16 v[252:253], v27 offset:16384
    ds_read_b64_tr_b16 v[254:255], v27 offset:17408
    s_waitcnt lgkmcnt(4)
    v_mfma_f32_32x32x16_bf16 v[96:111], v[144:147], v[240:243], v[96:111]
    v_mfma_f32_16x16x32_bf16 v[16:19], v[8:11], v[240:243], v[16:19]
    ds_read_b64_tr_b16 v[240:241], v24 offset:32768
    ds_read_b64_tr_b16 v[242:243], v24 offset:33792
    v_mfma_f32_32x32x16_bf16 v[96:111], v[148:151], v[244:247], v[96:111]
    ds_read_b64_tr_b16 v[244:245], v25 offset:32768
    ds_read_b64_tr_b16 v[246:247], v25 offset:33792
    s_waitcnt lgkmcnt(4)
    v_mfma_f32_32x32x16_bf16 v[96:111], v[152:155], v[248:251], v[96:111]
    ds_read_b64_tr_b16 v[248:249], v26 offset:32768
    ds_read_b64_tr_b16 v[250:251], v26 offset:33792
    v_mfma_f32_32x32x16_bf16 v[96:111], v[156:159], v[252:255], v[96:111]
    ds_read_b64_tr_b16 v[252:253], v27 offset:32768
    ds_read_b64_tr_b16 v[254:255], v27 offset:33792
    s_waitcnt lgkmcnt(4)
    v_mfma_f32_32x32x16_bf16 v[96:111], v[160:163], v[240:243], v[96:111]
    v_mfma_f32_16x16x32_bf16 v[16:19], v[8:11], v[240:243], v[16:19]
    ds_read_b64_tr_b16 v[240:241], v24 offset:49152
    ds_read_b64_tr_b16 v[242:243], v24 offset:50176
    v_mfma_f32_32x32x16_bf16 v[96:111], v[164:167], v[244:247], v[96:111]
    ds_read_b64_tr_b16 v[244:245], v25 offset:49152
    ds_read_b64_tr_b16 v[246:247], v25 offset:50176
    s_waitcnt lgkmcnt(4)
    v_mfma_f32_32x32x16_bf16 v[96:111], v[168:171], v[248:251], v[96:111]
    ds_read_b64_tr_b16 v[248:249], v26 offset:49152
    ds_read_b64_tr_b16 v[250:251], v26 offset:50176
    v_mfma_f32_32x32x16_bf16 v[96:111], v[172:175], v[252:255], v[96:111]
    ds_read_b64_tr_b16 v[252:253], v27 offset:49152
    ds_read_b64_tr_b16 v[254:255], v27 offset:50176
    s_waitcnt lgkmcnt(0)
    s_barrier
    v_mfma_f32_32x32x16_bf16 v[96:111], v[176:179], v[240:243], v[96:111]
    v_mfma_f32_16x16x32_bf16 v[16:19], v[8:11], v[240:243], v[16:19]
    v_add_u32 v24, 0x10000, v24
    v_add_u32 v25, 0x10000, v25
    v_add_u32 v26, 0x10000, v26
    v_add_u32 v27, 0x10000, v27
    ds_read_b64_tr_b16 v[240:241], v24 offset:0
    ds_read_b64_tr_b16 v[242:243], v24 offset:1024
    v_mfma_f32_32x32x16_bf16 v[96:111], v[180:183], v[244:247], v[96:111]
    ds_read_b64_tr_b16 v[244:245], v25 offset:0
    ds_read_b64_tr_b16 v[246:247], v25 offset:1024
    v_mfma_f32_32x32x16_bf16 v[96:111], v[184:187], v[248:251], v[96:111]
    ds_read_b64_tr_b16 v[248:249], v26 offset:0
    ds_read_b64_tr_b16 v[250:251], v26 offset:1024
    v_mfma_f32_32x32x16_bf16 v[96:111], v[188:191], v[252:255], v[96:111]
    ds_read_b64_tr_b16 v[252:253], v27 offset:0
    ds_read_b64_tr_b16 v[254:255], v27 offset:1024
    s_lshr_b32 s73, s80, 1
    s_lshl2_add_u32 s73, s73, s4
    s_mul_i32 s73, s73, 896
    s_add_u32 s73, s73, 0x911000
    v_cmp_gt_u32 vcc, 32, v1
    v_lshlrev_b32 v31, 3, v1
    s_nop 0
    v_cndmask_b32 v31, v46, v31, vcc
    buffer_load_dword v44, v31, s[16:19], s73 offen offset:0 sc1
    s_waitcnt lgkmcnt(4)
    v_mfma_f32_32x32x16_bf16 v[96:111], v[192:195], v[240:243], v[96:111]
    v_mfma_f32_16x16x32_bf16 v[16:19], v[8:11], v[240:243], v[16:19]
    ds_read_b64_tr_b16 v[240:241], v24 offset:16384
    ds_read_b64_tr_b16 v[242:243], v24 offset:17408
    v_mfma_f32_32x32x16_bf16 v[96:111], v[196:199], v[244:247], v[96:111]
    ds_read_b64_tr_b16 v[244:245], v25 offset:16384
    ds_read_b64_tr_b16 v[246:247], v25 offset:17408
    v_lshrrev_b32 v72, 3, v0
    v_and_b32 v73, 0x70, v1
    v_mul_u32_u24 v72, 896, v72
    s_lshl_b32 s95, s7, 7
    v_add_u32 v72, v72, v73
    buffer_load_dwordx4 v[64:67], v72, s[8:11], s63 offen
    s_waitcnt lgkmcnt(4)
    v_mfma_f32_32x32x16_bf16 v[96:111], v[200:203], v[248:251], v[96:111]
    ds_read_b64_tr_b16 v[248:249], v26 offset:16384
    ds_read_b64_tr_b16 v[250:251], v26 offset:17408
    v_mfma_f32_32x32x16_bf16 v[96:111], v[204:207], v[252:255], v[96:111]
    ds_read_b64_tr_b16 v[252:253], v27 offset:16384
    ds_read_b64_tr_b16 v[254:255], v27 offset:17408
    buffer_load_dwordx4 v[68:71], v73, s[36:39], s95 offen
    s_waitcnt lgkmcnt(4)
    v_mfma_f32_32x32x16_bf16 v[96:111], v[208:211], v[240:243], v[96:111]
    v_mfma_f32_16x16x32_bf16 v[16:19], v[8:11], v[240:243], v[16:19]
    ds_read_b64_tr_b16 v[240:241], v24 offset:32768
    ds_read_b64_tr_b16 v[242:243], v24 offset:33792
    v_mfma_f32_32x32x16_bf16 v[96:111], v[212:215], v[244:247], v[96:111]
    ds_read_b64_tr_b16 v[244:245], v25 offset:32768
    ds_read_b64_tr_b16 v[246:247], v25 offset:33792
    s_waitcnt lgkmcnt(4)
    v_mfma_f32_32x32x16_bf16 v[96:111], v[216:219], v[248:251], v[96:111]
    ds_read_b64_tr_b16 v[248:249], v26 offset:32768
    ds_read_b64_tr_b16 v[250:251], v26 offset:33792
    v_mfma_f32_32x32x16_bf16 v[96:111], v[220:223], v[252:255], v[96:111]
    ds_read_b64_tr_b16 v[252:253], v27 offset:32768
    ds_read_b64_tr_b16 v[254:255], v27 offset:33792
    s_waitcnt lgkmcnt(4)
    v_mfma_f32_32x32x16_bf16 v[96:111], v[224:227], v[240:243], v[96:111]
    v_mfma_f32_16x16x32_bf16 v[16:19], v[8:11], v[240:243], v[16:19]
    v_mfma_f32_32x32x16_bf16 v[96:111], v[228:231], v[244:247], v[96:111]
    s_waitcnt lgkmcnt(0)
    v_mfma_f32_32x32x16_bf16 v[96:111], v[232:235], v[248:251], v[96:111]
    s_nop 4
    ds_write_b32 v6, v16 offset:2560
    v_mfma_f32_32x32x16_bf16 v[96:111], v[236:239], v[252:255], v[96:111]
    s_waitcnt lgkmcnt(0)
    s_barrier
    s_setprio 2
    ds_read_b128 v[52:55], v7 offset:2560
    s_waitcnt lgkmcnt(0)
    v_add_f32 v52, v52, v53
    v_add_f32 v54, v54, v55
    v_add_f32 v52, v52, v54
    v_cvt_pk_bf16_f32 v53, v52, v52
    v_lshlrev_b32 v53, 16, v53
    v_sub_f32 v53, v52, v53
    v_cvt_pk_bf16_f32 v32, v52, v53
    s_nop 1
    v_mfma_f32_32x32x8_bf16 v[96:111], v[36:37], v[32:33], v[96:111]
    v_add_u32 v12, 147456, v1
    s_mul_i32 s82, s4, 7168
    s_add_u32 s96, s61, s82
    s_add_u32 s96, s96, 114688
    s_add_u32 s68, s96, 4096
    s_mul_i32 s82, s4, 28672
    s_add_u32 s61, s61, s82
    s_waitcnt vmcnt(2)
    v_cmp_ne_u32 vcc, 0, v44
    s_nop 0
    s_andn2_b32 s95, 3, vcc_lo
    s_cbranch_scc1 L_slow8
L_ret8:
    s_xor_b32 s82, s89, 0
    s_lshl_b32 s82, s82, 10
    s_add_u32 s82, s82, s61
    buffer_load_dwordx4 v[128:131], v1, s[16:19], s82 offen sc1
    v_fma_f32 v96, v96, v112, v29
    v_fma_f32 v97, v97, v113, v29
    v_fma_f32 v98, v98, v114, v29
    v_fma_f32 v99, v99, v115, v29
    buffer_load_dwordx4 v[132:135], v12, s[16:19], s82 offen sc1
    v_fma_f32 v100, v100, v116, v29
    v_fma_f32 v101, v101, v117, v29
    v_fma_f32 v102, v102, v118, v29
    v_fma_f32 v103, v103, v119, v29
    v_cvt_pk_bf16_f32 v96, v96, v97
    s_xor_b32 s82, s89, 1
    s_lshl_b32 s82, s82, 10
    s_add_u32 s82, s82, s61
    buffer_load_dwordx4 v[136:139], v1, s[16:19], s82 offen sc1
    v_cvt_pk_bf16_f32 v97, v98, v99
    v_cvt_pk_bf16_f32 v98, v100, v101
    v_cvt_pk_bf16_f32 v99, v102, v103
    v_fma_f32 v104, v104, v120, v29
    buffer_load_dwordx4 v[140:143], v12, s[16:19], s82 offen sc1
    v_fma_f32 v105, v105, v121, v29
    v_fma_f32 v106, v106, v122, v29
    v_fma_f32 v107, v107, v123, v29
    v_fma_f32 v108, v108, v124, v29
    v_fma_f32 v109, v109, v125, v29
    s_xor_b32 s82, s89, 2
    s_lshl_b32 s82, s82, 10
    s_add_u32 s82, s82, s61
    buffer_load_dwordx4 v[144:147], v1, s[16:19], s82 offen sc1
    v_fma_f32 v110, v110, v126, v29
    v_fma_f32 v111, v111, v127, v29
    v_cvt_pk_bf16_f32 v104, v104, v105
    v_cvt_pk_bf16_f32 v105, v106, v107
    v_cvt_pk_bf16_f32 v106, v108, v109
    buffer_load_dwordx4 v[148:151], v12, s[16:19], s82 offen sc1
    v_cvt_pk_bf16_f32 v107, v110, v111
    s_setprio 2
    v_mfma_f32_32x32x16_bf16 v[208:223], v[80:83], v[96:99], 0
    v_mfma_f32_32x32x16_bf16 v[208:223], v[84:87], v[104:107], v[208:223]
    s_nop 11
    ds_write_b128 v30, v[208:211] offset:32768
    ds_write_b128 v30, v[212:215] offset:33792
    ds_write_b128 v30, v[216:219] offset:34816
    ds_write_b128 v30, v[220:223] offset:35840
    s_waitcnt lgkmcnt(0)
    s_barrier
    s_branch L_p2k
L_kc:
    s_waitcnt vmcnt(4) lgkmcnt(0)
    s_barrier
    v_add_u32 v20, 0x14000, v20
    v_add_u32 v21, 0x14000, v21
    v_add_u32 v22, 0x14000, v22
    v_add_u32 v23, 0x14000, v23
    ds_read_b64_tr_b16 v[112:113], v20 offset:0
    ds_read_b64_tr_b16 v[114:115], v20 offset:1024
    v_add_u32 v28, 0x10000, v28
    v_add_u32 v29, 0x10000, v29
    v_add_u32 v30, 0x10000, v30
    v_add_u32 v31, 0x10000, v31
    ds_read_b128 v[128:131], v28 offset:0
    ds_read_b64_tr_b16 v[116:117], v21 offset:0
    ds_read_b64_tr_b16 v[118:119], v21 offset:1024
    ds_read_b128 v[132:135], v29 offset:0
    ds_read_b64_tr_b16 v[120:121], v22 offset:0
    ds_read_b64_tr_b16 v[122:123], v22 offset:1024
    ds_read_b128 v[136:139], v30 offset:0
    ds_read_b64_tr_b16 v[124:125], v23 offset:0
    ds_read_b64_tr_b16 v[126:127], v23 offset:1024
    s_add_u32 m0, s87, 131072
    ds_read_b128 v[140:143], v31 offset:0
    buffer_load_dwordx4 v3, s[8:11], s68 offen lds
    buffer_load_dwordx4 v4, s[8:11], s68 offen offset:1024 lds
    s_add_u32 m0, s87, 0
    s_nop 0
    buffer_load_dwordx4 v5, s[12:15], s75 offen lds
    buffer_load_dwordx4 v42, s[12:15], s75 offen offset:1024 lds
    s_waitcnt vmcnt(4) lgkmcnt(0)
    s_barrier
    v_mfma_f32_32x32x16_bf16 v[64:79], v[128:131], v[112:115], 0
    v_mfma_f32_16x16x32_bf16 v[12:15], v[8:11], v[112:115], 0
    ds_read_b64_tr_b16 v[112:113], v20 offset:32768
    ds_read_b64_tr_b16 v[114:115], v20 offset:33792
    ds_read_b128 v[144:147], v28 offset:32768
    v_mfma_f32_32x32x16_bf16 v[64:79], v[132:135], v[116:119], v[64:79]
    ds_read_b64_tr_b16 v[116:117], v21 offset:32768
    ds_read_b64_tr_b16 v[118:119], v21 offset:33792
    ds_read_b128 v[148:151], v29 offset:32768
    v_mfma_f32_32x32x16_bf16 v[64:79], v[136:139], v[120:123], v[64:79]
    ds_read_b64_tr_b16 v[120:121], v22 offset:32768
    ds_read_b64_tr_b16 v[122:123], v22 offset:33792
    ds_read_b128 v[152:155], v30 offset:32768
    v_mfma_f32_32x32x16_bf16 v[64:79], v[140:143], v[124:127], v[64:79]
    ds_read_b64_tr_b16 v[124:125], v23 offset:32768
    ds_read_b64_tr_b16 v[126:127], v23 offset:33792
    s_add_u32 m0, s87, 16384
    ds_read_b128 v[156:159], v31 offset:32768
    buffer_load_dwordx4 v3, s[8:11], s69 offen lds
    buffer_load_dwordx4 v4, s[8:11], s69 offen offset:1024 lds
    s_add_u32 m0, s87, 32768
    s_nop 0
    buffer_load_dwordx4 v5, s[12:15], s76 offen lds
    buffer_load_dwordx4 v42, s[12:15], s76 offen offset:1024 lds
    s_waitcnt vmcnt(4) lgkmcnt(0)
    s_barrier
    v_mfma_f32_32x32x16_bf16 v[64:79], v[144:147], v[112:115], v[64:79]
    v_mfma_f32_16x16x32_bf16 v[12:15], v[8:11], v[112:115], v[12:15]
    v_add_u32 v20, 0xfffec000, v20
    v_add_u32 v21, 0xfffec000, v21
    v_add_u32 v22, 0xfffec000, v22
    v_add_u32 v23, 0xfffec000, v23
    ds_read_b64_tr_b16 v[112:113], v20 offset:0
    ds_read_b64_tr_b16 v[114:115], v20 offset:1024
    v_add_u32 v28, 0x10000, v28
    v_add_u32 v29, 0x10000, v29
    v_add_u32 v30, 0x10000, v30
    v_add_u32 v31, 0x10000, v31
    ds_read_b128 v[160:163], v28 offset:0
    v_mfma_f32_32x32x16_bf16 v[64:79], v[148:151], v[116:119], v[64:79]
    ds_read_b64_tr_b16 v[116:117], v21 offset:0
    ds_read_b64_tr_b16 v[118:119], v21 offset:1024
    ds_read_b128 v[164:167], v29 offset:0
    v_mfma_f32_32x32x16_bf16 v[64:79], v[152:155], v[120:123], v[64:79]
    ds_read_b64_tr_b16 v[120:121], v22 offset:0
    ds_read_b64_tr_b16 v[122:123], v22 offset:1024
    ds_read_b128 v[168:171], v30 offset:0
    v_mfma_f32_32x32x16_bf16 v[64:79], v[156:159], v[124:127], v[64:79]
    ds_read_b64_tr_b16 v[124:125], v23 offset:0
    ds_read_b64_tr_b16 v[126:127], v23 offset:1024
    s_add_u32 m0, s87, 49152
    ds_read_b128 v[172:175], v31 offset:0
    buffer_load_dwordx4 v3, s[8:11], s70 offen lds
    buffer_load_dwordx4 v4, s[8:11], s70 offen offset:1024 lds
    s_add_u32 m0, s87, 65536
    s_nop 0
    buffer_load_dwordx4 v5, s[12:15], s77 offen lds
    buffer_load_dwordx4 v42, s[12:15], s77 offen offset:1024 lds
    s_waitcnt vmcnt(4) lgkmcnt(0)
    s_barrier
    v_mfma_f32_32x32x16_bf16 v[64:79], v[160:163], v[112:115], v[64:79]
    v_mfma_f32_16x16x32_bf16 v[12:15], v[8:11], v[112:115], v[12:15]
    ds_read_b64_tr_b16 v[112:113], v20 offset:32768
    ds_read_b64_tr_b16 v[114:115], v20 offset:33792
    v_add_u32 v28, 0xfffe4000, v28
    v_add_u32 v29, 0xfffe4000, v29
    v_add_u32 v30, 0xfffe4000, v30
    v_add_u32 v31, 0xfffe4000, v31
    ds_read_b128 v[176:179], v28 offset:0
    v_mfma_f32_32x32x16_bf16 v[64:79], v[164:167], v[116:119], v[64:79]
    ds_read_b64_tr_b16 v[116:117], v21 offset:32768
    ds_read_b64_tr_b16 v[118:119], v21 offset:33792
    ds_read_b128 v[180:183], v29 offset:0
    v_mfma_f32_32x32x16_bf16 v[64:79], v[168:171], v[120:123], v[64:79]
    ds_read_b64_tr_b16 v[120:121], v22 offset:32768
    ds_read_b64_tr_b16 v[122:123], v22 offset:33792
    ds_read_b128 v[184:187], v30 offset:0
    v_mfma_f32_32x32x16_bf16 v[64:79], v[172:175], v[124:127], v[64:79]
    ds_read_b64_tr_b16 v[124:125], v23 offset:32768
    ds_read_b64_tr_b16 v[126:127], v23 offset:33792
    s_add_u32 m0, s87, 81920
    ds_read_b128 v[188:191], v31 offset:0
    buffer_load_dwordx4 v3, s[8:11], s71 offen lds
    buffer_load_dwordx4 v4, s[8:11], s71 offen offset:1024 lds
    s_add_u32 m0, s87, 98304
    s_nop 0
    buffer_load_dwordx4 v5, s[12:15], s78 offen lds
    buffer_load_dwordx4 v42, s[12:15], s78 offen offset:1024 lds
    s_waitcnt vmcnt(4) lgkmcnt(0)
    s_barrier
    v_mfma_f32_32x32x16_bf16 v[64:79], v[176:179], v[112:115], v[64:79]
    v_mfma_f32_16x16x32_bf16 v[12:15], v[8:11], v[112:115], v[12:15]
    v_add_u32 v20, 0x10000, v20
    v_add_u32 v21, 0x10000, v21
    v_add_u32 v22, 0x10000, v22
    v_add_u32 v23, 0x10000, v23
    ds_read_b64_tr_b16 v[112:113], v20 offset:0
    ds_read_b64_tr_b16 v[114:115], v20 offset:1024
    ds_read_b128 v[192:195], v28 offset:32768
    v_mfma_f32_32x32x16_bf16 v[64:79], v[180:183], v[116:119], v[64:79]
    ds_read_b64_tr_b16 v[116:117], v21 offset:0
    ds_read_b64_tr_b16 v[118:119], v21 offset:1024
    ds_read_b128 v[196:199], v29 offset:32768
    v_mfma_f32_32x32x16_bf16 v[64:79], v[184:187], v[120:123], v[64:79]
    ds_read_b64_tr_b16 v[120:121], v22 offset:0
    ds_read_b64_tr_b16 v[122:123], v22 offset:1024
    ds_read_b128 v[200:203], v30 offset:32768
    v_mfma_f32_32x32x16_bf16 v[64:79], v[188:191], v[124:127], v[64:79]
    ds_read_b64_tr_b16 v[124:125], v23 offset:0
    ds_read_b64_tr_b16 v[126:127], v23 offset:1024
    ds_read_b128 v[204:207], v31 offset:32768
    buffer_load_dword v44, v46, s[40:43], 0 offen sc1
    s_add_u32 m0, s87, 114688
    s_nop 0
    buffer_load_dwordx4 v3, s[8:11], s72 offen lds
    buffer_load_dwordx4 v4, s[8:11], s72 offen offset:1024 lds
    s_add_u32 m0, s87, 131072
    s_nop 0
    buffer_load_dwordx4 v5, s[12:15], s79 offen lds
    buffer_load_dwordx4 v42, s[12:15], s79 offen offset:1024 lds
    s_waitcnt vmcnt(5) lgkmcnt(0)
    s_barrier
    v_mfma_f32_32x32x16_bf16 v[64:79], v[192:195], v[112:115], v[64:79]
    v_mfma_f32_16x16x32_bf16 v[12:15], v[8:11], v[112:115], v[12:15]
    ds_read_b64_tr_b16 v[112:113], v20 offset:32768
    ds_read_b64_tr_b16 v[114:115], v20 offset:33792
    v_add_u32 v28, 0x10000, v28
    v_add_u32 v29, 0x10000, v29
    v_add_u32 v30, 0x10000, v30
    v_add_u32 v31, 0x10000, v31
    ds_read_b128 v[208:211], v28 offset:0
    v_mfma_f32_32x32x16_bf16 v[64:79], v[196:199], v[116:119], v[64:79]
    ds_read_b64_tr_b16 v[116:117], v21 offset:32768
    ds_read_b64_tr_b16 v[118:119], v21 offset:33792
    ds_read_b128 v[212:215], v29 offset:0
    v_mfma_f32_32x32x16_bf16 v[64:79], v[200:203], v[120:123], v[64:79]
    ds_read_b64_tr_b16 v[120:121], v22 offset:32768
    ds_read_b64_tr_b16 v[122:123], v22 offset:33792
    ds_read_b128 v[216:219], v30 offset:0
    v_mfma_f32_32x32x16_bf16 v[64:79], v[204:207], v[124:127], v[64:79]
    ds_read_b64_tr_b16 v[124:125], v23 offset:32768
    ds_read_b64_tr_b16 v[126:127], v23 offset:33792
    ds_read_b128 v[220:223], v31 offset:0
    v_add_u32 v5, 896, v5
    s_add_u32 m0, s87, 0
    v_add_u32 v42, 896, v42
    buffer_load_dwordx4 v5, s[12:15], s73 offen lds
    buffer_load_dwordx4 v42, s[12:15], s73 offen offset:1024 lds
    s_add_u32 m0, s87, 16384
    v_add_u32 v3, 6144, v2
    buffer_load_dwordx4 v5, s[12:15], s74 offen lds
    buffer_load_dwordx4 v42, s[12:15], s74 offen offset:1024 lds
    s_waitcnt vmcnt(4) lgkmcnt(0)
    s_barrier
    v_mfma_f32_32x32x16_bf16 v[64:79], v[208:211], v[112:115], v[64:79]
    v_mfma_f32_16x16x32_bf16 v[12:15], v[8:11], v[112:115], v[12:15]
    v_add_u32 v20, 0x10000, v20
    v_add_u32 v21, 0x10000, v21
    v_add_u32 v22, 0x10000, v22
    v_add_u32 v23, 0x10000, v23
    ds_read_b64_tr_b16 v[112:113], v20 offset:0
    ds_read_b64_tr_b16 v[114:115], v20 offset:1024
    ds_read_b128 v[224:227], v28 offset:32768
    v_mfma_f32_32x32x16_bf16 v[64:79], v[212:215], v[116:119], v[64:79]
    ds_read_b64_tr_b16 v[116:117], v21 offset:0
    ds_read_b64_tr_b16 v[118:119], v21 offset:1024
    ds_read_b128 v[228:231], v29 offset:32768
    v_mfma_f32_32x32x16_bf16 v[64:79], v[216:219], v[120:123], v[64:79]
    ds_read_b64_tr_b16 v[120:121], v22 offset:0
    ds_read_b64_tr_b16 v[122:123], v22 offset:1024
    ds_read_b128 v[232:235], v30 offset:32768
    v_mfma_f32_32x32x16_bf16 v[64:79], v[220:223], v[124:127], v[64:79]
    ds_read_b64_tr_b16 v[124:125], v23 offset:0
    ds_read_b64_tr_b16 v[126:127], v23 offset:1024
    ds_read_b128 v[236:239], v31 offset:32768
    v_cmp_le_u32 vcc, 32, v44
    s_nop 0
    s_andn2_b32 s95, 0x1, vcc_lo
    s_cbranch_scc1 L_slow9
L_ret9:
    s_add_u32 m0, s87, 32768
    s_nop 0
    buffer_load_dwordx4 v5, s[12:15], s75 offen lds
    buffer_load_dwordx4 v42, s[12:15], s75 offen offset:1024 lds
    s_add_u32 m0, s87, 49152
    s_nop 0
    buffer_load_dwordx4 v5, s[12:15], s76 offen lds
    buffer_load_dwordx4 v42, s[12:15], s76 offen offset:1024 lds
    s_waitcnt vmcnt(6) lgkmcnt(0)
    s_barrier
    v_mfma_f32_32x32x16_bf16 v[64:79], v[224:227], v[112:115], v[64:79]
    v_mfma_f32_16x16x32_bf16 v[12:15], v[8:11], v[112:115], v[12:15]
    v_mfma_f32_32x32x16_bf16 v[64:79], v[228:231], v[116:119], v[64:79]
    v_mfma_f32_32x32x16_bf16 v[64:79], v[232:235], v[120:123], v[64:79]
    s_nop 5
    ds_write_b32 v6, v12 offset:512
    s_add_u32 m0, s87, 65536
    v_mfma_f32_32x32x16_bf16 v[64:79], v[236:239], v[124:127], v[64:79]
    buffer_load_dwordx4 v5, s[12:15], s77 offen lds
    buffer_load_dwordx4 v42, s[12:15], s77 offen offset:1024 lds
    buffer_load_dword v38, v39, s[16:19], s90 offen sc1
    s_waitcnt vmcnt(5) lgkmcnt(0)
    s_barrier
    s_add_u32 m0, s87, 81920
    ds_read_b128 v[52:55], v7 offset:512
    buffer_load_dwordx4 v5, s[12:15], s78 offen lds
    buffer_load_dwordx4 v42, s[12:15], s78 offen offset:1024 lds
    s_waitcnt lgkmcnt(0)
    v_add_f32 v52, v52, v53
    v_add_f32 v54, v54, v55
    v_add_f32 v52, v52, v54
    v_cvt_pk_bf16_f32 v53, v52, v52
    v_lshlrev_b32 v53, 16, v53
    v_sub_f32 v53, v52, v53
    s_add_u32 m0, s87, 98304
    v_cvt_pk_bf16_f32 v32, v52, v53
    buffer_load_dwordx4 v5, s[12:15], s79 offen lds
    buffer_load_dwordx4 v42, s[12:15], s79 offen offset:1024 lds
    s_mul_i32 s82, s4, 10240
    s_add_u32 s82, s82, 122880
    v_add_u32 v28, s82, v1
    s_waitcnt vmcnt(4)
    v_cmp_le_u32 vcc, 1, v38
    s_nop 0
    s_andn2_b32 s95, 0xffffffff, vcc_lo
    s_cbranch_scc1 L_slow10
L_ret10:
    v_and_b32 v48, 0xffff, v38
    v_lshl_or_b32 v48, v38, 16, v48
    v_cndmask_b32 v36, v48, 0, s[92:93]
    v_and_b32 v49, 0xffff0000, v38
    v_rcp_f32 v49, v49
    s_setprio 2
    v_mfma_f32_32x32x8_bf16 v[64:79], v[36:37], v[32:33], v[64:79]
    s_setprio 0
    ds_write_b32 v40, v49
    ds_read_b128 v[112:115], v43 offset:0
    ds_read_b128 v[116:119], v43 offset:32
    ds_read_b128 v[120:123], v43 offset:64
    ds_read_b128 v[124:127], v43 offset:96
    s_waitcnt lgkmcnt(0)
    s_barrier
    s_nop 3
    v_fma_f32 v64, v64, v112, s85
    v_fma_f32 v65, v65, v113, s85
    v_fma_f32 v66, v66, v114, s85
    v_fma_f32 v67, v67, v115, s85
    v_mul_f32 v48, s99, v64
    v_mul_f32 v49, s99, v65
    v_mul_f32 v50, s99, v66
    v_mul_f32 v51, s99, v67
    v_exp_f32_e64 v48, v48 clamp
    v_exp_f32_e64 v49, v49 clamp
    v_exp_f32_e64 v50, v50 clamp
    v_exp_f32_e64 v51, v51 clamp
    v_max_f32 v64, s85, v64
    v_max_f32 v65, s85, v65
    v_max_f32 v66, s85, v66
    v_max_f32 v67, s85, v67
    v_add_f32 v64, v64, v48
    v_add_f32 v65, v65, v49
    v_add_f32 v66, v66, v50
    v_add_f32 v67, v67, v51
    v_cvt_pk_bf16_f32 v64, v64, v65
    v_cvt_pk_bf16_f32 v65, v66, v67
    v_fma_f32 v68, v68, v116, s85
    v_fma_f32 v69, v69, v117, s85
    v_fma_f32 v70, v70, v118, s85
    v_fma_f32 v71, v71, v119, s85
    v_mul_f32 v48, s99, v68
    v_mul_f32 v49, s99, v69
    v_mul_f32 v50, s99, v70
    v_mul_f32 v51, s99, v71
    v_exp_f32_e64 v48, v48 clamp
    v_exp_f32_e64 v49, v49 clamp
    v_exp_f32_e64 v50, v50 clamp
    v_exp_f32_e64 v51, v51 clamp
    v_max_f32 v68, s85, v68
    v_max_f32 v69, s85, v69
    v_max_f32 v70, s85, v70
    v_max_f32 v71, s85, v71
    v_add_f32 v68, v68, v48
    v_add_f32 v69, v69, v49
    v_add_f32 v70, v70, v50
    v_add_f32 v71, v71, v51
    v_cvt_pk_bf16_f32 v66, v68, v69
    v_cvt_pk_bf16_f32 v67, v70, v71
    v_fma_f32 v72, v72, v120, s85
    v_fma_f32 v73, v73, v121, s85
    v_fma_f32 v74, v74, v122, s85
    v_fma_f32 v75, v75, v123, s85
    v_mul_f32 v48, s99, v72
    v_mul_f32 v49, s99, v73
    v_mul_f32 v50, s99, v74
    v_mul_f32 v51, s99, v75
    v_exp_f32_e64 v48, v48 clamp
    v_exp_f32_e64 v49, v49 clamp
    v_exp_f32_e64 v50, v50 clamp
    v_exp_f32_e64 v51, v51 clamp
    v_max_f32 v72, s85, v72
    v_max_f32 v73, s85, v73
    v_max_f32 v74, s85, v74
    v_max_f32 v75, s85, v75
    v_add_f32 v72, v72, v48
    v_add_f32 v73, v73, v49
    v_add_f32 v74, v74, v50
    v_add_f32 v75, v75, v51
    v_cvt_pk_bf16_f32 v68, v72, v73
    v_cvt_pk_bf16_f32 v69, v74, v75
    v_fma_f32 v76, v76, v124, s85
    v_fma_f32 v77, v77, v125, s85
    v_fma_f32 v78, v78, v126, s85
    v_fma_f32 v79, v79, v127, s85
    v_mul_f32 v48, s99, v76
    v_mul_f32 v49, s99, v77
    v_mul_f32 v50, s99, v78
    v_mul_f32 v51, s99, v79
    v_exp_f32_e64 v48, v48 clamp
    v_exp_f32_e64 v49, v49 clamp
    v_exp_f32_e64 v50, v50 clamp
    v_exp_f32_e64 v51, v51 clamp
    v_max_f32 v76, s85, v76
    v_max_f32 v77, s85, v77
    v_max_f32 v78, s85, v78
    v_max_f32 v79, s85, v79
    v_add_f32 v76, v76, v48
    v_add_f32 v77, v77, v49
    v_add_f32 v78, v78, v50
    v_add_f32 v79, v79, v51
    v_cvt_pk_bf16_f32 v70, v76, v77
    v_cvt_pk_bf16_f32 v71, v78, v79
    ds_write_b128 v28, v[64:67] offset:0
    ds_write_b128 v28, v[68:71] offset:1024
    s_waitcnt vmcnt(0) lgkmcnt(0)
    s_barrier
    s_mul_i32 s95, s6, 6
    s_add_u32 s95, s95, s96
    s_lshl2_add_u32 s95, s95, s4
    v_min_u32 v56, 512, v1
    s_mul_i32 s88, s95, 4224
    v_lshlrev_b32 v56, 3, v56
    buffer_load_dword v57, v56, s[20:23], s88 offen
    v_min_u32 v56, 1024, v56
    s_mul_i32 s88, s95, 1152
    buffer_load_dword v57, v56, s[24:27], s88 offen
    s_waitcnt lgkmcnt(0)
    s_barrier
    s_waitcnt lgkmcnt(0)
    s_barrier
    s_lshr_b32 s73, s80, 1
    s_lshl2_add_u32 s73, s73, s4
    s_mul_i32 s73, s73, 896
    s_add_u32 s73, s73, 0x911000
    v_cmp_gt_u32 vcc, 32, v1
    v_lshlrev_b32 v31, 3, v1
    s_nop 0
    v_cndmask_b32 v31, v46, v31, vcc
    buffer_load_dword v44, v31, s[16:19], s73 offen offset:0 sc1
    v_lshrrev_b32 v72, 3, v0
    v_and_b32 v73, 0x70, v1
    v_mul_u32_u24 v72, 896, v72
    s_lshl_b32 s95, s7, 7
    v_add_u32 v72, v72, v73
    buffer_load_dwordx4 v[64:67], v72, s[8:11], s63 offen
    buffer_load_dwordx4 v[68:71], v73, s[36:39], s95 offen
    v_add_u32 v12, 147456, v1
    s_mul_i32 s82, s4, 7168
    s_add_u32 s96, s61, s82
    s_add_u32 s96, s96, 114688
    s_add_u32 s68, s96, 4096
    s_mul_i32 s82, s4, 28672
    s_add_u32 s61, s61, s82
    s_waitcnt lgkmcnt(0)
    s_barrier
    s_waitcnt vmcnt(2)
    v_cmp_ne_u32 vcc, 0, v44
    s_nop 0
    s_andn2_b32 s95, 3, vcc_lo
    s_cbranch_scc1 L_slow11
L_ret11:
    s_xor_b32 s82, s89, 0
    s_lshl_b32 s82, s82, 10
    s_add_u32 s82, s82, s61
    buffer_load_dwordx4 v[128:131], v1, s[16:19], s82 offen sc1
    buffer_load_dwordx4 v[132:135], v12, s[16:19], s82 offen sc1
    s_xor_b32 s82, s89, 1
    s_lshl_b32 s82, s82, 10
    s_add_u32 s82, s82, s61
    buffer_load_dwordx4 v[136:139], v1, s[16:19], s82 offen sc1
    buffer_load_dwordx4 v[140:143], v12, s[16:19], s82 offen sc1
    s_xor_b32 s82, s89, 2
    s_lshl_b32 s82, s82, 10
    s_add_u32 s82, s82, s61
    buffer_load_dwordx4 v[144:147], v1, s[16:19], s82 offen sc1
    buffer_load_dwordx4 v[148:151], v12, s[16:19], s82 offen sc1
    s_waitcnt lgkmcnt(0)
    s_barrier
    s_branch L_p2k
L_q:
    v_cmp_eq_u32 vcc, 7, v62
    v_mov_b32 v53, 0x20000
    s_nop 0
    v_cndmask_b32 v62, v62, v53, vcc
    s_mul_i32 s83, s5, 56
    v_lshrrev_b32 v54, 1, v58
    v_lshl_add_u32 v53, v62, 3, s83
    v_lshlrev_b32 v54, 6, v54
    v_xor_b32 v53, v53, v54
    v_lshl_add_u32 v20, v60, 7, v53
    v_xor_b32 v21, 2048, v20
    v_xor_b32 v22, 4096, v20
    v_xor_b32 v23, 6144, v20
    s_mov_b32 s18, 0x10000000
    s_mov_b32 s19, 0x20000
    s_mov_b32 s42, 0x100
    s_mov_b32 s43, 0x20000
    s_waitcnt lgkmcnt(0)
    s_lshl1_add_u32 s95, s6, s81
    s_mul_i32 s83, s95, 6
    s_add_u32 s83, s83, s3
    s_lshl_b32 s83, s83, 10
    s_add_u32 s83, s83, 0x900000
    s_lshl_b32 s97, s95, 10
    s_add_u32 s97, s97, 0x938000
    s_cmp_lt_u32 s3, 6
    s_cselect_b32 s83, s83, 0x40000000
    s_cmp_eq_u32 s3, 6
    s_cselect_b32 s83, s97, s83
    buffer_store_dwordx4 v[38:41], v1, s[16:19], s83 offen sc1
    s_cmp_eq_u32 s5, 1
    s_cbranch_scc1 L_qb
    s_add_u32 m0, s87, 131072
    s_nop 0
    buffer_load_dwordx4 v3, s[8:11], s67 offen lds
    buffer_load_dwordx4 v4, s[8:11], s67 offen offset:1024 lds
    s_mov_b32 s22, 0x188000
    s_mov_b32 s23, 0x20000
    s_mov_b32 s26, 0x62000
    s_mov_b32 s27, 0x20000
    s_mov_b32 s30, 0x1c0000
    s_mov_b32 s31, 0x20000
    s_mov_b32 s38, 0x380
    s_mov_b32 s39, 0x20000
    s_mov_b32 s85, 0x358637bd
    s_mov_b32 s99, 0x3fb8aa3b
    s_mov_b32 s92, 0
    s_mov_b32 s93, -1
    s_mov_b32 s94, 0
    v_and_b32 v52, 7, v52
    v_mul_u32_u24 v2, 896, v49
    v_lshl_add_u32 v2, v52, 4, v2
    s_lshl_b32 s83, s5, 9
    s_add_u32 s83, s83, 159744
    v_lshl_add_u32 v7, v56, 4, s83
    v_lshl_add_u32 v6, s4, 2, v7
    s_lshl2_add_u32 s83, s3, 157696
    v_mov_b32 v45, s83
    ds_write_b32 v45, v33 offset:0
    v_lshlrev_b32 v37, 2, v61
    v_add_u32 v36, 155648, v37
    s_and_b32 s83, s2, 7
    s_lshl2_add_u32 s80, s83, s80
    s_lshl1_add_u32 s83, s80, s7
    s_and_b32 s89, s83, 3
    s_and_b32 s83, s83, 4
    s_lshl2_add_u32 s89, s83, s89
    s_lshl2_add_u32 s90, s6, s4
    s_mul_i32 s90, s90, 147456
    s_add_u32 s90, s90, 114688
    s_mul_i32 s83, s81, 14336
    s_add_u32 s90, s90, s83
    s_lshl_b32 s83, s81, 1
    s_lshl2_add_u32 s83, s6, s83
    s_mul_i32 s91, s83, 896
    s_lshl1_add_u32 s91, s98, s91
    s_lshl_b32 s83, s4, 28
    s_add_u32 s91, s91, s83
    s_add_u32 s91, s91, 0x911000
    s_barrier
    s_add_u32 m0, s87, 65536
    s_nop 0
    buffer_load_dwordx4 v3, s[8:11], s68 offen lds
    buffer_load_dwordx4 v4, s[8:11], s68 offen offset:1024 lds
    s_waitcnt vmcnt(4) lgkmcnt(0)
    s_barrier
    s_lshl_b32 s95, s3, 28
    buffer_atomic_add v47, v46, s[40:43], s95 offen sc1
    ds_read_b64_tr_b16 v[240:241], v20 offset:0
    ds_read_b64_tr_b16 v[242:243], v20 offset:512
    v_add_u32 v28, 0x1c000, v28
    v_add_u32 v29, 0x1c000, v29
    v_add_u32 v30, 0x1c000, v30
    v_add_u32 v31, 0x1c000, v31
    ds_read_b128 v[128:131], v28 offset:0
    ds_read_b64_tr_b16 v[244:245], v21 offset:0
    ds_read_b64_tr_b16 v[246:247], v21 offset:512
    ds_read_b128 v[132:135], v29 offset:0
    ds_read_b64_tr_b16 v[248:249], v22 offset:0
    ds_read_b64_tr_b16 v[250:251], v22 offset:512
    ds_read_b128 v[136:139], v30 offset:0
    ds_read_b64_tr_b16 v[252:253], v23 offset:0
    ds_read_b64_tr_b16 v[254:255], v23 offset:512
    s_add_u32 m0, s87, 81920
    ds_read_b128 v[140:143], v31 offset:0
    buffer_load_dwordx4 v3, s[8:11], s69 offen lds
    buffer_load_dwordx4 v4, s[8:11], s69 offen offset:1024 lds
    s_waitcnt vmcnt(5) lgkmcnt(0)
    s_barrier
    v_mfma_f32_32x32x16_bf16 v[64:79], v[240:243], v[128:131], 0
    v_mfma_f32_16x16x32_bf16 v[12:15], v[8:11], v[240:243], 0
    ds_read_b64_tr_b16 v[240:241], v20 offset:8192
    ds_read_b64_tr_b16 v[242:243], v20 offset:8704
    ds_read_b128 v[144:147], v28 offset:16384
    v_mfma_f32_32x32x16_bf16 v[64:79], v[244:247], v[132:135], v[64:79]
    ds_read_b64_tr_b16 v[244:245], v21 offset:8192
    ds_read_b64_tr_b16 v[246:247], v21 offset:8704
    ds_read_b128 v[148:151], v29 offset:16384
    v_mfma_f32_32x32x16_bf16 v[64:79], v[248:251], v[136:139], v[64:79]
    ds_read_b64_tr_b16 v[248:249], v22 offset:8192
    ds_read_b64_tr_b16 v[250:251], v22 offset:8704
    ds_read_b128 v[152:155], v30 offset:16384
    v_mfma_f32_32x32x16_bf16 v[64:79], v[252:255], v[140:143], v[64:79]
    ds_read_b64_tr_b16 v[252:253], v23 offset:8192
    ds_read_b64_tr_b16 v[254:255], v23 offset:8704
    s_add_u32 m0, s87, 98304
    ds_read_b128 v[156:159], v31 offset:16384
    buffer_load_dwordx4 v3, s[8:11], s70 offen lds
    buffer_load_dwordx4 v4, s[8:11], s70 offen offset:1024 lds
    s_waitcnt vmcnt(5) lgkmcnt(0)
    s_barrier
    v_mfma_f32_32x32x16_bf16 v[64:79], v[240:243], v[144:147], v[64:79]
    v_mfma_f32_16x16x32_bf16 v[12:15], v[8:11], v[240:243], v[12:15]
    ds_read_b64_tr_b16 v[240:241], v20 offset:16384
    ds_read_b64_tr_b16 v[242:243], v20 offset:16896
    v_add_u32 v28, 0xffff4000, v28
    v_add_u32 v29, 0xffff4000, v29
    v_add_u32 v30, 0xffff4000, v30
    v_add_u32 v31, 0xffff4000, v31
    ds_read_b128 v[160:163], v28 offset:0
    v_mfma_f32_32x32x16_bf16 v[64:79], v[244:247], v[148:151], v[64:79]
    ds_read_b64_tr_b16 v[244:245], v21 offset:16384
    ds_read_b64_tr_b16 v[246:247], v21 offset:16896
    ds_read_b128 v[164:167], v29 offset:0
    v_mfma_f32_32x32x16_bf16 v[64:79], v[248:251], v[152:155], v[64:79]
    ds_read_b64_tr_b16 v[248:249], v22 offset:16384
    ds_read_b64_tr_b16 v[250:251], v22 offset:16896
    ds_read_b128 v[168:171], v30 offset:0
    v_mfma_f32_32x32x16_bf16 v[64:79], v[252:255], v[156:159], v[64:79]
    ds_read_b64_tr_b16 v[252:253], v23 offset:16384
    ds_read_b64_tr_b16 v[254:255], v23 offset:16896
    s_add_u32 m0, s87, 114688
    ds_read_b128 v[172:175], v31 offset:0
    buffer_load_dwordx4 v3, s[8:11], s71 offen lds
    buffer_load_dwordx4 v4, s[8:11], s71 offen offset:1024 lds
    s_waitcnt vmcnt(4) lgkmcnt(0)
    s_barrier
    v_mfma_f32_32x32x16_bf16 v[64:79], v[240:243], v[160:163], v[64:79]
    v_mfma_f32_16x16x32_bf16 v[12:15], v[8:11], v[240:243], v[12:15]
    ds_read_b64_tr_b16 v[240:241], v20 offset:24576
    ds_read_b64_tr_b16 v[242:243], v20 offset:25088
    ds_read_b128 v[176:179], v28 offset:16384
    v_mfma_f32_32x32x16_bf16 v[64:79], v[244:247], v[164:167], v[64:79]
    ds_read_b64_tr_b16 v[244:245], v21 offset:24576
    ds_read_b64_tr_b16 v[246:247], v21 offset:25088
    ds_read_b128 v[180:183], v29 offset:16384
    v_mfma_f32_32x32x16_bf16 v[64:79], v[248:251], v[168:171], v[64:79]
    ds_read_b64_tr_b16 v[248:249], v22 offset:24576
    ds_read_b64_tr_b16 v[250:251], v22 offset:25088
    ds_read_b128 v[184:187], v30 offset:16384
    v_mfma_f32_32x32x16_bf16 v[64:79], v[252:255], v[172:175], v[64:79]
    ds_read_b64_tr_b16 v[252:253], v23 offset:24576
    ds_read_b64_tr_b16 v[254:255], v23 offset:25088
    s_add_u32 m0, s87, 131072
    ds_read_b128 v[188:191], v31 offset:16384
    buffer_load_dwordx4 v3, s[8:11], s72 offen lds
    buffer_load_dwordx4 v4, s[8:11], s72 offen offset:1024 lds
    s_waitcnt vmcnt(4) lgkmcnt(0)
    s_barrier
    v_mfma_f32_32x32x16_bf16 v[64:79], v[240:243], v[176:179], v[64:79]
    v_mfma_f32_16x16x32_bf16 v[12:15], v[8:11], v[240:243], v[12:15]
    ds_read_b64_tr_b16 v[240:241], v20 offset:32768
    ds_read_b64_tr_b16 v[242:243], v20 offset:33280
    ds_read_b128 v[192:195], v28 offset:32768
    v_mfma_f32_32x32x16_bf16 v[64:79], v[244:247], v[180:183], v[64:79]
    ds_read_b64_tr_b16 v[244:245], v21 offset:32768
    ds_read_b64_tr_b16 v[246:247], v21 offset:33280
    ds_read_b128 v[196:199], v29 offset:32768
    v_mfma_f32_32x32x16_bf16 v[64:79], v[248:251], v[184:187], v[64:79]
    ds_read_b64_tr_b16 v[248:249], v22 offset:32768
    ds_read_b64_tr_b16 v[250:251], v22 offset:33280
    ds_read_b128 v[200:203], v30 offset:32768
    v_mfma_f32_32x32x16_bf16 v[64:79], v[252:255], v[188:191], v[64:79]
    ds_read_b64_tr_b16 v[252:253], v23 offset:32768
    ds_read_b64_tr_b16 v[254:255], v23 offset:33280
    ds_read_b128 v[204:207], v31 offset:32768
    v_add_u32 v5, 112, v5
    v_add_u32 v42, 112, v42
    s_lshl3_add_u32 s95, s6, s3
    s_mul_i32 s95, s95, 10752
    s_mul_i32 s88, s81, 384
    s_add_u32 s95, s95, s88
    v_min_u32 v50, 31, v48
    v_lshrrev_b32 v63, 3, v50
    v_mad_u32_u24 v63, v63, 13, v50
    v_bfe_u32 v50, v50, 2, 1
    v_mad_u32_u24 v50, v50, 10, v63
    v_lshlrev_b32 v50, 7, v50
    buffer_load_dword v127, v50, s[12:15], s95 offen
    s_waitcnt vmcnt(3) lgkmcnt(0)
    s_barrier
    v_mfma_f32_32x32x16_bf16 v[64:79], v[240:243], v[192:195], v[64:79]
    v_mfma_f32_16x16x32_bf16 v[12:15], v[8:11], v[240:243], v[12:15]
    ds_read_b64_tr_b16 v[240:241], v20 offset:40960
    ds_read_b64_tr_b16 v[242:243], v20 offset:41472
    ds_read_b128 v[208:211], v28 offset:49152
    v_mfma_f32_32x32x16_bf16 v[64:79], v[244:247], v[196:199], v[64:79]
    ds_read_b64_tr_b16 v[244:245], v21 offset:40960
    ds_read_b64_tr_b16 v[246:247], v21 offset:41472
    ds_read_b128 v[212:215], v29 offset:49152
    v_mfma_f32_32x32x16_bf16 v[64:79], v[248:251], v[200:203], v[64:79]
    ds_read_b64_tr_b16 v[248:249], v22 offset:40960
    ds_read_b64_tr_b16 v[250:251], v22 offset:41472
    ds_read_b128 v[216:219], v30 offset:49152
    v_mfma_f32_32x32x16_bf16 v[64:79], v[252:255], v[204:207], v[64:79]
    ds_read_b64_tr_b16 v[252:253], v23 offset:40960
    ds_read_b64_tr_b16 v[254:255], v23 offset:41472
    ds_read_b128 v[220:223], v31 offset:49152
    s_waitcnt vmcnt(1) lgkmcnt(0)
    s_barrier
    v_mfma_f32_32x32x16_bf16 v[64:79], v[240:243], v[208:211], v[64:79]
    v_mfma_f32_16x16x32_bf16 v[12:15], v[8:11], v[240:243], v[12:15]
    ds_read_b64_tr_b16 v[240:241], v20 offset:49152
    ds_read_b64_tr_b16 v[242:243], v20 offset:49664
    v_add_u32 v28, 0x10000, v28
    v_add_u32 v29, 0x10000, v29
    v_add_u32 v30, 0x10000, v30
    v_add_u32 v31, 0x10000, v31
    ds_read_b128 v[224:227], v28 offset:0
    v_mfma_f32_32x32x16_bf16 v[64:79], v[244:247], v[212:215], v[64:79]
    ds_read_b64_tr_b16 v[244:245], v21 offset:49152
    ds_read_b64_tr_b16 v[246:247], v21 offset:49664
    ds_read_b128 v[228:231], v29 offset:0
    v_mfma_f32_32x32x16_bf16 v[64:79], v[248:251], v[216:219], v[64:79]
    ds_read_b64_tr_b16 v[248:249], v22 offset:49152
    ds_read_b64_tr_b16 v[250:251], v22 offset:49664
    ds_read_b128 v[232:235], v30 offset:0
    v_mfma_f32_32x32x16_bf16 v[64:79], v[252:255], v[220:223], v[64:79]
    ds_read_b64_tr_b16 v[252:253], v23 offset:49152
    ds_read_b64_tr_b16 v[254:255], v23 offset:49664
    ds_read_b128 v[236:239], v31 offset:0
    s_barrier
    s_waitcnt lgkmcnt(7)
    v_mfma_f32_32x32x16_bf16 v[64:79], v[240:243], v[224:227], v[64:79]
    v_mfma_f32_16x16x32_bf16 v[12:15], v[8:11], v[240:243], v[12:15]
    s_waitcnt lgkmcnt(6)
    v_mfma_f32_32x32x16_bf16 v[64:79], v[244:247], v[228:231], v[64:79]
    s_waitcnt lgkmcnt(1)
    v_mfma_f32_32x32x16_bf16 v[64:79], v[248:251], v[232:235], v[64:79]
    s_waitcnt lgkmcnt(0)
    s_add_u32 m0, s86, 81920
    v_mfma_f32_32x32x16_bf16 v[64:79], v[252:255], v[236:239], v[64:79]
    buffer_load_dwordx4 v5, s[12:15], s76 offen lds
    ds_write_b32 v6, v12
    buffer_load_dwordx4 v42, s[12:15], s76 offen offset:1024 lds
    s_waitcnt lgkmcnt(0)
    s_barrier
    s_setprio 2
    ds_read_b32 v48, v36
    ds_read_b128 v[56:59], v7 offset:0
    s_waitcnt lgkmcnt(1)
    v_and_b32 v40, 0xffff0000, v48
    v_rcp_f32 v41, v40
    v_cndmask_b32 v48, v48, 0, s[92:93]
    v_and_b32 v49, 0xffff, v48
    v_lshl_or_b32 v36, v48, 16, v49
    v_lshrrev_b32 v37, 16, v48
    v_mul_f32 v38, s99, v41
    s_waitcnt lgkmcnt(0)
    v_add_f32 v56, v56, v57
    v_add_f32 v58, v58, v59
    v_add_f32 v56, v56, v58
    v_cvt_pk_bf16_f32 v57, v56, v56
    v_lshlrev_b32 v57, 16, v57
    v_sub_f32 v57, v56, v57
    v_cvt_pk_bf16_f32 v32, v56, v57
    s_nop 1
    v_mfma_f32_32x32x8_bf16 v[64:79], v[32:33], v[36:37], v[64:79]
    s_setprio 0
    s_nop 10
    v_mul_f32 v48, v64, v38
    v_mul_f32 v49, v65, v38
    v_mul_f32 v50, v66, v38
    v_mul_f32 v51, v67, v38
    v_exp_f32_e64 v48, v48 clamp
    v_exp_f32_e64 v49, v49 clamp
    v_exp_f32_e64 v50, v50 clamp
    v_exp_f32_e64 v51, v51 clamp
    v_fma_f32 v64, v64, v41, s85
    v_fma_f32 v65, v65, v41, s85
    v_fma_f32 v66, v66, v41, s85
    v_fma_f32 v67, v67, v41, s85
    v_max_f32 v64, s85, v64
    v_max_f32 v65, s85, v65
    v_max_f32 v66, s85, v66
    v_max_f32 v67, s85, v67
    v_add_f32 v64, v64, v48
    v_add_f32 v65, v65, v49
    v_add_f32 v66, v66, v50
    v_add_f32 v67, v67, v51
    v_cvt_pk_bf16_f32 v80, v64, v65
    v_cvt_pk_bf16_f32 v81, v66, v67
    v_mul_f32 v48, v68, v38
    v_mul_f32 v49, v69, v38
    v_mul_f32 v50, v70, v38
    v_mul_f32 v51, v71, v38
    v_exp_f32_e64 v48, v48 clamp
    v_exp_f32_e64 v49, v49 clamp
    v_exp_f32_e64 v50, v50 clamp
    v_exp_f32_e64 v51, v51 clamp
    v_fma_f32 v68, v68, v41, s85
    v_fma_f32 v69, v69, v41, s85
    v_fma_f32 v70, v70, v41, s85
    v_fma_f32 v71, v71, v41, s85
    v_max_f32 v68, s85, v68
    v_max_f32 v69, s85, v69
    v_max_f32 v70, s85, v70
    v_max_f32 v71, s85, v71
    v_add_f32 v68, v68, v48
    v_add_f32 v69, v69, v49
    v_add_f32 v70, v70, v50
    ds_read_b64_tr_b16 v[240:241], v20 offset:57344
    v_add_f32 v71, v71, v51
    v_cvt_pk_bf16_f32 v82, v68, v69
    v_cvt_pk_bf16_f32 v83, v70, v71
    v_mul_f32 v48, v72, v38
    ds_read_b64_tr_b16 v[242:243], v20 offset:57856
    v_mul_f32 v49, v73, v38
    v_mul_f32 v50, v74, v38
    v_mul_f32 v51, v75, v38
    v_exp_f32_e64 v48, v48 clamp
    ds_read_b64_tr_b16 v[244:245], v21 offset:57344
    v_exp_f32_e64 v49, v49 clamp
    v_exp_f32_e64 v50, v50 clamp
    v_exp_f32_e64 v51, v51 clamp
    v_fma_f32 v72, v72, v41, s85
    ds_read_b64_tr_b16 v[246:247], v21 offset:57856
    v_fma_f32 v73, v73, v41, s85
    buffer_load_dword v44, v46, s[40:43], 0 offen sc1
    v_fma_f32 v74, v74, v41, s85
    v_fma_f32 v75, v75, v41, s85
    ds_read_b64_tr_b16 v[248:249], v22 offset:57344
    v_max_f32 v72, s85, v72
    v_max_f32 v73, s85, v73
    v_max_f32 v74, s85, v74
    v_max_f32 v75, s85, v75
    ds_read_b64_tr_b16 v[250:251], v22 offset:57856
    v_add_f32 v72, v72, v48
    v_add_f32 v73, v73, v49
    v_add_f32 v74, v74, v50
    v_add_f32 v75, v75, v51
    ds_read_b64_tr_b16 v[252:253], v23 offset:57344
    v_cvt_pk_bf16_f32 v84, v72, v73
    v_cvt_pk_bf16_f32 v85, v74, v75
    v_mul_f32 v48, v76, v38
    v_mul_f32 v49, v77, v38
    ds_read_b64_tr_b16 v[254:255], v23 offset:57856
    v_mul_f32 v50, v78, v38
    v_mul_f32 v51, v79, v38
    v_exp_f32_e64 v48, v48 clamp
    v_exp_f32_e64 v49, v49 clamp
    v_exp_f32_e64 v50, v50 clamp
    v_exp_f32_e64 v51, v51 clamp
    v_fma_f32 v76, v76, v41, s85
    v_fma_f32 v77, v77, v41, s85
    v_fma_f32 v78, v78, v41, s85
    v_fma_f32 v79, v79, v41, s85
    v_max_f32 v76, s85, v76
    v_max_f32 v77, s85, v77
    v_max_f32 v78, s85, v78
    v_max_f32 v79, s85, v79
    v_add_f32 v76, v76, v48
    v_add_f32 v77, v77, v49
    v_add_f32 v78, v78, v50
    v_add_f32 v79, v79, v51
    v_cvt_pk_bf16_f32 v86, v76, v77
    v_cvt_pk_bf16_f32 v87, v78, v79
    v_cndmask_b32 v86, v86, 0, s[92:93]
    v_cndmask_b32 v87, v87, 0, s[92:93]
    s_waitcnt vmcnt(1) lgkmcnt(0)
    s_barrier
    s_setprio 1
    v_mfma_f32_32x32x16_bf16 v[64:79], v[240:243], v[128:131], 0
    v_mfma_f32_16x16x32_bf16 v[12:15], v[8:11], v[240:243], 0
    v_add_u32 v20, 0x10000, v20
    v_add_u32 v21, 0x10000, v21
    v_add_u32 v22, 0x10000, v22
    v_add_u32 v23, 0x10000, v23
    ds_read_b64_tr_b16 v[240:241], v20 offset:0
    ds_read_b64_tr_b16 v[242:243], v20 offset:512
    v_mfma_f32_32x32x16_bf16 v[64:79], v[244:247], v[132:135], v[64:79]
    ds_read_b64_tr_b16 v[244:245], v21 offset:0
    ds_read_b64_tr_b16 v[246:247], v21 offset:512
    v_add_u32 v5, 112, v5
    s_add_u32 m0, s86, 8192
    v_add_u32 v42, 112, v42
    buffer_load_dwordx4 v5, s[12:15], s74 offen lds
    v_mfma_f32_32x32x16_bf16 v[64:79], v[248:251], v[136:139], v[64:79]
    ds_read_b64_tr_b16 v[248:249], v22 offset:0
    ds_read_b64_tr_b16 v[250:251], v22 offset:512
    v_mfma_f32_32x32x16_bf16 v[64:79], v[252:255], v[140:143], v[64:79]
    ds_read_b64_tr_b16 v[252:253], v23 offset:0
    ds_read_b64_tr_b16 v[254:255], v23 offset:512
    s_waitcnt lgkmcnt(4)
    v_mfma_f32_32x32x16_bf16 v[64:79], v[240:243], v[144:147], v[64:79]
    v_mfma_f32_16x16x32_bf16 v[12:15], v[8:11], v[240:243], v[12:15]
    ds_read_b64_tr_b16 v[240:241], v20 offset:8192
    ds_read_b64_tr_b16 v[242:243], v20 offset:8704
    buffer_load_dwordx4 v42, s[12:15], s74 offen offset:1024 lds
    v_mfma_f32_32x32x16_bf16 v[64:79], v[244:247], v[148:151], v[64:79]
    ds_read_b64_tr_b16 v[244:245], v21 offset:8192
    ds_read_b64_tr_b16 v[246:247], v21 offset:8704
    s_waitcnt lgkmcnt(4)
    v_mfma_f32_32x32x16_bf16 v[64:79], v[248:251], v[152:155], v[64:79]
    ds_read_b64_tr_b16 v[248:249], v22 offset:8192
    ds_read_b64_tr_b16 v[250:251], v22 offset:8704
    v_mfma_f32_32x32x16_bf16 v[64:79], v[252:255], v[156:159], v[64:79]
    ds_read_b64_tr_b16 v[252:253], v23 offset:8192
    s_add_u32 m0, s86, 16384
    ds_read_b64_tr_b16 v[254:255], v23 offset:8704
    buffer_load_dwordx4 v5, s[12:15], s75 offen lds
    s_waitcnt lgkmcnt(4)
    v_mfma_f32_32x32x16_bf16 v[64:79], v[240:243], v[160:163], v[64:79]
    v_mfma_f32_16x16x32_bf16 v[12:15], v[8:11], v[240:243], v[12:15]
    ds_read_b64_tr_b16 v[240:241], v20 offset:16384
    ds_read_b64_tr_b16 v[242:243], v20 offset:16896
    v_mfma_f32_32x32x16_bf16 v[64:79], v[244:247], v[164:167], v[64:79]
    ds_read_b64_tr_b16 v[244:245], v21 offset:16384
    ds_read_b64_tr_b16 v[246:247], v21 offset:16896
    s_waitcnt lgkmcnt(4)
    v_mfma_f32_32x32x16_bf16 v[64:79], v[248:251], v[168:171], v[64:79]
    ds_read_b64_tr_b16 v[248:249], v22 offset:16384
    ds_read_b64_tr_b16 v[250:251], v22 offset:16896
    buffer_load_dwordx4 v42, s[12:15], s75 offen offset:1024 lds
    v_mfma_f32_32x32x16_bf16 v[64:79], v[252:255], v[172:175], v[64:79]
    ds_read_b64_tr_b16 v[252:253], v23 offset:16384
    ds_read_b64_tr_b16 v[254:255], v23 offset:16896
    s_waitcnt lgkmcnt(4)
    v_mfma_f32_32x32x16_bf16 v[64:79], v[240:243], v[176:179], v[64:79]
    v_mfma_f32_16x16x32_bf16 v[12:15], v[8:11], v[240:243], v[12:15]
    ds_read_b64_tr_b16 v[240:241], v20 offset:24576
    ds_read_b64_tr_b16 v[242:243], v20 offset:25088
    v_mfma_f32_32x32x16_bf16 v[64:79], v[244:247], v[180:183], v[64:79]
    ds_read_b64_tr_b16 v[244:245], v21 offset:24576
    s_add_u32 m0, s86, 24576
    ds_read_b64_tr_b16 v[246:247], v21 offset:25088
    buffer_load_dwordx4 v5, s[12:15], s76 offen lds
    s_waitcnt lgkmcnt(4)
    v_mfma_f32_32x32x16_bf16 v[64:79], v[248:251], v[184:187], v[64:79]
    ds_read_b64_tr_b16 v[248:249], v22 offset:24576
    ds_read_b64_tr_b16 v[250:251], v22 offset:25088
    v_mfma_f32_32x32x16_bf16 v[64:79], v[252:255], v[188:191], v[64:79]
    ds_read_b64_tr_b16 v[252:253], v23 offset:24576
    ds_read_b64_tr_b16 v[254:255], v23 offset:25088
    s_waitcnt lgkmcnt(4)
    v_mfma_f32_32x32x16_bf16 v[64:79], v[240:243], v[192:195], v[64:79]
    v_mfma_f32_16x16x32_bf16 v[12:15], v[8:11], v[240:243], v[12:15]
    ds_read_b64_tr_b16 v[240:241], v20 offset:32768
    ds_read_b64_tr_b16 v[242:243], v20 offset:33280
    buffer_load_dwordx4 v42, s[12:15], s76 offen offset:1024 lds
    v_mfma_f32_32x32x16_bf16 v[64:79], v[244:247], v[196:199], v[64:79]
    ds_read_b64_tr_b16 v[244:245], v21 offset:32768
    ds_read_b64_tr_b16 v[246:247], v21 offset:33280
    s_waitcnt lgkmcnt(4)
    v_mfma_f32_32x32x16_bf16 v[64:79], v[248:251], v[200:203], v[64:79]
    ds_read_b64_tr_b16 v[248:249], v22 offset:32768
    ds_read_b64_tr_b16 v[250:251], v22 offset:33280
    v_mfma_f32_32x32x16_bf16 v[64:79], v[252:255], v[204:207], v[64:79]
    ds_read_b64_tr_b16 v[252:253], v23 offset:32768
    s_add_u32 m0, s86, 32768
    ds_read_b64_tr_b16 v[254:255], v23 offset:33280
    buffer_load_dwordx4 v5, s[12:15], s77 offen lds
    s_waitcnt lgkmcnt(4)
    v_mfma_f32_32x32x16_bf16 v[64:79], v[240:243], v[208:211], v[64:79]
    v_mfma_f32_16x16x32_bf16 v[12:15], v[8:11], v[240:243], v[12:15]
    ds_read_b64_tr_b16 v[240:241], v20 offset:40960
    ds_read_b64_tr_b16 v[242:243], v20 offset:41472
    v_mfma_f32_32x32x16_bf16 v[64:79], v[244:247], v[212:215], v[64:79]
    ds_read_b64_tr_b16 v[244:245], v21 offset:40960
    ds_read_b64_tr_b16 v[246:247], v21 offset:41472
    s_waitcnt lgkmcnt(4)
    v_mfma_f32_32x32x16_bf16 v[64:79], v[248:251], v[216:219], v[64:79]
    ds_read_b64_tr_b16 v[248:249], v22 offset:40960
    ds_read_b64_tr_b16 v[250:251], v22 offset:41472
    buffer_load_dwordx4 v42, s[12:15], s77 offen offset:1024 lds
    v_mfma_f32_32x32x16_bf16 v[64:79], v[252:255], v[220:223], v[64:79]
    ds_read_b64_tr_b16 v[252:253], v23 offset:40960
    ds_read_b64_tr_b16 v[254:255], v23 offset:41472
    s_waitcnt lgkmcnt(4)
    v_mfma_f32_32x32x16_bf16 v[64:79], v[240:243], v[224:227], v[64:79]
    v_mfma_f32_16x16x32_bf16 v[12:15], v[8:11], v[240:243], v[12:15]
    v_mfma_f32_32x32x16_bf16 v[64:79], v[244:247], v[228:231], v[64:79]
    s_nop 6
    ds_write_b32 v6, v12
    s_waitcnt vmcnt(8)
    v_cmp_le_u32 vcc, 32, v44
    s_nop 0
    s_andn2_b32 s95, 0x1, vcc_lo
    s_cbranch_scc1 L_slow3
L_ret3:
    s_waitcnt lgkmcnt(0)
    s_barrier
    s_setprio 2
    ds_read_b128 v[56:59], v7 offset:0
    v_mfma_f32_32x32x16_bf16 v[64:79], v[248:251], v[232:235], v[64:79]
    v_mfma_f32_32x32x16_bf16 v[64:79], v[252:255], v[236:239], v[64:79]
    s_waitcnt lgkmcnt(0)
    v_add_f32 v56, v56, v57
    v_add_f32 v58, v58, v59
    v_add_f32 v56, v56, v58
    v_cvt_pk_bf16_f32 v57, v56, v56
    v_lshlrev_b32 v57, 16, v57
    v_sub_f32 v57, v56, v57
    v_cvt_pk_bf16_f32 v32, v56, v57
    s_nop 1
    v_mfma_f32_32x32x8_bf16 v[64:79], v[32:33], v[36:37], v[64:79]
    s_setprio 0
    s_nop 10
    v_mul_f32 v48, v64, v38
    v_mul_f32 v49, v65, v38
    v_mul_f32 v50, v66, v38
    v_mul_f32 v51, v67, v38
    v_exp_f32_e64 v48, v48 clamp
    v_exp_f32_e64 v49, v49 clamp
    v_exp_f32_e64 v50, v50 clamp
    v_exp_f32_e64 v51, v51 clamp
    v_fma_f32 v64, v64, v41, s85
    v_fma_f32 v65, v65, v41, s85
    v_fma_f32 v66, v66, v41, s85
    v_fma_f32 v67, v67, v41, s85
    v_max_f32 v64, s85, v64
    v_max_f32 v65, s85, v65
    v_max_f32 v66, s85, v66
    v_max_f32 v67, s85, v67
    v_add_f32 v64, v64, v48
    v_add_f32 v65, v65, v49
    v_add_f32 v66, v66, v50
    v_add_f32 v67, v67, v51
    v_cvt_pk_bf16_f32 v88, v64, v65
    v_cvt_pk_bf16_f32 v89, v66, v67
    v_mul_f32 v48, v68, v38
    v_mul_f32 v49, v69, v38
    v_mul_f32 v50, v70, v38
    v_mul_f32 v51, v71, v38
    v_exp_f32_e64 v48, v48 clamp
    v_exp_f32_e64 v49, v49 clamp
    v_exp_f32_e64 v50, v50 clamp
    v_exp_f32_e64 v51, v51 clamp
    v_fma_f32 v68, v68, v41, s85
    v_fma_f32 v69, v69, v41, s85
    v_fma_f32 v70, v70, v41, s85
    v_fma_f32 v71, v71, v41, s85
    v_max_f32 v68, s85, v68
    v_max_f32 v69, s85, v69
    v_max_f32 v70, s85, v70
    v_max_f32 v71, s85, v71
    v_add_f32 v68, v68, v48
    v_add_f32 v69, v69, v49
    v_add_f32 v70, v70, v50
    v_add_u32 v20, 0xffff0000, v20
    v_add_f32 v71, v71, v51
    v_cvt_pk_bf16_f32 v90, v68, v69
    v_cvt_pk_bf16_f32 v91, v70, v71
    v_add_u32 v21, 0xffff0000, v21
    v_mul_f32 v48, v72, v38
    v_mul_f32 v49, v73, v38
    v_add_u32 v22, 0xffff0000, v22
    v_mul_f32 v50, v74, v38
    v_mul_f32 v51, v75, v38
    v_exp_f32_e64 v48, v48 clamp
    v_add_u32 v23, 0xffff0000, v23
    v_exp_f32_e64 v49, v49 clamp
    v_exp_f32_e64 v50, v50 clamp
    ds_read_b64_tr_b16 v[240:241], v20 offset:0
    v_exp_f32_e64 v51, v51 clamp
    v_fma_f32 v72, v72, v41, s85
    v_fma_f32 v73, v73, v41, s85
    ds_read_b64_tr_b16 v[242:243], v20 offset:512
    v_fma_f32 v74, v74, v41, s85
    v_fma_f32 v75, v75, v41, s85
    v_max_f32 v72, s85, v72
    ds_read_b64_tr_b16 v[244:245], v21 offset:0
    v_max_f32 v73, s85, v73
    v_max_f32 v74, s85, v74
    ds_read_b64_tr_b16 v[246:247], v21 offset:512
    v_max_f32 v75, s85, v75
    v_add_f32 v72, v72, v48
    v_add_f32 v73, v73, v49
    ds_read_b64_tr_b16 v[248:249], v22 offset:0
    v_add_f32 v74, v74, v50
    v_add_f32 v75, v75, v51
    v_cvt_pk_bf16_f32 v92, v72, v73
    ds_read_b64_tr_b16 v[250:251], v22 offset:512
    v_cvt_pk_bf16_f32 v93, v74, v75
    v_mul_f32 v48, v76, v38
    ds_read_b64_tr_b16 v[252:253], v23 offset:0
    v_mul_f32 v49, v77, v38
    v_mul_f32 v50, v78, v38
    v_mul_f32 v51, v79, v38
    ds_read_b64_tr_b16 v[254:255], v23 offset:512
    v_exp_f32_e64 v48, v48 clamp
    v_exp_f32_e64 v49, v49 clamp
    v_exp_f32_e64 v50, v50 clamp
    v_exp_f32_e64 v51, v51 clamp
    v_fma_f32 v76, v76, v41, s85
    v_fma_f32 v77, v77, v41, s85
    v_fma_f32 v78, v78, v41, s85
    v_fma_f32 v79, v79, v41, s85
    v_max_f32 v76, s85, v76
    v_max_f32 v77, s85, v77
    v_max_f32 v78, s85, v78
    v_max_f32 v79, s85, v79
    v_add_f32 v76, v76, v48
    v_add_f32 v77, v77, v49
    v_add_f32 v78, v78, v50
    v_add_f32 v79, v79, v51
    v_cvt_pk_bf16_f32 v94, v76, v77
    v_cvt_pk_bf16_f32 v95, v78, v79
    v_cndmask_b32 v94, v94, 0, s[92:93]
    v_cndmask_b32 v95, v95, 0, s[92:93]
    s_waitcnt vmcnt(0) lgkmcnt(0)
    s_barrier
    s_setprio 1
    v_mfma_f32_32x32x16_bf16 v[64:79], v[240:243], v[128:131], 0
    v_mfma_f32_16x16x32_bf16 v[12:15], v[8:11], v[240:243], 0
    ds_read_b64_tr_b16 v[240:241], v20 offset:8192
    ds_read_b64_tr_b16 v[242:243], v20 offset:8704
    v_mfma_f32_32x32x16_bf16 v[64:79], v[244:247], v[132:135], v[64:79]
    ds_read_b64_tr_b16 v[244:245], v21 offset:8192
    ds_read_b64_tr_b16 v[246:247], v21 offset:8704
    v_add_u32 v5, 112, v5
    s_add_u32 m0, s86, 65536
    v_add_u32 v42, 112, v42
    buffer_load_dwordx4 v5, s[12:15], s74 offen lds
    v_mfma_f32_32x32x16_bf16 v[64:79], v[248:251], v[136:139], v[64:79]
    ds_read_b64_tr_b16 v[248:249], v22 offset:8192
    ds_read_b64_tr_b16 v[250:251], v22 offset:8704
    v_mfma_f32_32x32x16_bf16 v[64:79], v[252:255], v[140:143], v[64:79]
    ds_read_b64_tr_b16 v[252:253], v23 offset:8192
    ds_read_b64_tr_b16 v[254:255], v23 offset:8704
    s_waitcnt lgkmcnt(4)
    v_mfma_f32_32x32x16_bf16 v[64:79], v[240:243], v[144:147], v[64:79]
    v_mfma_f32_16x16x32_bf16 v[12:15], v[8:11], v[240:243], v[12:15]
    ds_read_b64_tr_b16 v[240:241], v20 offset:16384
    ds_read_b64_tr_b16 v[242:243], v20 offset:16896
    buffer_load_dwordx4 v42, s[12:15], s74 offen offset:1024 lds
    v_mfma_f32_32x32x16_bf16 v[64:79], v[244:247], v[148:151], v[64:79]
    ds_read_b64_tr_b16 v[244:245], v21 offset:16384
    ds_read_b64_tr_b16 v[246:247], v21 offset:16896
    s_waitcnt lgkmcnt(4)
    v_mfma_f32_32x32x16_bf16 v[64:79], v[248:251], v[152:155], v[64:79]
    ds_read_b64_tr_b16 v[248:249], v22 offset:16384
    ds_read_b64_tr_b16 v[250:251], v22 offset:16896
    v_mfma_f32_32x32x16_bf16 v[64:79], v[252:255], v[156:159], v[64:79]
    ds_read_b64_tr_b16 v[252:253], v23 offset:16384
    s_add_u32 m0, s86, 73728
    ds_read_b64_tr_b16 v[254:255], v23 offset:16896
    buffer_load_dwordx4 v5, s[12:15], s75 offen lds
    s_waitcnt lgkmcnt(4)
    v_mfma_f32_32x32x16_bf16 v[64:79], v[240:243], v[160:163], v[64:79]
    v_mfma_f32_16x16x32_bf16 v[12:15], v[8:11], v[240:243], v[12:15]
    ds_read_b64_tr_b16 v[240:241], v20 offset:24576
    ds_read_b64_tr_b16 v[242:243], v20 offset:25088
    v_mfma_f32_32x32x16_bf16 v[64:79], v[244:247], v[164:167], v[64:79]
    ds_read_b64_tr_b16 v[244:245], v21 offset:24576
    ds_read_b64_tr_b16 v[246:247], v21 offset:25088
    s_waitcnt lgkmcnt(4)
    v_mfma_f32_32x32x16_bf16 v[64:79], v[248:251], v[168:171], v[64:79]
    ds_read_b64_tr_b16 v[248:249], v22 offset:24576
    ds_read_b64_tr_b16 v[250:251], v22 offset:25088
    buffer_load_dwordx4 v42, s[12:15], s75 offen offset:1024 lds
    v_mfma_f32_32x32x16_bf16 v[64:79], v[252:255], v[172:175], v[64:79]
    ds_read_b64_tr_b16 v[252:253], v23 offset:24576
    ds_read_b64_tr_b16 v[254:255], v23 offset:25088
    s_waitcnt lgkmcnt(4)
    v_mfma_f32_32x32x16_bf16 v[64:79], v[240:243], v[176:179], v[64:79]
    v_mfma_f32_16x16x32_bf16 v[12:15], v[8:11], v[240:243], v[12:15]
    ds_read_b64_tr_b16 v[240:241], v20 offset:32768
    ds_read_b64_tr_b16 v[242:243], v20 offset:33280
    v_mfma_f32_32x32x16_bf16 v[64:79], v[244:247], v[180:183], v[64:79]
    ds_read_b64_tr_b16 v[244:245], v21 offset:32768
    s_add_u32 m0, s86, 81920
    ds_read_b64_tr_b16 v[246:247], v21 offset:33280
    buffer_load_dwordx4 v5, s[12:15], s76 offen lds
    s_waitcnt lgkmcnt(4)
    v_mfma_f32_32x32x16_bf16 v[64:79], v[248:251], v[184:187], v[64:79]
    ds_read_b64_tr_b16 v[248:249], v22 offset:32768
    ds_read_b64_tr_b16 v[250:251], v22 offset:33280
    v_mfma_f32_32x32x16_bf16 v[64:79], v[252:255], v[188:191], v[64:79]
    ds_read_b64_tr_b16 v[252:253], v23 offset:32768
    ds_read_b64_tr_b16 v[254:255], v23 offset:33280
    s_waitcnt lgkmcnt(4)
    v_mfma_f32_32x32x16_bf16 v[64:79], v[240:243], v[192:195], v[64:79]
    v_mfma_f32_16x16x32_bf16 v[12:15], v[8:11], v[240:243], v[12:15]
    ds_read_b64_tr_b16 v[240:241], v20 offset:40960
    ds_read_b64_tr_b16 v[242:243], v20 offset:41472
    buffer_load_dwordx4 v42, s[12:15], s76 offen offset:1024 lds
    v_mfma_f32_32x32x16_bf16 v[64:79], v[244:247], v[196:199], v[64:79]
    ds_read_b64_tr_b16 v[244:245], v21 offset:40960
    ds_read_b64_tr_b16 v[246:247], v21 offset:41472
    s_waitcnt lgkmcnt(4)
    v_mfma_f32_32x32x16_bf16 v[64:79], v[248:251], v[200:203], v[64:79]
    ds_read_b64_tr_b16 v[248:249], v22 offset:40960
    ds_read_b64_tr_b16 v[250:251], v22 offset:41472
    v_mfma_f32_32x32x16_bf16 v[64:79], v[252:255], v[204:207], v[64:79]
    ds_read_b64_tr_b16 v[252:253], v23 offset:40960
    s_add_u32 m0, s86, 90112
    ds_read_b64_tr_b16 v[254:255], v23 offset:41472
    buffer_load_dwordx4 v5, s[12:15], s77 offen lds
    s_waitcnt lgkmcnt(4)
    v_mfma_f32_32x32x16_bf16 v[64:79], v[240:243], v[208:211], v[64:79]
    v_mfma_f32_16x16x32_bf16 v[12:15], v[8:11], v[240:243], v[12:15]
    ds_read_b64_tr_b16 v[240:241], v20 offset:49152
    ds_read_b64_tr_b16 v[242:243], v20 offset:49664
    v_mfma_f32_32x32x16_bf16 v[64:79], v[244:247], v[212:215], v[64:79]
    ds_read_b64_tr_b16 v[244:245], v21 offset:49152
    ds_read_b64_tr_b16 v[246:247], v21 offset:49664
    s_waitcnt lgkmcnt(4)
    v_mfma_f32_32x32x16_bf16 v[64:79], v[248:251], v[216:219], v[64:79]
    ds_read_b64_tr_b16 v[248:249], v22 offset:49152
    ds_read_b64_tr_b16 v[250:251], v22 offset:49664
    buffer_load_dwordx4 v42, s[12:15], s77 offen offset:1024 lds
    v_mfma_f32_32x32x16_bf16 v[64:79], v[252:255], v[220:223], v[64:79]
    ds_read_b64_tr_b16 v[252:253], v23 offset:49152
    ds_read_b64_tr_b16 v[254:255], v23 offset:49664
    s_waitcnt lgkmcnt(4)
    v_mfma_f32_32x32x16_bf16 v[64:79], v[240:243], v[224:227], v[64:79]
    v_mfma_f32_16x16x32_bf16 v[12:15], v[8:11], v[240:243], v[12:15]
    v_mfma_f32_32x32x16_bf16 v[64:79], v[244:247], v[228:231], v[64:79]
    s_nop 6
    ds_write_b32 v6, v12
    s_waitcnt lgkmcnt(0)
    s_barrier
    s_setprio 2
    ds_read_b128 v[56:59], v7 offset:0
    v_mfma_f32_32x32x16_bf16 v[64:79], v[248:251], v[232:235], v[64:79]
    v_mfma_f32_32x32x16_bf16 v[64:79], v[252:255], v[236:239], v[64:79]
    s_waitcnt lgkmcnt(0)
    v_add_f32 v56, v56, v57
    v_add_f32 v58, v58, v59
    v_add_f32 v56, v56, v58
    v_cvt_pk_bf16_f32 v57, v56, v56
    v_lshlrev_b32 v57, 16, v57
    v_sub_f32 v57, v56, v57
    v_cvt_pk_bf16_f32 v32, v56, v57
    s_nop 1
    v_mfma_f32_32x32x8_bf16 v[64:79], v[32:33], v[36:37], v[64:79]
    s_setprio 0
    s_nop 10
    v_mul_f32 v48, v64, v38
    v_mul_f32 v49, v65, v38
    v_mul_f32 v50, v66, v38
    v_mul_f32 v51, v67, v38
    v_exp_f32_e64 v48, v48 clamp
    v_exp_f32_e64 v49, v49 clamp
    v_exp_f32_e64 v50, v50 clamp
    v_exp_f32_e64 v51, v51 clamp
    v_fma_f32 v64, v64, v41, s85
    v_fma_f32 v65, v65, v41, s85
    v_fma_f32 v66, v66, v41, s85
    v_fma_f32 v67, v67, v41, s85
    v_max_f32 v64, s85, v64
    v_max_f32 v65, s85, v65
    v_max_f32 v66, s85, v66
    v_max_f32 v67, s85, v67
    v_add_f32 v64, v64, v48
    v_add_f32 v65, v65, v49
    v_add_f32 v66, v66, v50
    v_add_f32 v67, v67, v51
    v_cvt_pk_bf16_f32 v96, v64, v65
    v_cvt_pk_bf16_f32 v97, v66, v67
    v_mul_f32 v48, v68, v38
    v_mul_f32 v49, v69, v38
    v_mul_f32 v50, v70, v38
    v_mul_f32 v51, v71, v38
    v_exp_f32_e64 v48, v48 clamp
    v_exp_f32_e64 v49, v49 clamp
    v_exp_f32_e64 v50, v50 clamp
    v_exp_f32_e64 v51, v51 clamp
    v_fma_f32 v68, v68, v41, s85
    v_fma_f32 v69, v69, v41, s85
    v_fma_f32 v70, v70, v41, s85
    v_fma_f32 v71, v71, v41, s85
    v_max_f32 v68, s85, v68
    v_max_f32 v69, s85, v69
    v_max_f32 v70, s85, v70
    v_max_f32 v71, s85, v71
    v_add_f32 v68, v68, v48
    v_add_f32 v69, v69, v49
    v_add_f32 v70, v70, v50
    ds_read_b64_tr_b16 v[240:241], v20 offset:57344
    v_add_f32 v71, v71, v51
    v_cvt_pk_bf16_f32 v98, v68, v69
    v_cvt_pk_bf16_f32 v99, v70, v71
    v_mul_f32 v48, v72, v38
    ds_read_b64_tr_b16 v[242:243], v20 offset:57856
    v_mul_f32 v49, v73, v38
    v_mul_f32 v50, v74, v38
    v_mul_f32 v51, v75, v38
    v_exp_f32_e64 v48, v48 clamp
    ds_read_b64_tr_b16 v[244:245], v21 offset:57344
    v_exp_f32_e64 v49, v49 clamp
    v_exp_f32_e64 v50, v50 clamp
    v_exp_f32_e64 v51, v51 clamp
    v_fma_f32 v72, v72, v41, s85
    ds_read_b64_tr_b16 v[246:247], v21 offset:57856
    v_fma_f32 v73, v73, v41, s85
    v_fma_f32 v74, v74, v41, s85
    v_fma_f32 v75, v75, v41, s85
    v_max_f32 v72, s85, v72
    ds_read_b64_tr_b16 v[248:249], v22 offset:57344
    v_max_f32 v73, s85, v73
    v_max_f32 v74, s85, v74
    v_max_f32 v75, s85, v75
    v_add_f32 v72, v72, v48
    ds_read_b64_tr_b16 v[250:251], v22 offset:57856
    v_add_f32 v73, v73, v49
    v_add_f32 v74, v74, v50
    v_add_f32 v75, v75, v51
    v_cvt_pk_bf16_f32 v100, v72, v73
    ds_read_b64_tr_b16 v[252:253], v23 offset:57344
    v_cvt_pk_bf16_f32 v101, v74, v75
    v_mul_f32 v48, v76, v38
    v_mul_f32 v49, v77, v38
    v_mul_f32 v50, v78, v38
    ds_read_b64_tr_b16 v[254:255], v23 offset:57856
    v_mul_f32 v51, v79, v38
    v_exp_f32_e64 v48, v48 clamp
    v_exp_f32_e64 v49, v49 clamp
    v_exp_f32_e64 v50, v50 clamp
    v_exp_f32_e64 v51, v51 clamp
    v_fma_f32 v76, v76, v41, s85
    v_fma_f32 v77, v77, v41, s85
    v_fma_f32 v78, v78, v41, s85
    v_fma_f32 v79, v79, v41, s85
    v_max_f32 v76, s85, v76
    v_max_f32 v77, s85, v77
    v_max_f32 v78, s85, v78
    v_max_f32 v79, s85, v79
    v_add_f32 v76, v76, v48
    v_add_f32 v77, v77, v49
    v_add_f32 v78, v78, v50
    v_add_f32 v79, v79, v51
    v_cvt_pk_bf16_f32 v102, v76, v77
    v_cvt_pk_bf16_f32 v103, v78, v79
    v_cndmask_b32 v102, v102, 0, s[92:93]
    v_cndmask_b32 v103, v103, 0, s[92:93]
    s_waitcnt vmcnt(0) lgkmcnt(0)
    s_barrier
    s_setprio 1
    v_mfma_f32_32x32x16_bf16 v[64:79], v[240:243], v[128:131], 0
    v_mfma_f32_16x16x32_bf16 v[12:15], v[8:11], v[240:243], 0
    v_add_u32 v20, 0x10000, v20
    v_add_u32 v21, 0x10000, v21
    v_add_u32 v22, 0x10000, v22
    v_add_u32 v23, 0x10000, v23
    ds_read_b64_tr_b16 v[240:241], v20 offset:0
    ds_read_b64_tr_b16 v[242:243], v20 offset:512
    v_mfma_f32_32x32x16_bf16 v[64:79], v[244:247], v[132:135], v[64:79]
    ds_read_b64_tr_b16 v[244:245], v21 offset:0
    ds_read_b64_tr_b16 v[246:247], v21 offset:512
    v_mfma_f32_32x32x16_bf16 v[64:79], v[248:251], v[136:139], v[64:79]
    ds_read_b64_tr_b16 v[248:249], v22 offset:0
    ds_read_b64_tr_b16 v[250:251], v22 offset:512
    v_mfma_f32_32x32x16_bf16 v[64:79], v[252:255], v[140:143], v[64:79]
    ds_read_b64_tr_b16 v[252:253], v23 offset:0
    ds_read_b64_tr_b16 v[254:255], v23 offset:512
    s_waitcnt lgkmcnt(4)
    v_mfma_f32_32x32x16_bf16 v[64:79], v[240:243], v[144:147], v[64:79]
    v_mfma_f32_16x16x32_bf16 v[12:15], v[8:11], v[240:243], v[12:15]
    ds_read_b64_tr_b16 v[240:241], v20 offset:8192
    ds_read_b64_tr_b16 v[242:243], v20 offset:8704
    v_mfma_f32_32x32x16_bf16 v[64:79], v[244:247], v[148:151], v[64:79]
    ds_read_b64_tr_b16 v[244:245], v21 offset:8192
    ds_read_b64_tr_b16 v[246:247], v21 offset:8704
    s_waitcnt lgkmcnt(4)
    v_mfma_f32_32x32x16_bf16 v[64:79], v[248:251], v[152:155], v[64:79]
    ds_read_b64_tr_b16 v[248:249], v22 offset:8192
    ds_read_b64_tr_b16 v[250:251], v22 offset:8704
    v_mfma_f32_32x32x16_bf16 v[64:79], v[252:255], v[156:159], v[64:79]
    ds_read_b64_tr_b16 v[252:253], v23 offset:8192
    ds_read_b64_tr_b16 v[254:255], v23 offset:8704
    s_waitcnt lgkmcnt(4)
    v_mfma_f32_32x32x16_bf16 v[64:79], v[240:243], v[160:163], v[64:79]
    v_mfma_f32_16x16x32_bf16 v[12:15], v[8:11], v[240:243], v[12:15]
    ds_read_b64_tr_b16 v[240:241], v20 offset:16384
    ds_read_b64_tr_b16 v[242:243], v20 offset:16896
    v_mfma_f32_32x32x16_bf16 v[64:79], v[244:247], v[164:167], v[64:79]
    ds_read_b64_tr_b16 v[244:245], v21 offset:16384
    ds_read_b64_tr_b16 v[246:247], v21 offset:16896
    s_waitcnt lgkmcnt(4)
    v_mfma_f32_32x32x16_bf16 v[64:79], v[248:251], v[168:171], v[64:79]
    ds_read_b64_tr_b16 v[248:249], v22 offset:16384
    ds_read_b64_tr_b16 v[250:251], v22 offset:16896
    v_mfma_f32_32x32x16_bf16 v[64:79], v[252:255], v[172:175], v[64:79]
    ds_read_b64_tr_b16 v[252:253], v23 offset:16384
    ds_read_b64_tr_b16 v[254:255], v23 offset:16896
    s_waitcnt lgkmcnt(4)
    v_mfma_f32_32x32x16_bf16 v[64:79], v[240:243], v[176:179], v[64:79]
    v_mfma_f32_16x16x32_bf16 v[12:15], v[8:11], v[240:243], v[12:15]
    ds_read_b64_tr_b16 v[240:241], v20 offset:24576
    ds_read_b64_tr_b16 v[242:243], v20 offset:25088
    v_mfma_f32_32x32x16_bf16 v[64:79], v[244:247], v[180:183], v[64:79]
    ds_read_b64_tr_b16 v[244:245], v21 offset:24576
    ds_read_b64_tr_b16 v[246:247], v21 offset:25088
    s_waitcnt lgkmcnt(4)
    v_mfma_f32_32x32x16_bf16 v[64:79], v[248:251], v[184:187], v[64:79]
    ds_read_b64_tr_b16 v[248:249], v22 offset:24576
    ds_read_b64_tr_b16 v[250:251], v22 offset:25088
    v_mfma_f32_32x32x16_bf16 v[64:79], v[252:255], v[188:191], v[64:79]
    ds_read_b64_tr_b16 v[252:253], v23 offset:24576
    ds_read_b64_tr_b16 v[254:255], v23 offset:25088
    s_waitcnt lgkmcnt(4)
    v_mfma_f32_32x32x16_bf16 v[64:79], v[240:243], v[192:195], v[64:79]
    v_mfma_f32_16x16x32_bf16 v[12:15], v[8:11], v[240:243], v[12:15]
    ds_read_b64_tr_b16 v[240:241], v20 offset:32768
    ds_read_b64_tr_b16 v[242:243], v20 offset:33280
    v_mfma_f32_32x32x16_bf16 v[64:79], v[244:247], v[196:199], v[64:79]
    ds_read_b64_tr_b16 v[244:245], v21 offset:32768
    ds_read_b64_tr_b16 v[246:247], v21 offset:33280
    s_waitcnt lgkmcnt(4)
    v_mfma_f32_32x32x16_bf16 v[64:79], v[248:251], v[200:203], v[64:79]
    ds_read_b64_tr_b16 v[248:249], v22 offset:32768
    ds_read_b64_tr_b16 v[250:251], v22 offset:33280
    v_mfma_f32_32x32x16_bf16 v[64:79], v[252:255], v[204:207], v[64:79]
    ds_read_b64_tr_b16 v[252:253], v23 offset:32768
    ds_read_b64_tr_b16 v[254:255], v23 offset:33280
    s_waitcnt lgkmcnt(4)
    v_mfma_f32_32x32x16_bf16 v[64:79], v[240:243], v[208:211], v[64:79]
    v_mfma_f32_16x16x32_bf16 v[12:15], v[8:11], v[240:243], v[12:15]
    ds_read_b64_tr_b16 v[240:241], v20 offset:40960
    ds_read_b64_tr_b16 v[242:243], v20 offset:41472
    v_mfma_f32_32x32x16_bf16 v[64:79], v[244:247], v[212:215], v[64:79]
    ds_read_b64_tr_b16 v[244:245], v21 offset:40960
    ds_read_b64_tr_b16 v[246:247], v21 offset:41472
    s_waitcnt lgkmcnt(4)
    v_mfma_f32_32x32x16_bf16 v[64:79], v[248:251], v[216:219], v[64:79]
    ds_read_b64_tr_b16 v[248:249], v22 offset:40960
    ds_read_b64_tr_b16 v[250:251], v22 offset:41472
    v_mfma_f32_32x32x16_bf16 v[64:79], v[252:255], v[220:223], v[64:79]
    ds_read_b64_tr_b16 v[252:253], v23 offset:40960
    ds_read_b64_tr_b16 v[254:255], v23 offset:41472
    s_waitcnt lgkmcnt(4)
    v_mfma_f32_32x32x16_bf16 v[64:79], v[240:243], v[224:227], v[64:79]
    v_mfma_f32_16x16x32_bf16 v[12:15], v[8:11], v[240:243], v[12:15]
    v_mfma_f32_32x32x16_bf16 v[64:79], v[244:247], v[228:231], v[64:79]
    s_nop 6
    ds_write_b32 v6, v12
    s_waitcnt lgkmcnt(0)
    s_barrier
    s_setprio 2
    ds_read_b128 v[56:59], v7 offset:0
    v_mfma_f32_32x32x16_bf16 v[64:79], v[248:251], v[232:235], v[64:79]
    v_mfma_f32_32x32x16_bf16 v[64:79], v[252:255], v[236:239], v[64:79]
    s_waitcnt lgkmcnt(0)
    v_add_f32 v56, v56, v57
    v_add_f32 v58, v58, v59
    v_add_f32 v56, v56, v58
    v_cvt_pk_bf16_f32 v57, v56, v56
    v_lshlrev_b32 v57, 16, v57
    v_sub_f32 v57, v56, v57
    v_cvt_pk_bf16_f32 v32, v56, v57
    s_nop 1
    v_mfma_f32_32x32x8_bf16 v[64:79], v[32:33], v[36:37], v[64:79]
    s_setprio 0
    s_nop 10
    v_mul_f32 v48, v64, v38
    v_mul_f32 v49, v65, v38
    v_mul_f32 v50, v66, v38
    v_mul_f32 v51, v67, v38
    v_exp_f32_e64 v48, v48 clamp
    v_exp_f32_e64 v49, v49 clamp
    v_exp_f32_e64 v50, v50 clamp
    v_exp_f32_e64 v51, v51 clamp
    v_fma_f32 v64, v64, v41, s85
    v_fma_f32 v65, v65, v41, s85
    v_fma_f32 v66, v66, v41, s85
    v_fma_f32 v67, v67, v41, s85
    v_max_f32 v64, s85, v64
    v_max_f32 v65, s85, v65
    v_max_f32 v66, s85, v66
    v_max_f32 v67, s85, v67
    v_add_f32 v64, v64, v48
    v_add_f32 v65, v65, v49
    v_add_f32 v66, v66, v50
    v_add_f32 v67, v67, v51
    v_cvt_pk_bf16_f32 v104, v64, v65
    v_cvt_pk_bf16_f32 v105, v66, v67
    v_mul_f32 v48, v68, v38
    v_mul_f32 v49, v69, v38
    v_mul_f32 v50, v70, v38
    v_mul_f32 v51, v71, v38
    v_exp_f32_e64 v48, v48 clamp
    v_exp_f32_e64 v49, v49 clamp
    v_exp_f32_e64 v50, v50 clamp
    v_exp_f32_e64 v51, v51 clamp
    v_fma_f32 v68, v68, v41, s85
    v_fma_f32 v69, v69, v41, s85
    v_fma_f32 v70, v70, v41, s85
    v_fma_f32 v71, v71, v41, s85
    v_max_f32 v68, s85, v68
    v_max_f32 v69, s85, v69
    v_max_f32 v70, s85, v70
    v_max_f32 v71, s85, v71
    v_add_f32 v68, v68, v48
    v_add_f32 v69, v69, v49
    v_add_f32 v70, v70, v50
    v_add_f32 v71, v71, v51
    v_cvt_pk_bf16_f32 v106, v68, v69
    v_cvt_pk_bf16_f32 v107, v70, v71
    v_mul_f32 v48, v72, v38
    v_mul_f32 v49, v73, v38
    v_mul_f32 v50, v74, v38
    v_mul_f32 v51, v75, v38
    v_exp_f32_e64 v48, v48 clamp
    v_exp_f32_e64 v49, v49 clamp
    v_exp_f32_e64 v50, v50 clamp
    v_exp_f32_e64 v51, v51 clamp
    v_fma_f32 v72, v72, v41, s85
    v_fma_f32 v73, v73, v41, s85
    v_fma_f32 v74, v74, v41, s85
    v_fma_f32 v75, v75, v41, s85
    v_max_f32 v72, s85, v72
    v_max_f32 v73, s85, v73
    v_max_f32 v74, s85, v74
    v_max_f32 v75, s85, v75
    v_add_f32 v72, v72, v48
    v_add_f32 v73, v73, v49
    v_add_f32 v74, v74, v50
    v_add_f32 v75, v75, v51
    v_cvt_pk_bf16_f32 v108, v72, v73
    v_cvt_pk_bf16_f32 v109, v74, v75
    v_mul_f32 v48, v76, v38
    v_mul_f32 v49, v77, v38
    v_mul_f32 v50, v78, v38
    v_mul_f32 v51, v79, v38
    v_exp_f32_e64 v48, v48 clamp
    v_exp_f32_e64 v49, v49 clamp
    v_exp_f32_e64 v50, v50 clamp
    v_exp_f32_e64 v51, v51 clamp
    v_fma_f32 v76, v76, v41, s85
    v_fma_f32 v77, v77, v41, s85
    v_fma_f32 v78, v78, v41, s85
    v_fma_f32 v79, v79, v41, s85
    v_max_f32 v76, s85, v76
    v_max_f32 v77, s85, v77
    v_max_f32 v78, s85, v78
    v_max_f32 v79, s85, v79
    v_add_f32 v76, v76, v48
    v_add_f32 v77, v77, v49
    v_add_f32 v78, v78, v50
    v_add_f32 v79, v79, v51
    v_cvt_pk_bf16_f32 v110, v76, v77
    v_cvt_pk_bf16_f32 v111, v78, v79
    v_cndmask_b32 v110, v110, 0, s[92:93]
    v_cndmask_b32 v111, v111, 0, s[92:93]
    s_lshl2_add_u32 s82, s81, s4
    s_lshl_b32 s73, s82, 8
    s_add_u32 s73, s73, 0x910000
    s_lshl_b32 s82, s82, 13
    s_add_u32 s82, s82, 0x900000
    s_add_u32 s88, s82, 4096
    v_cmp_gt_u32 vcc, 32, v1
    v_lshlrev_b32 v31, 3, v1
    s_nop 0
    v_cndmask_b32 v31, v46, v31, vcc
    v_lshrrev_b32 v48, 2, v1
    s_lshl1_add_u32 s83, s86, 114688
    v_add_u32 v49, s83, v1
    s_barrier
L_qs4:
    v_mov_b32 v44, 0
    buffer_atomic_add v44, v31, s[16:19], s73 offen sc0 sc1
    s_add_u32 s94, s94, 1
    s_cmp_gt_u32 s94, 0x10000
    s_waitcnt vmcnt(0)
    s_cbranch_scc1 L_qz4
    v_cmp_le_u32 vcc, 16, v44
    s_nop 0
    s_andn2_b32 s95, 3, vcc_lo
    s_cbranch_scc1 L_qs4
L_qz4:
    buffer_load_dword v128, v48, s[16:19], s82 offen offset:0 sc1
    buffer_load_dword v129, v48, s[16:19], s82 offen offset:256 sc1
    buffer_load_dword v130, v48, s[16:19], s82 offen offset:512 sc1
    buffer_load_dword v131, v48, s[16:19], s82 offen offset:768 sc1
    buffer_load_dword v132, v48, s[16:19], s82 offen offset:1024 sc1
    buffer_load_dword v133, v48, s[16:19], s82 offen offset:1280 sc1
    buffer_load_dword v134, v48, s[16:19], s82 offen offset:1536 sc1
    buffer_load_dword v135, v48, s[16:19], s82 offen offset:1792 sc1
    buffer_load_dword v136, v48, s[16:19], s82 offen offset:2048 sc1
    buffer_load_dword v137, v48, s[16:19], s82 offen offset:2304 sc1
    buffer_load_dword v138, v48, s[16:19], s82 offen offset:2560 sc1
    buffer_load_dword v139, v48, s[16:19], s82 offen offset:2816 sc1
    buffer_load_dword v140, v48, s[16:19], s82 offen offset:3072 sc1
    buffer_load_dword v141, v48, s[16:19], s82 offen offset:3328 sc1
    buffer_load_dword v142, v48, s[16:19], s82 offen offset:3584 sc1
    buffer_load_dword v143, v48, s[16:19], s82 offen offset:3840 sc1
    buffer_load_dword v144, v48, s[16:19], s88 offen offset:0 sc1
    buffer_load_dword v145, v48, s[16:19], s88 offen offset:256 sc1
    buffer_load_dword v146, v48, s[16:19], s88 offen offset:512 sc1
    buffer_load_dword v147, v48, s[16:19], s88 offen offset:768 sc1
    buffer_load_dword v148, v48, s[16:19], s88 offen offset:1024 sc1
    buffer_load_dword v149, v48, s[16:19], s88 offen offset:1280 sc1
    buffer_load_dword v150, v48, s[16:19], s88 offen offset:1536 sc1
    buffer_load_dword v151, v48, s[16:19], s88 offen offset:1792 sc1
    buffer_load_dword v152, v48, s[16:19], s88 offen offset:2048 sc1
    buffer_load_dword v153, v48, s[16:19], s88 offen offset:2304 sc1
    buffer_load_dword v154, v48, s[16:19], s88 offen offset:2560 sc1
    buffer_load_dword v155, v48, s[16:19], s88 offen offset:2816 sc1
    buffer_load_dword v156, v48, s[16:19], s88 offen offset:3072 sc1
    buffer_load_dword v157, v48, s[16:19], s88 offen offset:3328 sc1
    buffer_load_dword v158, v48, s[16:19], s88 offen offset:3584 sc1
    buffer_load_dword v159, v48, s[16:19], s88 offen offset:3840 sc1
    s_waitcnt vmcnt(24)
    v_cvt_pk_bf16_f32 v128, v128, v129
    v_cvt_pk_bf16_f32 v129, v130, v131
    v_cvt_pk_bf16_f32 v130, v132, v133
    v_cvt_pk_bf16_f32 v131, v134, v135
    ds_write_b128 v49, v[128:131] offset:0
    s_waitcnt vmcnt(16)
    v_cvt_pk_bf16_f32 v136, v136, v137
    v_cvt_pk_bf16_f32 v137, v138, v139
    v_cvt_pk_bf16_f32 v138, v140, v141
    v_cvt_pk_bf16_f32 v139, v142, v143
    ds_write_b128 v49, v[136:139] offset:1024
    s_waitcnt vmcnt(8)
    v_cvt_pk_bf16_f32 v144, v144, v145
    v_cvt_pk_bf16_f32 v145, v146, v147
    v_cvt_pk_bf16_f32 v146, v148, v149
    v_cvt_pk_bf16_f32 v147, v150, v151
    ds_write_b128 v49, v[144:147] offset:2048
    s_waitcnt vmcnt(0)
    v_cvt_pk_bf16_f32 v152, v152, v153
    v_cvt_pk_bf16_f32 v153, v154, v155
    v_cvt_pk_bf16_f32 v154, v156, v157
    v_cvt_pk_bf16_f32 v155, v158, v159
    ds_write_b128 v49, v[152:155] offset:3072
    s_branch L_qo
L_qb:
    s_add_u32 m0, s87, 131072
    s_nop 0
    buffer_load_dwordx4 v3, s[8:11], s67 offen lds
    buffer_load_dwordx4 v4, s[8:11], s67 offen offset:1024 lds
    s_add_u32 m0, s86, 8192
    s_nop 0
    buffer_load_dwordx4 v5, s[12:15], s74 offen lds
    buffer_load_dwordx4 v42, s[12:15], s74 offen offset:1024 lds
    s_mov_b32 s22, 0x188000
    s_mov_b32 s23, 0x20000
    s_mov_b32 s26, 0x62000
    s_mov_b32 s27, 0x20000
    s_mov_b32 s30, 0x1c0000
    s_mov_b32 s31, 0x20000
    s_mov_b32 s38, 0x380
    s_mov_b32 s39, 0x20000
    s_mov_b32 s85, 0x358637bd
    s_mov_b32 s99, 0x3fb8aa3b
    s_mov_b32 s92, 0
    s_mov_b32 s93, -1
    s_mov_b32 s94, 0
    v_and_b32 v52, 7, v52
    v_mul_u32_u24 v2, 896, v49
    v_lshl_add_u32 v2, v52, 4, v2
    s_lshl_b32 s83, s5, 9
    s_add_u32 s83, s83, 159744
    v_lshl_add_u32 v7, v56, 4, s83
    v_lshl_add_u32 v6, s4, 2, v7
    s_lshl2_add_u32 s83, s3, 157696
    v_mov_b32 v45, s83
    ds_write_b32 v45, v33 offset:0
    v_lshlrev_b32 v37, 2, v61
    v_add_u32 v36, 155648, v37
    s_and_b32 s83, s2, 7
    s_lshl2_add_u32 s80, s83, s80
    s_lshl1_add_u32 s83, s80, s7
    s_and_b32 s89, s83, 3
    s_and_b32 s83, s83, 4
    s_lshl2_add_u32 s89, s83, s89
    s_lshl2_add_u32 s90, s6, s4
    s_mul_i32 s90, s90, 147456
    s_add_u32 s90, s90, 121856
    s_mul_i32 s83, s81, 14336
    s_add_u32 s90, s90, s83
    s_mov_b32 s91, 0x40000000
    s_barrier
    s_setprio 1
    s_add_u32 m0, s87, 65536
    s_nop 0
    buffer_load_dwordx4 v3, s[8:11], s68 offen lds
    buffer_load_dwordx4 v4, s[8:11], s68 offen offset:1024 lds
    s_add_u32 m0, s86, 16384
    s_nop 0
    buffer_load_dwordx4 v5, s[12:15], s75 offen lds
    buffer_load_dwordx4 v42, s[12:15], s75 offen offset:1024 lds
    s_waitcnt vmcnt(8) lgkmcnt(0)
    s_barrier
    v_add_u32 v28, 0x1c000, v28
    v_add_u32 v29, 0x1c000, v29
    v_add_u32 v30, 0x1c000, v30
    v_add_u32 v31, 0x1c000, v31
    ds_read_b128 v[128:131], v28 offset:0
    ds_read_b128 v[132:135], v29 offset:0
    ds_read_b128 v[136:139], v30 offset:0
    s_add_u32 m0, s87, 81920
    ds_read_b128 v[140:143], v31 offset:0
    buffer_load_dwordx4 v3, s[8:11], s69 offen lds
    buffer_load_dwordx4 v4, s[8:11], s69 offen offset:1024 lds
    s_add_u32 m0, s86, 24576
    s_nop 0
    buffer_load_dwordx4 v5, s[12:15], s76 offen lds
    buffer_load_dwordx4 v42, s[12:15], s76 offen offset:1024 lds
    s_waitcnt lgkmcnt(3)
    v_dot2c_f32_bf16 v38, s84, v128
    v_dot2c_f32_bf16 v40, v128, v128
    v_dot2c_f32_bf16 v39, s84, v129
    v_dot2c_f32_bf16 v41, v129, v129
    v_dot2c_f32_bf16 v38, s84, v130
    v_dot2c_f32_bf16 v40, v130, v130
    v_dot2c_f32_bf16 v39, s84, v131
    v_dot2c_f32_bf16 v41, v131, v131
    s_waitcnt lgkmcnt(2)
    v_dot2c_f32_bf16 v38, s84, v132
    v_dot2c_f32_bf16 v40, v132, v132
    v_dot2c_f32_bf16 v39, s84, v133
    v_dot2c_f32_bf16 v41, v133, v133
    v_dot2c_f32_bf16 v38, s84, v134
    v_dot2c_f32_bf16 v40, v134, v134
    v_dot2c_f32_bf16 v39, s84, v135
    v_dot2c_f32_bf16 v41, v135, v135
    s_waitcnt lgkmcnt(1)
    v_dot2c_f32_bf16 v38, s84, v136
    v_dot2c_f32_bf16 v40, v136, v136
    v_dot2c_f32_bf16 v39, s84, v137
    v_dot2c_f32_bf16 v41, v137, v137
    v_dot2c_f32_bf16 v38, s84, v138
    v_dot2c_f32_bf16 v40, v138, v138
    v_dot2c_f32_bf16 v39, s84, v139
    v_dot2c_f32_bf16 v41, v139, v139
    s_waitcnt lgkmcnt(0)
    v_dot2c_f32_bf16 v38, s84, v140
    v_dot2c_f32_bf16 v40, v140, v140
    v_dot2c_f32_bf16 v39, s84, v141
    v_dot2c_f32_bf16 v41, v141, v141
    v_dot2c_f32_bf16 v38, s84, v142
    v_dot2c_f32_bf16 v40, v142, v142
    v_dot2c_f32_bf16 v39, s84, v143
    v_dot2c_f32_bf16 v41, v143, v143
    s_waitcnt vmcnt(8) lgkmcnt(0)
    s_barrier
    ds_read_b128 v[144:147], v28 offset:16384
    ds_read_b128 v[148:151], v29 offset:16384
    ds_read_b128 v[152:155], v30 offset:16384
    s_add_u32 m0, s87, 98304
    ds_read_b128 v[156:159], v31 offset:16384
    buffer_load_dwordx4 v3, s[8:11], s70 offen lds
    buffer_load_dwordx4 v4, s[8:11], s70 offen offset:1024 lds
    s_add_u32 m0, s86, 32768
    s_nop 0
    buffer_load_dwordx4 v5, s[12:15], s77 offen lds
    buffer_load_dwordx4 v42, s[12:15], s77 offen offset:1024 lds
    s_waitcnt lgkmcnt(3)
    v_dot2c_f32_bf16 v38, s84, v144
    v_dot2c_f32_bf16 v40, v144, v144
    v_dot2c_f32_bf16 v39, s84, v145
    v_dot2c_f32_bf16 v41, v145, v145
    v_dot2c_f32_bf16 v38, s84, v146
    v_dot2c_f32_bf16 v40, v146, v146
    v_dot2c_f32_bf16 v39, s84, v147
    v_dot2c_f32_bf16 v41, v147, v147
    s_waitcnt lgkmcnt(2)
    v_dot2c_f32_bf16 v38, s84, v148
    v_dot2c_f32_bf16 v40, v148, v148
    v_dot2c_f32_bf16 v39, s84, v149
    v_dot2c_f32_bf16 v41, v149, v149
    v_dot2c_f32_bf16 v38, s84, v150
    v_dot2c_f32_bf16 v40, v150, v150
    v_dot2c_f32_bf16 v39, s84, v151
    v_dot2c_f32_bf16 v41, v151, v151
    s_waitcnt lgkmcnt(1)
    v_dot2c_f32_bf16 v38, s84, v152
    v_dot2c_f32_bf16 v40, v152, v152
    v_dot2c_f32_bf16 v39, s84, v153
    v_dot2c_f32_bf16 v41, v153, v153
    v_dot2c_f32_bf16 v38, s84, v154
    v_dot2c_f32_bf16 v40, v154, v154
    v_dot2c_f32_bf16 v39, s84, v155
    v_dot2c_f32_bf16 v41, v155, v155
    s_waitcnt lgkmcnt(0)
    v_dot2c_f32_bf16 v38, s84, v156
    v_dot2c_f32_bf16 v40, v156, v156
    v_dot2c_f32_bf16 v39, s84, v157
    v_dot2c_f32_bf16 v41, v157, v157
    v_dot2c_f32_bf16 v38, s84, v158
    v_dot2c_f32_bf16 v40, v158, v158
    v_dot2c_f32_bf16 v39, s84, v159
    v_dot2c_f32_bf16 v41, v159, v159
    s_waitcnt vmcnt(8) lgkmcnt(0)
    s_barrier
    v_add_u32 v28, 0xffff4000, v28
    v_add_u32 v29, 0xffff4000, v29
    v_add_u32 v30, 0xffff4000, v30
    v_add_u32 v31, 0xffff4000, v31
    ds_read_b128 v[160:163], v28 offset:0
    ds_read_b128 v[164:167], v29 offset:0
    ds_read_b128 v[168:171], v30 offset:0
    s_add_u32 m0, s87, 114688
    ds_read_b128 v[172:175], v31 offset:0
    buffer_load_dwordx4 v3, s[8:11], s71 offen lds
    buffer_load_dwordx4 v4, s[8:11], s71 offen offset:1024 lds
    s_add_u32 m0, s86, 40960
    s_nop 0
    buffer_load_dwordx4 v5, s[12:15], s78 offen lds
    buffer_load_dwordx4 v42, s[12:15], s78 offen offset:1024 lds
    s_waitcnt lgkmcnt(3)
    v_dot2c_f32_bf16 v38, s84, v160
    v_dot2c_f32_bf16 v40, v160, v160
    v_dot2c_f32_bf16 v39, s84, v161
    v_dot2c_f32_bf16 v41, v161, v161
    v_dot2c_f32_bf16 v38, s84, v162
    v_dot2c_f32_bf16 v40, v162, v162
    v_dot2c_f32_bf16 v39, s84, v163
    v_dot2c_f32_bf16 v41, v163, v163
    s_waitcnt lgkmcnt(2)
    v_dot2c_f32_bf16 v38, s84, v164
    v_dot2c_f32_bf16 v40, v164, v164
    v_dot2c_f32_bf16 v39, s84, v165
    v_dot2c_f32_bf16 v41, v165, v165
    v_dot2c_f32_bf16 v38, s84, v166
    v_dot2c_f32_bf16 v40, v166, v166
    v_dot2c_f32_bf16 v39, s84, v167
    v_dot2c_f32_bf16 v41, v167, v167
    s_waitcnt lgkmcnt(1)
    v_dot2c_f32_bf16 v38, s84, v168
    v_dot2c_f32_bf16 v40, v168, v168
    v_dot2c_f32_bf16 v39, s84, v169
    v_dot2c_f32_bf16 v41, v169, v169
    v_dot2c_f32_bf16 v38, s84, v170
    v_dot2c_f32_bf16 v40, v170, v170
    v_dot2c_f32_bf16 v39, s84, v171
    v_dot2c_f32_bf16 v41, v171, v171
    s_waitcnt lgkmcnt(0)
    v_dot2c_f32_bf16 v38, s84, v172
    v_dot2c_f32_bf16 v40, v172, v172
    v_dot2c_f32_bf16 v39, s84, v173
    v_dot2c_f32_bf16 v41, v173, v173
    v_dot2c_f32_bf16 v38, s84, v174
    v_dot2c_f32_bf16 v40, v174, v174
    v_dot2c_f32_bf16 v39, s84, v175
    v_dot2c_f32_bf16 v41, v175, v175
    s_waitcnt vmcnt(8) lgkmcnt(0)
    s_barrier
    ds_read_b128 v[176:179], v28 offset:16384
    ds_read_b128 v[180:183], v29 offset:16384
    ds_read_b128 v[184:187], v30 offset:16384
    s_add_u32 m0, s87, 131072
    ds_read_b128 v[188:191], v31 offset:16384
    buffer_load_dwordx4 v3, s[8:11], s72 offen lds
    buffer_load_dwordx4 v4, s[8:11], s72 offen offset:1024 lds
    s_add_u32 m0, s86, 49152
    s_nop 0
    buffer_load_dwordx4 v5, s[12:15], s79 offen lds
    buffer_load_dwordx4 v42, s[12:15], s79 offen offset:1024 lds
    s_waitcnt lgkmcnt(3)
    v_dot2c_f32_bf16 v38, s84, v176
    v_dot2c_f32_bf16 v40, v176, v176
    v_dot2c_f32_bf16 v39, s84, v177
    v_dot2c_f32_bf16 v41, v177, v177
    v_dot2c_f32_bf16 v38, s84, v178
    v_dot2c_f32_bf16 v40, v178, v178
    v_dot2c_f32_bf16 v39, s84, v179
    v_dot2c_f32_bf16 v41, v179, v179
    s_waitcnt lgkmcnt(2)
    v_dot2c_f32_bf16 v38, s84, v180
    v_dot2c_f32_bf16 v40, v180, v180
    v_dot2c_f32_bf16 v39, s84, v181
    v_dot2c_f32_bf16 v41, v181, v181
    v_dot2c_f32_bf16 v38, s84, v182
    v_dot2c_f32_bf16 v40, v182, v182
    v_dot2c_f32_bf16 v39, s84, v183
    v_dot2c_f32_bf16 v41, v183, v183
    s_waitcnt lgkmcnt(1)
    v_dot2c_f32_bf16 v38, s84, v184
    v_dot2c_f32_bf16 v40, v184, v184
    v_dot2c_f32_bf16 v39, s84, v185
    v_dot2c_f32_bf16 v41, v185, v185
    v_dot2c_f32_bf16 v38, s84, v186
    v_dot2c_f32_bf16 v40, v186, v186
    v_dot2c_f32_bf16 v39, s84, v187
    v_dot2c_f32_bf16 v41, v187, v187
    s_waitcnt lgkmcnt(0)
    v_dot2c_f32_bf16 v38, s84, v188
    v_dot2c_f32_bf16 v40, v188, v188
    v_dot2c_f32_bf16 v39, s84, v189
    v_dot2c_f32_bf16 v41, v189, v189
    v_dot2c_f32_bf16 v38, s84, v190
    v_dot2c_f32_bf16 v40, v190, v190
    v_dot2c_f32_bf16 v39, s84, v191
    v_dot2c_f32_bf16 v41, v191, v191
    s_waitcnt vmcnt(8) lgkmcnt(0)
    s_barrier
    ds_read_b128 v[192:195], v28 offset:32768
    ds_read_b128 v[196:199], v29 offset:32768
    ds_read_b128 v[200:203], v30 offset:32768
    ds_read_b128 v[204:207], v31 offset:32768
    v_add_u32 v5, 112, v5
    s_add_u32 m0, s86, 57344
    v_add_u32 v42, 112, v42
    buffer_load_dwordx4 v5, s[12:15], s73 offen lds
    buffer_load_dwordx4 v42, s[12:15], s73 offen offset:1024 lds
    s_lshl3_add_u32 s95, s6, s3
    s_mul_i32 s95, s95, 10752
    s_mul_i32 s88, s81, 384
    s_add_u32 s95, s95, s88
    v_min_u32 v50, 31, v48
    v_lshrrev_b32 v63, 3, v50
    v_mad_u32_u24 v63, v63, 13, v50
    v_bfe_u32 v50, v50, 2, 1
    v_mad_u32_u24 v50, v50, 10, v63
    v_lshlrev_b32 v50, 7, v50
    buffer_load_dword v127, v50, s[12:15], s95 offen
    ds_read_b64_tr_b16 v[240:241], v20 offset:0
    ds_read_b64_tr_b16 v[242:243], v20 offset:512
    ds_read_b64_tr_b16 v[244:245], v21 offset:0
    ds_read_b64_tr_b16 v[246:247], v21 offset:512
    ds_read_b64_tr_b16 v[248:249], v22 offset:0
    ds_read_b64_tr_b16 v[250:251], v22 offset:512
    ds_read_b64_tr_b16 v[252:253], v23 offset:0
    ds_read_b64_tr_b16 v[254:255], v23 offset:512
    s_waitcnt lgkmcnt(11)
    v_dot2c_f32_bf16 v38, s84, v192
    v_dot2c_f32_bf16 v40, v192, v192
    v_dot2c_f32_bf16 v39, s84, v193
    v_dot2c_f32_bf16 v41, v193, v193
    v_dot2c_f32_bf16 v38, s84, v194
    v_dot2c_f32_bf16 v40, v194, v194
    v_dot2c_f32_bf16 v39, s84, v195
    v_dot2c_f32_bf16 v41, v195, v195
    s_waitcnt lgkmcnt(10)
    v_dot2c_f32_bf16 v38, s84, v196
    v_dot2c_f32_bf16 v40, v196, v196
    v_dot2c_f32_bf16 v39, s84, v197
    v_dot2c_f32_bf16 v41, v197, v197
    v_dot2c_f32_bf16 v38, s84, v198
    v_dot2c_f32_bf16 v40, v198, v198
    v_dot2c_f32_bf16 v39, s84, v199
    v_dot2c_f32_bf16 v41, v199, v199
    s_waitcnt lgkmcnt(9)
    v_dot2c_f32_bf16 v38, s84, v200
    v_dot2c_f32_bf16 v40, v200, v200
    v_dot2c_f32_bf16 v39, s84, v201
    v_dot2c_f32_bf16 v41, v201, v201
    v_dot2c_f32_bf16 v38, s84, v202
    v_dot2c_f32_bf16 v40, v202, v202
    v_dot2c_f32_bf16 v39, s84, v203
    v_dot2c_f32_bf16 v41, v203, v203
    s_waitcnt lgkmcnt(8)
    v_dot2c_f32_bf16 v38, s84, v204
    v_dot2c_f32_bf16 v40, v204, v204
    v_dot2c_f32_bf16 v39, s84, v205
    v_dot2c_f32_bf16 v41, v205, v205
    v_dot2c_f32_bf16 v38, s84, v206
    v_dot2c_f32_bf16 v40, v206, v206
    v_dot2c_f32_bf16 v39, s84, v207
    v_dot2c_f32_bf16 v41, v207, v207
    s_waitcnt vmcnt(7) lgkmcnt(0)
    s_barrier
    ds_read_b128 v[208:211], v28 offset:49152
    ds_read_b128 v[212:215], v29 offset:49152
    ds_read_b128 v[216:219], v30 offset:49152
    s_add_u32 m0, s86, 65536
    ds_read_b128 v[220:223], v31 offset:49152
    buffer_load_dwordx4 v5, s[12:15], s74 offen lds
    buffer_load_dwordx4 v42, s[12:15], s74 offen offset:1024 lds
    s_waitcnt lgkmcnt(3)
    v_dot2c_f32_bf16 v38, s84, v208
    v_dot2c_f32_bf16 v40, v208, v208
    v_dot2c_f32_bf16 v39, s84, v209
    v_dot2c_f32_bf16 v41, v209, v209
    v_dot2c_f32_bf16 v38, s84, v210
    v_dot2c_f32_bf16 v40, v210, v210
    v_dot2c_f32_bf16 v39, s84, v211
    v_dot2c_f32_bf16 v41, v211, v211
    s_waitcnt lgkmcnt(2)
    v_dot2c_f32_bf16 v38, s84, v212
    v_dot2c_f32_bf16 v40, v212, v212
    v_dot2c_f32_bf16 v39, s84, v213
    v_dot2c_f32_bf16 v41, v213, v213
    v_dot2c_f32_bf16 v38, s84, v214
    v_dot2c_f32_bf16 v40, v214, v214
    v_dot2c_f32_bf16 v39, s84, v215
    v_dot2c_f32_bf16 v41, v215, v215
    s_waitcnt lgkmcnt(1)
    v_dot2c_f32_bf16 v38, s84, v216
    v_dot2c_f32_bf16 v40, v216, v216
    v_dot2c_f32_bf16 v39, s84, v217
    v_dot2c_f32_bf16 v41, v217, v217
    v_dot2c_f32_bf16 v38, s84, v218
    v_dot2c_f32_bf16 v40, v218, v218
    v_dot2c_f32_bf16 v39, s84, v219
    v_dot2c_f32_bf16 v41, v219, v219
    s_waitcnt lgkmcnt(0)
    v_dot2c_f32_bf16 v38, s84, v220
    v_dot2c_f32_bf16 v40, v220, v220
    v_dot2c_f32_bf16 v39, s84, v221
    v_dot2c_f32_bf16 v41, v221, v221
    v_dot2c_f32_bf16 v38, s84, v222
    v_dot2c_f32_bf16 v40, v222, v222
    v_dot2c_f32_bf16 v39, s84, v223
    v_dot2c_f32_bf16 v41, v223, v223
    s_waitcnt vmcnt(5) lgkmcnt(0)
    s_barrier
    v_add_u32 v28, 0x10000, v28
    v_add_u32 v29, 0x10000, v29
    v_add_u32 v30, 0x10000, v30
    v_add_u32 v31, 0x10000, v31
    ds_read_b128 v[224:227], v28 offset:0
    ds_read_b128 v[228:231], v29 offset:0
    ds_read_b128 v[232:235], v30 offset:0
    ds_read_b128 v[236:239], v31 offset:0
    s_waitcnt lgkmcnt(3)
    v_dot2c_f32_bf16 v38, s84, v224
    v_dot2c_f32_bf16 v40, v224, v224
    v_dot2c_f32_bf16 v39, s84, v225
    v_dot2c_f32_bf16 v41, v225, v225
    v_dot2c_f32_bf16 v38, s84, v226
    v_dot2c_f32_bf16 v40, v226, v226
    v_dot2c_f32_bf16 v39, s84, v227
    v_dot2c_f32_bf16 v41, v227, v227
    s_waitcnt lgkmcnt(2)
    v_dot2c_f32_bf16 v38, s84, v228
    v_dot2c_f32_bf16 v40, v228, v228
    v_dot2c_f32_bf16 v39, s84, v229
    v_dot2c_f32_bf16 v41, v229, v229
    v_dot2c_f32_bf16 v38, s84, v230
    v_dot2c_f32_bf16 v40, v230, v230
    v_dot2c_f32_bf16 v39, s84, v231
    v_dot2c_f32_bf16 v41, v231, v231
    s_waitcnt lgkmcnt(1)
    v_dot2c_f32_bf16 v38, s84, v232
    v_dot2c_f32_bf16 v40, v232, v232
    v_dot2c_f32_bf16 v39, s84, v233
    v_dot2c_f32_bf16 v41, v233, v233
    v_dot2c_f32_bf16 v38, s84, v234
    v_dot2c_f32_bf16 v40, v234, v234
    v_dot2c_f32_bf16 v39, s84, v235
    v_dot2c_f32_bf16 v41, v235, v235
    s_waitcnt lgkmcnt(0)
    v_dot2c_f32_bf16 v38, s84, v236
    v_dot2c_f32_bf16 v40, v236, v236
    v_dot2c_f32_bf16 v39, s84, v237
    v_dot2c_f32_bf16 v41, v237, v237
    v_dot2c_f32_bf16 v38, s84, v238
    v_dot2c_f32_bf16 v40, v238, v238
    v_dot2c_f32_bf16 v39, s84, v239
    v_dot2c_f32_bf16 v41, v239, v239
    s_barrier
    s_nop 0
    v_add_f32 v48, v38, v39
    v_add_f32 v50, v38, v39
    v_add_f32 v49, v40, v41
    v_add_f32 v51, v40, v41
    v_permlane32_swap_b32 v48, v50
    s_nop 0
    v_permlane32_swap_b32 v49, v51
    v_add_f32 v48, v48, v50
    v_add_f32 v49, v49, v51
    v_mul_f32 v48, 0x3b124925, v48
    v_mul_f32 v49, 0x3b124925, v49
    v_fma_f32 v49, -v48, v48, v49
    v_max_f32 v49, 0, v49
    v_cvt_pk_bf16_f32 v49, v49, v49
    v_lshlrev_b32 v49, 16, v49
    v_add_f32 v49, 0x3727c5ac, v49
    v_cvt_pk_bf16_f32 v49, v49, v49
    v_lshlrev_b32 v49, 16, v49
    v_sqrt_f32 v49, v49
    s_nop 0
    v_cvt_pk_bf16_f32 v48, -v48, v49
    ds_write_b32 v36, v48
    buffer_store_dword v48, v37, s[16:19], s97 offen sc1
    s_add_u32 m0, s86, 73728
    s_nop 0
    buffer_load_dwordx4 v5, s[12:15], s75 offen lds
    buffer_load_dwordx4 v42, s[12:15], s75 offen offset:1024 lds
    v_and_b32 v40, 0xffff0000, v48
    v_rcp_f32 v41, v40
    v_cndmask_b32 v48, v48, 0, s[92:93]
    v_and_b32 v49, 0xffff, v48
    v_lshl_or_b32 v36, v48, 16, v49
    v_lshrrev_b32 v37, 16, v48
    v_mul_f32 v38, s99, v41
    s_waitcnt vmcnt(6) lgkmcnt(0)
    s_barrier
    s_setprio 1
    v_mfma_f32_32x32x16_bf16 v[64:79], v[240:243], v[128:131], 0
    v_mfma_f32_16x16x32_bf16 v[12:15], v[8:11], v[240:243], 0
    ds_read_b64_tr_b16 v[240:241], v20 offset:8192
    ds_read_b64_tr_b16 v[242:243], v20 offset:8704
    v_mfma_f32_32x32x16_bf16 v[64:79], v[244:247], v[132:135], v[64:79]
    ds_read_b64_tr_b16 v[244:245], v21 offset:8192
    s_add_u32 m0, s86, 90112
    ds_read_b64_tr_b16 v[246:247], v21 offset:8704
    buffer_load_dwordx4 v5, s[12:15], s77 offen lds
    v_mfma_f32_32x32x16_bf16 v[64:79], v[248:251], v[136:139], v[64:79]
    ds_read_b64_tr_b16 v[248:249], v22 offset:8192
    ds_read_b64_tr_b16 v[250:251], v22 offset:8704
    v_mfma_f32_32x32x16_bf16 v[64:79], v[252:255], v[140:143], v[64:79]
    ds_read_b64_tr_b16 v[252:253], v23 offset:8192
    ds_read_b64_tr_b16 v[254:255], v23 offset:8704
    s_waitcnt lgkmcnt(4)
    v_mfma_f32_32x32x16_bf16 v[64:79], v[240:243], v[144:147], v[64:79]
    v_mfma_f32_16x16x32_bf16 v[12:15], v[8:11], v[240:243], v[12:15]
    ds_read_b64_tr_b16 v[240:241], v20 offset:16384
    ds_read_b64_tr_b16 v[242:243], v20 offset:16896
    buffer_load_dwordx4 v42, s[12:15], s77 offen offset:1024 lds
    v_mfma_f32_32x32x16_bf16 v[64:79], v[244:247], v[148:151], v[64:79]
    ds_read_b64_tr_b16 v[244:245], v21 offset:16384
    ds_read_b64_tr_b16 v[246:247], v21 offset:16896
    s_waitcnt lgkmcnt(4)
    v_mfma_f32_32x32x16_bf16 v[64:79], v[248:251], v[152:155], v[64:79]
    ds_read_b64_tr_b16 v[248:249], v22 offset:16384
    ds_read_b64_tr_b16 v[250:251], v22 offset:16896
    v_mfma_f32_32x32x16_bf16 v[64:79], v[252:255], v[156:159], v[64:79]
    ds_read_b64_tr_b16 v[252:253], v23 offset:16384
    s_add_u32 m0, s86, 98304
    ds_read_b64_tr_b16 v[254:255], v23 offset:16896
    buffer_load_dwordx4 v5, s[12:15], s78 offen lds
    s_waitcnt lgkmcnt(4)
    v_mfma_f32_32x32x16_bf16 v[64:79], v[240:243], v[160:163], v[64:79]
    v_mfma_f32_16x16x32_bf16 v[12:15], v[8:11], v[240:243], v[12:15]
    ds_read_b64_tr_b16 v[240:241], v20 offset:24576
    ds_read_b64_tr_b16 v[242:243], v20 offset:25088
    v_mfma_f32_32x32x16_bf16 v[64:79], v[244:247], v[164:167], v[64:79]
    ds_read_b64_tr_b16 v[244:245], v21 offset:24576
    ds_read_b64_tr_b16 v[246:247], v21 offset:25088
    s_waitcnt lgkmcnt(4)
    v_mfma_f32_32x32x16_bf16 v[64:79], v[248:251], v[168:171], v[64:79]
    ds_read_b64_tr_b16 v[248:249], v22 offset:24576
    ds_read_b64_tr_b16 v[250:251], v22 offset:25088
    buffer_load_dwordx4 v42, s[12:15], s78 offen offset:1024 lds
    v_mfma_f32_32x32x16_bf16 v[64:79], v[252:255], v[172:175], v[64:79]
    ds_read_b64_tr_b16 v[252:253], v23 offset:24576
    ds_read_b64_tr_b16 v[254:255], v23 offset:25088
    s_waitcnt lgkmcnt(4)
    v_mfma_f32_32x32x16_bf16 v[64:79], v[240:243], v[176:179], v[64:79]
    v_mfma_f32_16x16x32_bf16 v[12:15], v[8:11], v[240:243], v[12:15]
    ds_read_b64_tr_b16 v[240:241], v20 offset:32768
    ds_read_b64_tr_b16 v[242:243], v20 offset:33280
    v_mfma_f32_32x32x16_bf16 v[64:79], v[244:247], v[180:183], v[64:79]
    ds_read_b64_tr_b16 v[244:245], v21 offset:32768
    s_add_u32 m0, s86, 106496
    ds_read_b64_tr_b16 v[246:247], v21 offset:33280
    buffer_load_dwordx4 v5, s[12:15], s79 offen lds
    s_waitcnt lgkmcnt(4)
    v_mfma_f32_32x32x16_bf16 v[64:79], v[248:251], v[184:187], v[64:79]
    ds_read_b64_tr_b16 v[248:249], v22 offset:32768
    ds_read_b64_tr_b16 v[250:251], v22 offset:33280
    v_mfma_f32_32x32x16_bf16 v[64:79], v[252:255], v[188:191], v[64:79]
    ds_read_b64_tr_b16 v[252:253], v23 offset:32768
    ds_read_b64_tr_b16 v[254:255], v23 offset:33280
    s_waitcnt lgkmcnt(4)
    v_mfma_f32_32x32x16_bf16 v[64:79], v[240:243], v[192:195], v[64:79]
    v_mfma_f32_16x16x32_bf16 v[12:15], v[8:11], v[240:243], v[12:15]
    ds_read_b64_tr_b16 v[240:241], v20 offset:40960
    ds_read_b64_tr_b16 v[242:243], v20 offset:41472
    buffer_load_dwordx4 v42, s[12:15], s79 offen offset:1024 lds
    v_mfma_f32_32x32x16_bf16 v[64:79], v[244:247], v[196:199], v[64:79]
    ds_read_b64_tr_b16 v[244:245], v21 offset:40960
    ds_read_b64_tr_b16 v[246:247], v21 offset:41472
    s_waitcnt lgkmcnt(4)
    v_mfma_f32_32x32x16_bf16 v[64:79], v[248:251], v[200:203], v[64:79]
    ds_read_b64_tr_b16 v[248:249], v22 offset:40960
    ds_read_b64_tr_b16 v[250:251], v22 offset:41472
    v_mfma_f32_32x32x16_bf16 v[64:79], v[252:255], v[204:207], v[64:79]
    ds_read_b64_tr_b16 v[252:253], v23 offset:40960
    ds_read_b64_tr_b16 v[254:255], v23 offset:41472
    s_waitcnt lgkmcnt(4)
    v_mfma_f32_32x32x16_bf16 v[64:79], v[240:243], v[208:211], v[64:79]
    v_mfma_f32_16x16x32_bf16 v[12:15], v[8:11], v[240:243], v[12:15]
    ds_read_b64_tr_b16 v[240:241], v20 offset:49152
    ds_read_b64_tr_b16 v[242:243], v20 offset:49664
    v_mfma_f32_32x32x16_bf16 v[64:79], v[244:247], v[212:215], v[64:79]
    ds_read_b64_tr_b16 v[244:245], v21 offset:49152
    ds_read_b64_tr_b16 v[246:247], v21 offset:49664
    s_waitcnt lgkmcnt(4)
    v_mfma_f32_32x32x16_bf16 v[64:79], v[248:251], v[216:219], v[64:79]
    ds_read_b64_tr_b16 v[248:249], v22 offset:49152
    ds_read_b64_tr_b16 v[250:251], v22 offset:49664
    v_mfma_f32_32x32x16_bf16 v[64:79], v[252:255], v[220:223], v[64:79]
    ds_read_b64_tr_b16 v[252:253], v23 offset:49152
    ds_read_b64_tr_b16 v[254:255], v23 offset:49664
    s_waitcnt lgkmcnt(4)
    v_mfma_f32_32x32x16_bf16 v[64:79], v[240:243], v[224:227], v[64:79]
    v_mfma_f32_16x16x32_bf16 v[12:15], v[8:11], v[240:243], v[12:15]
    v_mfma_f32_32x32x16_bf16 v[64:79], v[244:247], v[228:231], v[64:79]
    s_nop 6
    ds_write_b32 v6, v12
    s_waitcnt vmcnt(0) lgkmcnt(0)
    s_barrier
    s_setprio 2
    ds_read_b128 v[56:59], v7 offset:0
    v_mfma_f32_32x32x16_bf16 v[64:79], v[248:251], v[232:235], v[64:79]
    v_mfma_f32_32x32x16_bf16 v[64:79], v[252:255], v[236:239], v[64:79]
    s_waitcnt lgkmcnt(0)
    v_add_f32 v56, v56, v57
    v_add_f32 v58, v58, v59
    v_add_f32 v56, v56, v58
    v_cvt_pk_bf16_f32 v57, v56, v56
    v_lshlrev_b32 v57, 16, v57
    v_sub_f32 v57, v56, v57
    v_cvt_pk_bf16_f32 v32, v56, v57
    s_nop 1
    v_mfma_f32_32x32x8_bf16 v[64:79], v[32:33], v[36:37], v[64:79]
    s_setprio 0
    v_add_u32 v5, 112, v5
    s_add_u32 m0, s86, 0
    v_add_u32 v42, 112, v42
    buffer_load_dwordx4 v5, s[12:15], s73 offen lds
    buffer_load_dwordx4 v42, s[12:15], s73 offen offset:1024 lds
    s_nop 5
    v_mul_f32 v48, v64, v38
    v_mul_f32 v49, v65, v38
    v_mul_f32 v50, v66, v38
    v_mul_f32 v51, v67, v38
    v_exp_f32_e64 v48, v48 clamp
    v_exp_f32_e64 v49, v49 clamp
    v_exp_f32_e64 v50, v50 clamp
    v_exp_f32_e64 v51, v51 clamp
    v_fma_f32 v64, v64, v41, s85
    v_fma_f32 v65, v65, v41, s85
    v_fma_f32 v66, v66, v41, s85
    v_fma_f32 v67, v67, v41, s85
    v_max_f32 v64, s85, v64
    v_max_f32 v65, s85, v65
    v_max_f32 v66, s85, v66
    v_max_f32 v67, s85, v67
    v_add_f32 v64, v64, v48
    v_add_f32 v65, v65, v49
    v_add_f32 v66, v66, v50
    v_add_f32 v67, v67, v51
    v_cvt_pk_bf16_f32 v80, v64, v65
    v_cvt_pk_bf16_f32 v81, v66, v67
    v_mul_f32 v48, v68, v38
    v_mul_f32 v49, v69, v38
    v_mul_f32 v50, v70, v38
    v_mul_f32 v51, v71, v38
    v_exp_f32_e64 v48, v48 clamp
    v_exp_f32_e64 v49, v49 clamp
    v_exp_f32_e64 v50, v50 clamp
    v_exp_f32_e64 v51, v51 clamp
    v_fma_f32 v68, v68, v41, s85
    v_fma_f32 v69, v69, v41, s85
    v_fma_f32 v70, v70, v41, s85
    v_fma_f32 v71, v71, v41, s85
    v_max_f32 v68, s85, v68
    v_max_f32 v69, s85, v69
    v_max_f32 v70, s85, v70
    v_max_f32 v71, s85, v71
    v_add_f32 v68, v68, v48
    v_add_f32 v69, v69, v49
    v_add_f32 v70, v70, v50
    ds_read_b64_tr_b16 v[240:241], v20 offset:57344
    v_add_f32 v71, v71, v51
    v_cvt_pk_bf16_f32 v82, v68, v69
    v_cvt_pk_bf16_f32 v83, v70, v71
    v_mul_f32 v48, v72, v38
    ds_read_b64_tr_b16 v[242:243], v20 offset:57856
    v_mul_f32 v49, v73, v38
    v_mul_f32 v50, v74, v38
    v_mul_f32 v51, v75, v38
    v_exp_f32_e64 v48, v48 clamp
    ds_read_b64_tr_b16 v[244:245], v21 offset:57344
    v_exp_f32_e64 v49, v49 clamp
    v_exp_f32_e64 v50, v50 clamp
    v_exp_f32_e64 v51, v51 clamp
    v_fma_f32 v72, v72, v41, s85
    ds_read_b64_tr_b16 v[246:247], v21 offset:57856
    v_fma_f32 v73, v73, v41, s85
    v_fma_f32 v74, v74, v41, s85
    v_fma_f32 v75, v75, v41, s85
    v_max_f32 v72, s85, v72
    ds_read_b64_tr_b16 v[248:249], v22 offset:57344
    v_max_f32 v73, s85, v73
    v_max_f32 v74, s85, v74
    v_max_f32 v75, s85, v75
    v_add_f32 v72, v72, v48
    ds_read_b64_tr_b16 v[250:251], v22 offset:57856
    v_add_f32 v73, v73, v49
    v_add_f32 v74, v74, v50
    v_add_f32 v75, v75, v51
    v_cvt_pk_bf16_f32 v84, v72, v73
    ds_read_b64_tr_b16 v[252:253], v23 offset:57344
    v_cvt_pk_bf16_f32 v85, v74, v75
    v_mul_f32 v48, v76, v38
    v_mul_f32 v49, v77, v38
    v_mul_f32 v50, v78, v38
    ds_read_b64_tr_b16 v[254:255], v23 offset:57856
    v_mul_f32 v51, v79, v38
    v_exp_f32_e64 v48, v48 clamp
    v_exp_f32_e64 v49, v49 clamp
    v_exp_f32_e64 v50, v50 clamp
    v_exp_f32_e64 v51, v51 clamp
    v_fma_f32 v76, v76, v41, s85
    v_fma_f32 v77, v77, v41, s85
    v_fma_f32 v78, v78, v41, s85
    v_fma_f32 v79, v79, v41, s85
    v_max_f32 v76, s85, v76
    v_max_f32 v77, s85, v77
    v_max_f32 v78, s85, v78
    v_max_f32 v79, s85, v79
    v_add_f32 v76, v76, v48
    v_add_f32 v77, v77, v49
    v_add_f32 v78, v78, v50
    v_add_f32 v79, v79, v51
    v_cvt_pk_bf16_f32 v86, v76, v77
    v_cvt_pk_bf16_f32 v87, v78, v79
    v_cndmask_b32 v86, v86, 0, s[92:93]
    v_cndmask_b32 v87, v87, 0, s[92:93]
    s_waitcnt vmcnt(0) lgkmcnt(0)
    s_barrier
    s_setprio 1
    v_mfma_f32_32x32x16_bf16 v[64:79], v[240:243], v[128:131], 0
    v_mfma_f32_16x16x32_bf16 v[12:15], v[8:11], v[240:243], 0
    v_add_u32 v20, 0x10000, v20
    v_add_u32 v21, 0x10000, v21
    v_add_u32 v22, 0x10000, v22
    v_add_u32 v23, 0x10000, v23
    ds_read_b64_tr_b16 v[240:241], v20 offset:0
    ds_read_b64_tr_b16 v[242:243], v20 offset:512
    v_mfma_f32_32x32x16_bf16 v[64:79], v[244:247], v[132:135], v[64:79]
    ds_read_b64_tr_b16 v[244:245], v21 offset:0
    s_add_u32 m0, s86, 40960
    ds_read_b64_tr_b16 v[246:247], v21 offset:512
    buffer_load_dwordx4 v5, s[12:15], s78 offen lds
    v_mfma_f32_32x32x16_bf16 v[64:79], v[248:251], v[136:139], v[64:79]
    ds_read_b64_tr_b16 v[248:249], v22 offset:0
    ds_read_b64_tr_b16 v[250:251], v22 offset:512
    v_mfma_f32_32x32x16_bf16 v[64:79], v[252:255], v[140:143], v[64:79]
    ds_read_b64_tr_b16 v[252:253], v23 offset:0
    ds_read_b64_tr_b16 v[254:255], v23 offset:512
    s_waitcnt lgkmcnt(4)
    v_mfma_f32_32x32x16_bf16 v[64:79], v[240:243], v[144:147], v[64:79]
    v_mfma_f32_16x16x32_bf16 v[12:15], v[8:11], v[240:243], v[12:15]
    ds_read_b64_tr_b16 v[240:241], v20 offset:8192
    ds_read_b64_tr_b16 v[242:243], v20 offset:8704
    buffer_load_dwordx4 v42, s[12:15], s78 offen offset:1024 lds
    v_mfma_f32_32x32x16_bf16 v[64:79], v[244:247], v[148:151], v[64:79]
    ds_read_b64_tr_b16 v[244:245], v21 offset:8192
    ds_read_b64_tr_b16 v[246:247], v21 offset:8704
    s_waitcnt lgkmcnt(4)
    v_mfma_f32_32x32x16_bf16 v[64:79], v[248:251], v[152:155], v[64:79]
    ds_read_b64_tr_b16 v[248:249], v22 offset:8192
    ds_read_b64_tr_b16 v[250:251], v22 offset:8704
    v_mfma_f32_32x32x16_bf16 v[64:79], v[252:255], v[156:159], v[64:79]
    ds_read_b64_tr_b16 v[252:253], v23 offset:8192
    s_add_u32 m0, s86, 49152
    ds_read_b64_tr_b16 v[254:255], v23 offset:8704
    buffer_load_dwordx4 v5, s[12:15], s79 offen lds
    s_waitcnt lgkmcnt(4)
    v_mfma_f32_32x32x16_bf16 v[64:79], v[240:243], v[160:163], v[64:79]
    v_mfma_f32_16x16x32_bf16 v[12:15], v[8:11], v[240:243], v[12:15]
    ds_read_b64_tr_b16 v[240:241], v20 offset:16384
    ds_read_b64_tr_b16 v[242:243], v20 offset:16896
    v_mfma_f32_32x32x16_bf16 v[64:79], v[244:247], v[164:167], v[64:79]
    ds_read_b64_tr_b16 v[244:245], v21 offset:16384
    ds_read_b64_tr_b16 v[246:247], v21 offset:16896
    s_waitcnt lgkmcnt(4)
    v_mfma_f32_32x32x16_bf16 v[64:79], v[248:251], v[168:171], v[64:79]
    ds_read_b64_tr_b16 v[248:249], v22 offset:16384
    ds_read_b64_tr_b16 v[250:251], v22 offset:16896
    buffer_load_dwordx4 v42, s[12:15], s79 offen offset:1024 lds
    v_mfma_f32_32x32x16_bf16 v[64:79], v[252:255], v[172:175], v[64:79]
    ds_read_b64_tr_b16 v[252:253], v23 offset:16384
    ds_read_b64_tr_b16 v[254:255], v23 offset:16896
    s_waitcnt lgkmcnt(4)
    v_mfma_f32_32x32x16_bf16 v[64:79], v[240:243], v[176:179], v[64:79]
    v_mfma_f32_16x16x32_bf16 v[12:15], v[8:11], v[240:243], v[12:15]
    ds_read_b64_tr_b16 v[240:241], v20 offset:24576
    ds_read_b64_tr_b16 v[242:243], v20 offset:25088
    v_mfma_f32_32x32x16_bf16 v[64:79], v[244:247], v[180:183], v[64:79]
    ds_read_b64_tr_b16 v[244:245], v21 offset:24576
    ds_read_b64_tr_b16 v[246:247], v21 offset:25088
    s_waitcnt lgkmcnt(4)
    v_mfma_f32_32x32x16_bf16 v[64:79], v[248:251], v[184:187], v[64:79]
    ds_read_b64_tr_b16 v[248:249], v22 offset:24576
    ds_read_b64_tr_b16 v[250:251], v22 offset:25088
    v_mfma_f32_32x32x16_bf16 v[64:79], v[252:255], v[188:191], v[64:79]
    ds_read_b64_tr_b16 v[252:253], v23 offset:24576
    ds_read_b64_tr_b16 v[254:255], v23 offset:25088
    s_waitcnt lgkmcnt(4)
    v_mfma_f32_32x32x16_bf16 v[64:79], v[240:243], v[192:195], v[64:79]
    v_mfma_f32_16x16x32_bf16 v[12:15], v[8:11], v[240:243], v[12:15]
    ds_read_b64_tr_b16 v[240:241], v20 offset:32768
    ds_read_b64_tr_b16 v[242:243], v20 offset:33280
    v_mfma_f32_32x32x16_bf16 v[64:79], v[244:247], v[196:199], v[64:79]
    ds_read_b64_tr_b16 v[244:245], v21 offset:32768
    ds_read_b64_tr_b16 v[246:247], v21 offset:33280
    s_waitcnt lgkmcnt(4)
    v_mfma_f32_32x32x16_bf16 v[64:79], v[248:251], v[200:203], v[64:79]
    ds_read_b64_tr_b16 v[248:249], v22 offset:32768
    ds_read_b64_tr_b16 v[250:251], v22 offset:33280
    v_mfma_f32_32x32x16_bf16 v[64:79], v[252:255], v[204:207], v[64:79]
    ds_read_b64_tr_b16 v[252:253], v23 offset:32768
    ds_read_b64_tr_b16 v[254:255], v23 offset:33280
    s_waitcnt lgkmcnt(4)
    v_mfma_f32_32x32x16_bf16 v[64:79], v[240:243], v[208:211], v[64:79]
    v_mfma_f32_16x16x32_bf16 v[12:15], v[8:11], v[240:243], v[12:15]
    ds_read_b64_tr_b16 v[240:241], v20 offset:40960
    ds_read_b64_tr_b16 v[242:243], v20 offset:41472
    v_mfma_f32_32x32x16_bf16 v[64:79], v[244:247], v[212:215], v[64:79]
    ds_read_b64_tr_b16 v[244:245], v21 offset:40960
    ds_read_b64_tr_b16 v[246:247], v21 offset:41472
    s_waitcnt lgkmcnt(4)
    v_mfma_f32_32x32x16_bf16 v[64:79], v[248:251], v[216:219], v[64:79]
    ds_read_b64_tr_b16 v[248:249], v22 offset:40960
    ds_read_b64_tr_b16 v[250:251], v22 offset:41472
    v_mfma_f32_32x32x16_bf16 v[64:79], v[252:255], v[220:223], v[64:79]
    ds_read_b64_tr_b16 v[252:253], v23 offset:40960
    ds_read_b64_tr_b16 v[254:255], v23 offset:41472
    s_waitcnt lgkmcnt(4)
    v_mfma_f32_32x32x16_bf16 v[64:79], v[240:243], v[224:227], v[64:79]
    v_mfma_f32_16x16x32_bf16 v[12:15], v[8:11], v[240:243], v[12:15]
    v_mfma_f32_32x32x16_bf16 v[64:79], v[244:247], v[228:231], v[64:79]
    s_nop 6
    ds_write_b32 v6, v12
    s_waitcnt vmcnt(0) lgkmcnt(0)
    s_barrier
    s_setprio 2
    ds_read_b128 v[56:59], v7 offset:0
    v_mfma_f32_32x32x16_bf16 v[64:79], v[248:251], v[232:235], v[64:79]
    v_mfma_f32_32x32x16_bf16 v[64:79], v[252:255], v[236:239], v[64:79]
    s_waitcnt lgkmcnt(0)
    v_add_f32 v56, v56, v57
    v_add_f32 v58, v58, v59
    v_add_f32 v56, v56, v58
    v_cvt_pk_bf16_f32 v57, v56, v56
    v_lshlrev_b32 v57, 16, v57
    v_sub_f32 v57, v56, v57
    v_cvt_pk_bf16_f32 v32, v56, v57
    s_nop 1
    v_mfma_f32_32x32x8_bf16 v[64:79], v[32:33], v[36:37], v[64:79]
    s_setprio 0
    v_add_u32 v5, 112, v5
    s_add_u32 m0, s86, 57344
    v_add_u32 v42, 112, v42
    buffer_load_dwordx4 v5, s[12:15], s73 offen lds
    buffer_load_dwordx4 v42, s[12:15], s73 offen offset:1024 lds
    s_nop 5
    v_mul_f32 v48, v64, v38
    v_mul_f32 v49, v65, v38
    v_mul_f32 v50, v66, v38
    v_mul_f32 v51, v67, v38
    v_exp_f32_e64 v48, v48 clamp
    v_exp_f32_e64 v49, v49 clamp
    v_exp_f32_e64 v50, v50 clamp
    v_exp_f32_e64 v51, v51 clamp
    v_fma_f32 v64, v64, v41, s85
    v_fma_f32 v65, v65, v41, s85
    v_fma_f32 v66, v66, v41, s85
    v_fma_f32 v67, v67, v41, s85
    v_max_f32 v64, s85, v64
    v_max_f32 v65, s85, v65
    v_max_f32 v66, s85, v66
    v_max_f32 v67, s85, v67
    v_add_f32 v64, v64, v48
    v_add_f32 v65, v65, v49
    v_add_f32 v66, v66, v50
    v_add_f32 v67, v67, v51
    v_cvt_pk_bf16_f32 v88, v64, v65
    v_cvt_pk_bf16_f32 v89, v66, v67
    v_mul_f32 v48, v68, v38
    v_mul_f32 v49, v69, v38
    v_mul_f32 v50, v70, v38
    v_mul_f32 v51, v71, v38
    v_exp_f32_e64 v48, v48 clamp
    v_exp_f32_e64 v49, v49 clamp
    v_exp_f32_e64 v50, v50 clamp
    v_exp_f32_e64 v51, v51 clamp
    v_fma_f32 v68, v68, v41, s85
    v_fma_f32 v69, v69, v41, s85
    v_fma_f32 v70, v70, v41, s85
    v_fma_f32 v71, v71, v41, s85
    v_max_f32 v68, s85, v68
    v_max_f32 v69, s85, v69
    v_max_f32 v70, s85, v70
    v_max_f32 v71, s85, v71
    v_add_f32 v68, v68, v48
    v_add_f32 v69, v69, v49
    v_add_f32 v70, v70, v50
    v_add_u32 v20, 0xffff0000, v20
    v_add_f32 v71, v71, v51
    v_cvt_pk_bf16_f32 v90, v68, v69
    v_cvt_pk_bf16_f32 v91, v70, v71
    v_add_u32 v21, 0xffff0000, v21
    v_mul_f32 v48, v72, v38
    v_mul_f32 v49, v73, v38
    v_add_u32 v22, 0xffff0000, v22
    v_mul_f32 v50, v74, v38
    v_mul_f32 v51, v75, v38
    v_exp_f32_e64 v48, v48 clamp
    v_add_u32 v23, 0xffff0000, v23
    v_exp_f32_e64 v49, v49 clamp
    v_exp_f32_e64 v50, v50 clamp
    ds_read_b64_tr_b16 v[240:241], v20 offset:0
    v_exp_f32_e64 v51, v51 clamp
    v_fma_f32 v72, v72, v41, s85
    v_fma_f32 v73, v73, v41, s85
    ds_read_b64_tr_b16 v[242:243], v20 offset:512
    v_fma_f32 v74, v74, v41, s85
    v_fma_f32 v75, v75, v41, s85
    v_max_f32 v72, s85, v72
    ds_read_b64_tr_b16 v[244:245], v21 offset:0
    v_max_f32 v73, s85, v73
    v_max_f32 v74, s85, v74
    ds_read_b64_tr_b16 v[246:247], v21 offset:512
    v_max_f32 v75, s85, v75
    v_add_f32 v72, v72, v48
    v_add_f32 v73, v73, v49
    ds_read_b64_tr_b16 v[248:249], v22 offset:0
    v_add_f32 v74, v74, v50
    v_add_f32 v75, v75, v51
    v_cvt_pk_bf16_f32 v92, v72, v73
    ds_read_b64_tr_b16 v[250:251], v22 offset:512
    v_cvt_pk_bf16_f32 v93, v74, v75
    v_mul_f32 v48, v76, v38
    ds_read_b64_tr_b16 v[252:253], v23 offset:0
    v_mul_f32 v49, v77, v38
    v_mul_f32 v50, v78, v38
    v_mul_f32 v51, v79, v38
    ds_read_b64_tr_b16 v[254:255], v23 offset:512
    v_exp_f32_e64 v48, v48 clamp
    v_exp_f32_e64 v49, v49 clamp
    v_exp_f32_e64 v50, v50 clamp
    v_exp_f32_e64 v51, v51 clamp
    v_fma_f32 v76, v76, v41, s85
    v_fma_f32 v77, v77, v41, s85
    v_fma_f32 v78, v78, v41, s85
    v_fma_f32 v79, v79, v41, s85
    v_max_f32 v76, s85, v76
    v_max_f32 v77, s85, v77
    v_max_f32 v78, s85, v78
    v_max_f32 v79, s85, v79
    v_add_f32 v76, v76, v48
    v_add_f32 v77, v77, v49
    v_add_f32 v78, v78, v50
    v_add_f32 v79, v79, v51
    v_cvt_pk_bf16_f32 v94, v76, v77
    v_cvt_pk_bf16_f32 v95, v78, v79
    v_cndmask_b32 v94, v94, 0, s[92:93]
    v_cndmask_b32 v95, v95, 0, s[92:93]
    s_waitcnt vmcnt(0) lgkmcnt(0)
    s_barrier
    s_setprio 1
    v_mfma_f32_32x32x16_bf16 v[64:79], v[240:243], v[128:131], 0
    v_mfma_f32_16x16x32_bf16 v[12:15], v[8:11], v[240:243], 0
    ds_read_b64_tr_b16 v[240:241], v20 offset:8192
    ds_read_b64_tr_b16 v[242:243], v20 offset:8704
    v_mfma_f32_32x32x16_bf16 v[64:79], v[244:247], v[132:135], v[64:79]
    ds_read_b64_tr_b16 v[244:245], v21 offset:8192
    s_add_u32 m0, s86, 98304
    ds_read_b64_tr_b16 v[246:247], v21 offset:8704
    buffer_load_dwordx4 v5, s[12:15], s78 offen lds
    v_mfma_f32_32x32x16_bf16 v[64:79], v[248:251], v[136:139], v[64:79]
    ds_read_b64_tr_b16 v[248:249], v22 offset:8192
    ds_read_b64_tr_b16 v[250:251], v22 offset:8704
    v_mfma_f32_32x32x16_bf16 v[64:79], v[252:255], v[140:143], v[64:79]
    ds_read_b64_tr_b16 v[252:253], v23 offset:8192
    ds_read_b64_tr_b16 v[254:255], v23 offset:8704
    s_waitcnt lgkmcnt(4)
    v_mfma_f32_32x32x16_bf16 v[64:79], v[240:243], v[144:147], v[64:79]
    v_mfma_f32_16x16x32_bf16 v[12:15], v[8:11], v[240:243], v[12:15]
    ds_read_b64_tr_b16 v[240:241], v20 offset:16384
    ds_read_b64_tr_b16 v[242:243], v20 offset:16896
    buffer_load_dwordx4 v42, s[12:15], s78 offen offset:1024 lds
    v_mfma_f32_32x32x16_bf16 v[64:79], v[244:247], v[148:151], v[64:79]
    ds_read_b64_tr_b16 v[244:245], v21 offset:16384
    ds_read_b64_tr_b16 v[246:247], v21 offset:16896
    s_waitcnt lgkmcnt(4)
    v_mfma_f32_32x32x16_bf16 v[64:79], v[248:251], v[152:155], v[64:79]
    ds_read_b64_tr_b16 v[248:249], v22 offset:16384
    ds_read_b64_tr_b16 v[250:251], v22 offset:16896
    v_mfma_f32_32x32x16_bf16 v[64:79], v[252:255], v[156:159], v[64:79]
    ds_read_b64_tr_b16 v[252:253], v23 offset:16384
    s_add_u32 m0, s86, 106496
    ds_read_b64_tr_b16 v[254:255], v23 offset:16896
    buffer_load_dwordx4 v5, s[12:15], s79 offen lds
    s_waitcnt lgkmcnt(4)
    v_mfma_f32_32x32x16_bf16 v[64:79], v[240:243], v[160:163], v[64:79]
    v_mfma_f32_16x16x32_bf16 v[12:15], v[8:11], v[240:243], v[12:15]
    ds_read_b64_tr_b16 v[240:241], v20 offset:24576
    ds_read_b64_tr_b16 v[242:243], v20 offset:25088
    v_mfma_f32_32x32x16_bf16 v[64:79], v[244:247], v[164:167], v[64:79]
    ds_read_b64_tr_b16 v[244:245], v21 offset:24576
    ds_read_b64_tr_b16 v[246:247], v21 offset:25088
    s_waitcnt lgkmcnt(4)
    v_mfma_f32_32x32x16_bf16 v[64:79], v[248:251], v[168:171], v[64:79]
    ds_read_b64_tr_b16 v[248:249], v22 offset:24576
    ds_read_b64_tr_b16 v[250:251], v22 offset:25088
    buffer_load_dwordx4 v42, s[12:15], s79 offen offset:1024 lds
    v_mfma_f32_32x32x16_bf16 v[64:79], v[252:255], v[172:175], v[64:79]
    ds_read_b64_tr_b16 v[252:253], v23 offset:24576
    ds_read_b64_tr_b16 v[254:255], v23 offset:25088
    s_waitcnt lgkmcnt(4)
    v_mfma_f32_32x32x16_bf16 v[64:79], v[240:243], v[176:179], v[64:79]
    v_mfma_f32_16x16x32_bf16 v[12:15], v[8:11], v[240:243], v[12:15]
    ds_read_b64_tr_b16 v[240:241], v20 offset:32768
    ds_read_b64_tr_b16 v[242:243], v20 offset:33280
    v_mfma_f32_32x32x16_bf16 v[64:79], v[244:247], v[180:183], v[64:79]
    ds_read_b64_tr_b16 v[244:245], v21 offset:32768
    ds_read_b64_tr_b16 v[246:247], v21 offset:33280
    s_waitcnt lgkmcnt(4)
    v_mfma_f32_32x32x16_bf16 v[64:79], v[248:251], v[184:187], v[64:79]
    ds_read_b64_tr_b16 v[248:249], v22 offset:32768
    ds_read_b64_tr_b16 v[250:251], v22 offset:33280
    v_mfma_f32_32x32x16_bf16 v[64:79], v[252:255], v[188:191], v[64:79]
    ds_read_b64_tr_b16 v[252:253], v23 offset:32768
    ds_read_b64_tr_b16 v[254:255], v23 offset:33280
    s_waitcnt lgkmcnt(4)
    v_mfma_f32_32x32x16_bf16 v[64:79], v[240:243], v[192:195], v[64:79]
    v_mfma_f32_16x16x32_bf16 v[12:15], v[8:11], v[240:243], v[12:15]
    ds_read_b64_tr_b16 v[240:241], v20 offset:40960
    ds_read_b64_tr_b16 v[242:243], v20 offset:41472
    v_mfma_f32_32x32x16_bf16 v[64:79], v[244:247], v[196:199], v[64:79]
    ds_read_b64_tr_b16 v[244:245], v21 offset:40960
    ds_read_b64_tr_b16 v[246:247], v21 offset:41472
    s_waitcnt lgkmcnt(4)
    v_mfma_f32_32x32x16_bf16 v[64:79], v[248:251], v[200:203], v[64:79]
    ds_read_b64_tr_b16 v[248:249], v22 offset:40960
    ds_read_b64_tr_b16 v[250:251], v22 offset:41472
    v_mfma_f32_32x32x16_bf16 v[64:79], v[252:255], v[204:207], v[64:79]
    ds_read_b64_tr_b16 v[252:253], v23 offset:40960
    ds_read_b64_tr_b16 v[254:255], v23 offset:41472
    s_waitcnt lgkmcnt(4)
    v_mfma_f32_32x32x16_bf16 v[64:79], v[240:243], v[208:211], v[64:79]
    v_mfma_f32_16x16x32_bf16 v[12:15], v[8:11], v[240:243], v[12:15]
    ds_read_b64_tr_b16 v[240:241], v20 offset:49152
    ds_read_b64_tr_b16 v[242:243], v20 offset:49664
    v_mfma_f32_32x32x16_bf16 v[64:79], v[244:247], v[212:215], v[64:79]
    ds_read_b64_tr_b16 v[244:245], v21 offset:49152
    ds_read_b64_tr_b16 v[246:247], v21 offset:49664
    s_waitcnt lgkmcnt(4)
    v_mfma_f32_32x32x16_bf16 v[64:79], v[248:251], v[216:219], v[64:79]
    ds_read_b64_tr_b16 v[248:249], v22 offset:49152
    ds_read_b64_tr_b16 v[250:251], v22 offset:49664
    v_mfma_f32_32x32x16_bf16 v[64:79], v[252:255], v[220:223], v[64:79]
    ds_read_b64_tr_b16 v[252:253], v23 offset:49152
    ds_read_b64_tr_b16 v[254:255], v23 offset:49664
    s_waitcnt lgkmcnt(4)
    v_mfma_f32_32x32x16_bf16 v[64:79], v[240:243], v[224:227], v[64:79]
    v_mfma_f32_16x16x32_bf16 v[12:15], v[8:11], v[240:243], v[12:15]
    v_mfma_f32_32x32x16_bf16 v[64:79], v[244:247], v[228:231], v[64:79]
    s_nop 6
    ds_write_b32 v6, v12
    s_waitcnt vmcnt(0) lgkmcnt(0)
    s_barrier
    s_setprio 2
    ds_read_b128 v[56:59], v7 offset:0
    v_mfma_f32_32x32x16_bf16 v[64:79], v[248:251], v[232:235], v[64:79]
    v_mfma_f32_32x32x16_bf16 v[64:79], v[252:255], v[236:239], v[64:79]
    s_waitcnt lgkmcnt(0)
    v_add_f32 v56, v56, v57
    v_add_f32 v58, v58, v59
    v_add_f32 v56, v56, v58
    v_cvt_pk_bf16_f32 v57, v56, v56
    v_lshlrev_b32 v57, 16, v57
    v_sub_f32 v57, v56, v57
    v_cvt_pk_bf16_f32 v32, v56, v57
    s_nop 1
    v_mfma_f32_32x32x8_bf16 v[64:79], v[32:33], v[36:37], v[64:79]
    s_setprio 0
    s_nop 10
    v_mul_f32 v48, v64, v38
    v_mul_f32 v49, v65, v38
    v_mul_f32 v50, v66, v38
    v_mul_f32 v51, v67, v38
    v_exp_f32_e64 v48, v48 clamp
    v_exp_f32_e64 v49, v49 clamp
    v_exp_f32_e64 v50, v50 clamp
    v_exp_f32_e64 v51, v51 clamp
    v_fma_f32 v64, v64, v41, s85
    v_fma_f32 v65, v65, v41, s85
    v_fma_f32 v66, v66, v41, s85
    v_fma_f32 v67, v67, v41, s85
    v_max_f32 v64, s85, v64
    v_max_f32 v65, s85, v65
    v_max_f32 v66, s85, v66
    v_max_f32 v67, s85, v67
    v_add_f32 v64, v64, v48
    v_add_f32 v65, v65, v49
    v_add_f32 v66, v66, v50
    v_add_f32 v67, v67, v51
    v_cvt_pk_bf16_f32 v96, v64, v65
    v_cvt_pk_bf16_f32 v97, v66, v67
    v_mul_f32 v48, v68, v38
    v_mul_f32 v49, v69, v38
    v_mul_f32 v50, v70, v38
    v_mul_f32 v51, v71, v38
    v_exp_f32_e64 v48, v48 clamp
    v_exp_f32_e64 v49, v49 clamp
    v_exp_f32_e64 v50, v50 clamp
    v_exp_f32_e64 v51, v51 clamp
    v_fma_f32 v68, v68, v41, s85
    v_fma_f32 v69, v69, v41, s85
    v_fma_f32 v70, v70, v41, s85
    v_fma_f32 v71, v71, v41, s85
    v_max_f32 v68, s85, v68
    v_max_f32 v69, s85, v69
    v_max_f32 v70, s85, v70
    v_max_f32 v71, s85, v71
    v_add_f32 v68, v68, v48
    v_add_f32 v69, v69, v49
    v_add_f32 v70, v70, v50
    ds_read_b64_tr_b16 v[240:241], v20 offset:57344
    v_add_f32 v71, v71, v51
    v_cvt_pk_bf16_f32 v98, v68, v69
    v_cvt_pk_bf16_f32 v99, v70, v71
    v_mul_f32 v48, v72, v38
    ds_read_b64_tr_b16 v[242:243], v20 offset:57856
    v_mul_f32 v49, v73, v38
    v_mul_f32 v50, v74, v38
    v_mul_f32 v51, v75, v38
    v_exp_f32_e64 v48, v48 clamp
    ds_read_b64_tr_b16 v[244:245], v21 offset:57344
    v_exp_f32_e64 v49, v49 clamp
    v_exp_f32_e64 v50, v50 clamp
    v_exp_f32_e64 v51, v51 clamp
    v_fma_f32 v72, v72, v41, s85
    ds_read_b64_tr_b16 v[246:247], v21 offset:57856
    v_fma_f32 v73, v73, v41, s85
    v_fma_f32 v74, v74, v41, s85
    v_fma_f32 v75, v75, v41, s85
    v_max_f32 v72, s85, v72
    ds_read_b64_tr_b16 v[248:249], v22 offset:57344
    v_max_f32 v73, s85, v73
    v_max_f32 v74, s85, v74
    v_max_f32 v75, s85, v75
    v_add_f32 v72, v72, v48
    ds_read_b64_tr_b16 v[250:251], v22 offset:57856
    v_add_f32 v73, v73, v49
    v_add_f32 v74, v74, v50
    v_add_f32 v75, v75, v51
    v_cvt_pk_bf16_f32 v100, v72, v73
    ds_read_b64_tr_b16 v[252:253], v23 offset:57344
    v_cvt_pk_bf16_f32 v101, v74, v75
    v_mul_f32 v48, v76, v38
    v_mul_f32 v49, v77, v38
    v_mul_f32 v50, v78, v38
    ds_read_b64_tr_b16 v[254:255], v23 offset:57856
    v_mul_f32 v51, v79, v38
    v_exp_f32_e64 v48, v48 clamp
    v_exp_f32_e64 v49, v49 clamp
    v_exp_f32_e64 v50, v50 clamp
    v_exp_f32_e64 v51, v51 clamp
    v_fma_f32 v76, v76, v41, s85
    v_fma_f32 v77, v77, v41, s85
    v_fma_f32 v78, v78, v41, s85
    v_fma_f32 v79, v79, v41, s85
    v_max_f32 v76, s85, v76
    v_max_f32 v77, s85, v77
    v_max_f32 v78, s85, v78
    v_max_f32 v79, s85, v79
    v_add_f32 v76, v76, v48
    v_add_f32 v77, v77, v49
    v_add_f32 v78, v78, v50
    v_add_f32 v79, v79, v51
    v_cvt_pk_bf16_f32 v102, v76, v77
    v_cvt_pk_bf16_f32 v103, v78, v79
    v_cndmask_b32 v102, v102, 0, s[92:93]
    v_cndmask_b32 v103, v103, 0, s[92:93]
    s_waitcnt lgkmcnt(0)
    s_barrier
    s_setprio 1
    v_mfma_f32_32x32x16_bf16 v[64:79], v[240:243], v[128:131], 0
    v_mfma_f32_16x16x32_bf16 v[12:15], v[8:11], v[240:243], 0
    v_add_u32 v20, 0x10000, v20
    v_add_u32 v21, 0x10000, v21
    v_add_u32 v22, 0x10000, v22
    v_add_u32 v23, 0x10000, v23
    ds_read_b64_tr_b16 v[240:241], v20 offset:0
    ds_read_b64_tr_b16 v[242:243], v20 offset:512
    v_mfma_f32_32x32x16_bf16 v[64:79], v[244:247], v[132:135], v[64:79]
    ds_read_b64_tr_b16 v[244:245], v21 offset:0
    ds_read_b64_tr_b16 v[246:247], v21 offset:512
    v_mfma_f32_32x32x16_bf16 v[64:79], v[248:251], v[136:139], v[64:79]
    ds_read_b64_tr_b16 v[248:249], v22 offset:0
    ds_read_b64_tr_b16 v[250:251], v22 offset:512
    v_mfma_f32_32x32x16_bf16 v[64:79], v[252:255], v[140:143], v[64:79]
    ds_read_b64_tr_b16 v[252:253], v23 offset:0
    ds_read_b64_tr_b16 v[254:255], v23 offset:512
    s_waitcnt lgkmcnt(4)
    v_mfma_f32_32x32x16_bf16 v[64:79], v[240:243], v[144:147], v[64:79]
    v_mfma_f32_16x16x32_bf16 v[12:15], v[8:11], v[240:243], v[12:15]
    ds_read_b64_tr_b16 v[240:241], v20 offset:8192
    ds_read_b64_tr_b16 v[242:243], v20 offset:8704
    v_mfma_f32_32x32x16_bf16 v[64:79], v[244:247], v[148:151], v[64:79]
    ds_read_b64_tr_b16 v[244:245], v21 offset:8192
    ds_read_b64_tr_b16 v[246:247], v21 offset:8704
    s_waitcnt lgkmcnt(4)
    v_mfma_f32_32x32x16_bf16 v[64:79], v[248:251], v[152:155], v[64:79]
    ds_read_b64_tr_b16 v[248:249], v22 offset:8192
    ds_read_b64_tr_b16 v[250:251], v22 offset:8704
    v_mfma_f32_32x32x16_bf16 v[64:79], v[252:255], v[156:159], v[64:79]
    ds_read_b64_tr_b16 v[252:253], v23 offset:8192
    ds_read_b64_tr_b16 v[254:255], v23 offset:8704
    s_waitcnt lgkmcnt(4)
    v_mfma_f32_32x32x16_bf16 v[64:79], v[240:243], v[160:163], v[64:79]
    v_mfma_f32_16x16x32_bf16 v[12:15], v[8:11], v[240:243], v[12:15]
    ds_read_b64_tr_b16 v[240:241], v20 offset:16384
    ds_read_b64_tr_b16 v[242:243], v20 offset:16896
    v_mfma_f32_32x32x16_bf16 v[64:79], v[244:247], v[164:167], v[64:79]
    ds_read_b64_tr_b16 v[244:245], v21 offset:16384
    ds_read_b64_tr_b16 v[246:247], v21 offset:16896
    s_waitcnt lgkmcnt(4)
    v_mfma_f32_32x32x16_bf16 v[64:79], v[248:251], v[168:171], v[64:79]
    ds_read_b64_tr_b16 v[248:249], v22 offset:16384
    ds_read_b64_tr_b16 v[250:251], v22 offset:16896
    v_mfma_f32_32x32x16_bf16 v[64:79], v[252:255], v[172:175], v[64:79]
    ds_read_b64_tr_b16 v[252:253], v23 offset:16384
    ds_read_b64_tr_b16 v[254:255], v23 offset:16896
    s_waitcnt lgkmcnt(4)
    v_mfma_f32_32x32x16_bf16 v[64:79], v[240:243], v[176:179], v[64:79]
    v_mfma_f32_16x16x32_bf16 v[12:15], v[8:11], v[240:243], v[12:15]
    ds_read_b64_tr_b16 v[240:241], v20 offset:24576
    ds_read_b64_tr_b16 v[242:243], v20 offset:25088
    v_mfma_f32_32x32x16_bf16 v[64:79], v[244:247], v[180:183], v[64:79]
    ds_read_b64_tr_b16 v[244:245], v21 offset:24576
    ds_read_b64_tr_b16 v[246:247], v21 offset:25088
    s_waitcnt lgkmcnt(4)
    v_mfma_f32_32x32x16_bf16 v[64:79], v[248:251], v[184:187], v[64:79]
    ds_read_b64_tr_b16 v[248:249], v22 offset:24576
    ds_read_b64_tr_b16 v[250:251], v22 offset:25088
    v_mfma_f32_32x32x16_bf16 v[64:79], v[252:255], v[188:191], v[64:79]
    ds_read_b64_tr_b16 v[252:253], v23 offset:24576
    ds_read_b64_tr_b16 v[254:255], v23 offset:25088
    s_waitcnt lgkmcnt(4)
    v_mfma_f32_32x32x16_bf16 v[64:79], v[240:243], v[192:195], v[64:79]
    v_mfma_f32_16x16x32_bf16 v[12:15], v[8:11], v[240:243], v[12:15]
    ds_read_b64_tr_b16 v[240:241], v20 offset:32768
    ds_read_b64_tr_b16 v[242:243], v20 offset:33280
    v_mfma_f32_32x32x16_bf16 v[64:79], v[244:247], v[196:199], v[64:79]
    ds_read_b64_tr_b16 v[244:245], v21 offset:32768
    ds_read_b64_tr_b16 v[246:247], v21 offset:33280
    s_waitcnt lgkmcnt(4)
    v_mfma_f32_32x32x16_bf16 v[64:79], v[248:251], v[200:203], v[64:79]
    ds_read_b64_tr_b16 v[248:249], v22 offset:32768
    ds_read_b64_tr_b16 v[250:251], v22 offset:33280
    v_mfma_f32_32x32x16_bf16 v[64:79], v[252:255], v[204:207], v[64:79]
    ds_read_b64_tr_b16 v[252:253], v23 offset:32768
    ds_read_b64_tr_b16 v[254:255], v23 offset:33280
    s_waitcnt lgkmcnt(4)
    v_mfma_f32_32x32x16_bf16 v[64:79], v[240:243], v[208:211], v[64:79]
    v_mfma_f32_16x16x32_bf16 v[12:15], v[8:11], v[240:243], v[12:15]
    ds_read_b64_tr_b16 v[240:241], v20 offset:40960
    ds_read_b64_tr_b16 v[242:243], v20 offset:41472
    v_mfma_f32_32x32x16_bf16 v[64:79], v[244:247], v[212:215], v[64:79]
    ds_read_b64_tr_b16 v[244:245], v21 offset:40960
    ds_read_b64_tr_b16 v[246:247], v21 offset:41472
    s_waitcnt lgkmcnt(4)
    v_mfma_f32_32x32x16_bf16 v[64:79], v[248:251], v[216:219], v[64:79]
    ds_read_b64_tr_b16 v[248:249], v22 offset:40960
    ds_read_b64_tr_b16 v[250:251], v22 offset:41472
    v_mfma_f32_32x32x16_bf16 v[64:79], v[252:255], v[220:223], v[64:79]
    ds_read_b64_tr_b16 v[252:253], v23 offset:40960
    ds_read_b64_tr_b16 v[254:255], v23 offset:41472
    s_waitcnt lgkmcnt(4)
    v_mfma_f32_32x32x16_bf16 v[64:79], v[240:243], v[224:227], v[64:79]
    v_mfma_f32_16x16x32_bf16 v[12:15], v[8:11], v[240:243], v[12:15]
    v_mfma_f32_32x32x16_bf16 v[64:79], v[244:247], v[228:231], v[64:79]
    s_nop 6
    ds_write_b32 v6, v12
    s_waitcnt lgkmcnt(0)
    s_barrier
    s_setprio 2
    ds_read_b128 v[56:59], v7 offset:0
    v_mfma_f32_32x32x16_bf16 v[64:79], v[248:251], v[232:235], v[64:79]
    v_mfma_f32_32x32x16_bf16 v[64:79], v[252:255], v[236:239], v[64:79]
    s_waitcnt lgkmcnt(0)
    v_add_f32 v56, v56, v57
    v_add_f32 v58, v58, v59
    v_add_f32 v56, v56, v58
    v_cvt_pk_bf16_f32 v57, v56, v56
    v_lshlrev_b32 v57, 16, v57
    v_sub_f32 v57, v56, v57
    v_cvt_pk_bf16_f32 v32, v56, v57
    s_nop 1
    v_mfma_f32_32x32x8_bf16 v[64:79], v[32:33], v[36:37], v[64:79]
    s_setprio 0
    s_nop 10
    v_mul_f32 v48, v64, v38
    v_mul_f32 v49, v65, v38
    v_mul_f32 v50, v66, v38
    v_mul_f32 v51, v67, v38
    v_exp_f32_e64 v48, v48 clamp
    v_exp_f32_e64 v49, v49 clamp
    v_exp_f32_e64 v50, v50 clamp
    v_exp_f32_e64 v51, v51 clamp
    v_fma_f32 v64, v64, v41, s85
    v_fma_f32 v65, v65, v41, s85
    v_fma_f32 v66, v66, v41, s85
    v_fma_f32 v67, v67, v41, s85
    v_max_f32 v64, s85, v64
    v_max_f32 v65, s85, v65
    v_max_f32 v66, s85, v66
    v_max_f32 v67, s85, v67
    v_add_f32 v64, v64, v48
    v_add_f32 v65, v65, v49
    v_add_f32 v66, v66, v50
    v_add_f32 v67, v67, v51
    v_cvt_pk_bf16_f32 v104, v64, v65
    v_cvt_pk_bf16_f32 v105, v66, v67
    v_mul_f32 v48, v68, v38
    v_mul_f32 v49, v69, v38
    v_mul_f32 v50, v70, v38
    v_mul_f32 v51, v71, v38
    v_exp_f32_e64 v48, v48 clamp
    v_exp_f32_e64 v49, v49 clamp
    v_exp_f32_e64 v50, v50 clamp
    v_exp_f32_e64 v51, v51 clamp
    v_fma_f32 v68, v68, v41, s85
    v_fma_f32 v69, v69, v41, s85
    v_fma_f32 v70, v70, v41, s85
    v_fma_f32 v71, v71, v41, s85
    v_max_f32 v68, s85, v68
    v_max_f32 v69, s85, v69
    v_max_f32 v70, s85, v70
    v_max_f32 v71, s85, v71
    v_add_f32 v68, v68, v48
    v_add_f32 v69, v69, v49
    v_add_f32 v70, v70, v50
    v_add_f32 v71, v71, v51
    v_cvt_pk_bf16_f32 v106, v68, v69
    v_cvt_pk_bf16_f32 v107, v70, v71
    v_mul_f32 v48, v72, v38
    v_mul_f32 v49, v73, v38
    v_mul_f32 v50, v74, v38
    v_mul_f32 v51, v75, v38
    v_exp_f32_e64 v48, v48 clamp
    v_exp_f32_e64 v49, v49 clamp
    v_exp_f32_e64 v50, v50 clamp
    v_exp_f32_e64 v51, v51 clamp
    v_fma_f32 v72, v72, v41, s85
    v_fma_f32 v73, v73, v41, s85
    v_fma_f32 v74, v74, v41, s85
    v_fma_f32 v75, v75, v41, s85
    v_max_f32 v72, s85, v72
    v_max_f32 v73, s85, v73
    v_max_f32 v74, s85, v74
    v_max_f32 v75, s85, v75
    v_add_f32 v72, v72, v48
    v_add_f32 v73, v73, v49
    v_add_f32 v74, v74, v50
    v_add_f32 v75, v75, v51
    v_cvt_pk_bf16_f32 v108, v72, v73
    v_cvt_pk_bf16_f32 v109, v74, v75
    v_mul_f32 v48, v76, v38
    v_mul_f32 v49, v77, v38
    v_mul_f32 v50, v78, v38
    v_mul_f32 v51, v79, v38
    v_exp_f32_e64 v48, v48 clamp
    v_exp_f32_e64 v49, v49 clamp
    v_exp_f32_e64 v50, v50 clamp
    v_exp_f32_e64 v51, v51 clamp
    v_fma_f32 v76, v76, v41, s85
    v_fma_f32 v77, v77, v41, s85
    v_fma_f32 v78, v78, v41, s85
    v_fma_f32 v79, v79, v41, s85
    v_max_f32 v76, s85, v76
    v_max_f32 v77, s85, v77
    v_max_f32 v78, s85, v78
    v_max_f32 v79, s85, v79
    v_add_f32 v76, v76, v48
    v_add_f32 v77, v77, v49
    v_add_f32 v78, v78, v50
    v_add_f32 v79, v79, v51
    v_cvt_pk_bf16_f32 v110, v76, v77
    v_cvt_pk_bf16_f32 v111, v78, v79
    v_cndmask_b32 v110, v110, 0, s[92:93]
    v_cndmask_b32 v111, v111, 0, s[92:93]
L_qo:
    s_lshl_b32 s83, s5, 11
    s_add_u32 s83, s83, 114688
    v_add_u32 v50, s83, v1
    s_waitcnt lgkmcnt(0)
    s_barrier
    ds_read_b128 v[192:195], v50 offset:0
    ds_read_b128 v[196:199], v50 offset:1024
    ds_read_b128 v[200:203], v50 offset:4096
    ds_read_b128 v[204:207], v50 offset:5120
    ds_read_b128 v[208:211], v50 offset:8192
    ds_read_b128 v[212:215], v50 offset:9216
    ds_read_b128 v[216:219], v50 offset:12288
    ds_read_b128 v[220:223], v50 offset:13312
    s_waitcnt lgkmcnt(7)
    v_mfma_f32_32x32x16_bf16 v[128:143], v[192:195], v[80:83], 0
    s_waitcnt lgkmcnt(6)
    v_mfma_f32_32x32x16_bf16 v[128:143], v[196:199], v[84:87], v[128:143]
    s_waitcnt lgkmcnt(5)
    v_mfma_f32_32x32x16_bf16 v[144:159], v[200:203], v[88:91], 0
    s_waitcnt lgkmcnt(4)
    v_mfma_f32_32x32x16_bf16 v[144:159], v[204:207], v[92:95], v[144:159]
    s_add_u32 s82, s90, 4096
    s_nop 6
    v_add_f32 v52, s85, v140
    v_add_f32 v53, s85, v140
    s_nop 1
    v_permlane32_swap_b32 v52, v53
    v_rcp_f32 v53, v53
    s_nop 0
    v_pk_mul_f32 v[128:129], v[128:129], v[52:53] op_sel:[0,1] op_sel_hi:[1,1]
    v_pk_mul_f32 v[130:131], v[130:131], v[52:53] op_sel:[0,1] op_sel_hi:[1,1]
    v_pk_mul_f32 v[132:133], v[132:133], v[52:53] op_sel:[0,1] op_sel_hi:[1,1]
    v_pk_mul_f32 v[134:135], v[134:135], v[52:53] op_sel:[0,1] op_sel_hi:[1,1]
    v_cvt_pk_bf16_f32 v226, v132, v133
    v_cvt_pk_bf16_f32 v227, v134, v135
    v_cvt_pk_bf16_f32 v224, v128, v129
    v_cvt_pk_bf16_f32 v225, v130, v131
    buffer_store_dwordx4 v[224:227], v1, s[16:19], s90 offen offset:0 sc1
    v_pk_mul_f32 v[136:137], v[136:137], v[52:53] op_sel:[0,1] op_sel_hi:[1,1]
    v_pk_mul_f32 v[138:139], v[138:139], v[52:53] op_sel:[0,1] op_sel_hi:[1,1]
    v_pk_mul_f32 v[140:141], v[140:141], v[52:53] op_sel:[0,1] op_sel_hi:[1,1]
    v_pk_mul_f32 v[142:143], v[142:143], v[52:53] op_sel:[0,1] op_sel_hi:[1,1]
    v_cvt_pk_bf16_f32 v230, v140, v141
    v_cvt_pk_bf16_f32 v231, v142, v143
    v_cvt_pk_bf16_f32 v228, v136, v137
    v_cvt_pk_bf16_f32 v229, v138, v139
    s_waitcnt lgkmcnt(3)
    v_mfma_f32_32x32x16_bf16 v[160:175], v[208:211], v[96:99], 0
    s_waitcnt lgkmcnt(2)
    v_mfma_f32_32x32x16_bf16 v[160:175], v[212:215], v[100:103], v[160:175]
    v_add_f32 v52, s85, v156
    v_add_f32 v53, s85, v156
    s_nop 1
    v_permlane32_swap_b32 v52, v53
    v_rcp_f32 v53, v53
    s_nop 0
    v_pk_mul_f32 v[152:153], v[152:153], v[52:53] op_sel:[0,1] op_sel_hi:[1,1]
    v_pk_mul_f32 v[154:155], v[154:155], v[52:53] op_sel:[0,1] op_sel_hi:[1,1]
    v_pk_mul_f32 v[156:157], v[156:157], v[52:53] op_sel:[0,1] op_sel_hi:[1,1]
    v_pk_mul_f32 v[158:159], v[158:159], v[52:53] op_sel:[0,1] op_sel_hi:[1,1]
    v_cvt_pk_bf16_f32 v54, v156, v157
    v_cvt_pk_bf16_f32 v55, v158, v159
    v_cvt_pk_bf16_f32 v236, v152, v153
    v_cvt_pk_bf16_f32 v237, v154, v155
    v_permlane32_swap_b32 v230, v54
    v_permlane32_swap_b32 v231, v55
    buffer_store_dwordx4 v[228:231], v1, s[16:19], s90 offen offset:1024 sc1
    v_pk_mul_f32 v[144:145], v[144:145], v[52:53] op_sel:[0,1] op_sel_hi:[1,1]
    v_pk_mul_f32 v[146:147], v[146:147], v[52:53] op_sel:[0,1] op_sel_hi:[1,1]
    v_pk_mul_f32 v[148:149], v[148:149], v[52:53] op_sel:[0,1] op_sel_hi:[1,1]
    v_pk_mul_f32 v[150:151], v[150:151], v[52:53] op_sel:[0,1] op_sel_hi:[1,1]
    v_cvt_pk_bf16_f32 v234, v148, v149
    v_cvt_pk_bf16_f32 v235, v150, v151
    v_cvt_pk_bf16_f32 v232, v144, v145
    v_cvt_pk_bf16_f32 v233, v146, v147
    s_waitcnt lgkmcnt(1)
    v_mfma_f32_32x32x16_bf16 v[176:191], v[216:219], v[104:107], 0
    s_waitcnt lgkmcnt(0)
    v_mfma_f32_32x32x16_bf16 v[176:191], v[220:223], v[108:111], v[176:191]
    buffer_store_dwordx4 v[232:235], v1, s[16:19], s90 offen offset:2048 sc1
    v_add_f32 v52, s85, v172
    v_add_f32 v53, s85, v172
    s_nop 1
    v_permlane32_swap_b32 v52, v53
    v_rcp_f32 v53, v53
    s_nop 0
    v_pk_mul_f32 v[160:161], v[160:161], v[52:53] op_sel:[0,1] op_sel_hi:[1,1]
    v_pk_mul_f32 v[162:163], v[162:163], v[52:53] op_sel:[0,1] op_sel_hi:[1,1]
    v_pk_mul_f32 v[164:165], v[164:165], v[52:53] op_sel:[0,1] op_sel_hi:[1,1]
    v_pk_mul_f32 v[166:167], v[166:167], v[52:53] op_sel:[0,1] op_sel_hi:[1,1]
    v_cvt_pk_bf16_f32 v240, v164, v165
    v_cvt_pk_bf16_f32 v241, v166, v167
    v_cvt_pk_bf16_f32 v238, v160, v161
    v_cvt_pk_bf16_f32 v239, v162, v163
    buffer_store_dwordx4 v[236:239], v1, s[16:19], s90 offen offset:3072 sc1
    v_pk_mul_f32 v[168:169], v[168:169], v[52:53] op_sel:[0,1] op_sel_hi:[1,1]
    v_pk_mul_f32 v[170:171], v[170:171], v[52:53] op_sel:[0,1] op_sel_hi:[1,1]
    v_pk_mul_f32 v[172:173], v[172:173], v[52:53] op_sel:[0,1] op_sel_hi:[1,1]
    v_pk_mul_f32 v[174:175], v[174:175], v[52:53] op_sel:[0,1] op_sel_hi:[1,1]
    v_cvt_pk_bf16_f32 v244, v172, v173
    v_cvt_pk_bf16_f32 v245, v174, v175
    v_cvt_pk_bf16_f32 v242, v168, v169
    v_cvt_pk_bf16_f32 v243, v170, v171
    buffer_store_dwordx4 v[240:243], v1, s[16:19], s82 offen offset:0 sc1
    v_add_f32 v52, s85, v188
    v_add_f32 v53, s85, v188
    s_nop 1
    v_permlane32_swap_b32 v52, v53
    v_rcp_f32 v53, v53
    s_nop 0
    v_pk_mul_f32 v[184:185], v[184:185], v[52:53] op_sel:[0,1] op_sel_hi:[1,1]
    v_pk_mul_f32 v[186:187], v[186:187], v[52:53] op_sel:[0,1] op_sel_hi:[1,1]
    v_pk_mul_f32 v[188:189], v[188:189], v[52:53] op_sel:[0,1] op_sel_hi:[1,1]
    v_pk_mul_f32 v[190:191], v[190:191], v[52:53] op_sel:[0,1] op_sel_hi:[1,1]
    v_cvt_pk_bf16_f32 v54, v188, v189
    v_cvt_pk_bf16_f32 v55, v190, v191
    v_cvt_pk_bf16_f32 v250, v184, v185
    v_cvt_pk_bf16_f32 v251, v186, v187
    v_permlane32_swap_b32 v244, v54
    v_permlane32_swap_b32 v245, v55
    v_pk_mul_f32 v[176:177], v[176:177], v[52:53] op_sel:[0,1] op_sel_hi:[1,1]
    v_pk_mul_f32 v[178:179], v[178:179], v[52:53] op_sel:[0,1] op_sel_hi:[1,1]
    v_pk_mul_f32 v[180:181], v[180:181], v[52:53] op_sel:[0,1] op_sel_hi:[1,1]
    v_pk_mul_f32 v[182:183], v[182:183], v[52:53] op_sel:[0,1] op_sel_hi:[1,1]
    v_cvt_pk_bf16_f32 v248, v180, v181
    v_cvt_pk_bf16_f32 v249, v182, v183
    v_cvt_pk_bf16_f32 v246, v176, v177
    v_cvt_pk_bf16_f32 v247, v178, v179
    buffer_store_dwordx4 v[244:247], v1, s[16:19], s82 offen offset:1024 sc1
    buffer_store_dwordx4 v[248:251], v1, s[16:19], s82 offen offset:2048 sc1
    s_lshl1_add_u32 s82, s6, s81
    s_lshl_b32 s82, s82, 11
    s_lshl_b32 s83, s3, 28
    s_add_u32 s82, s82, s83
    s_add_u32 s82, s82, 0x920000
    v_cmp_gt_u32 vcc, 0x100, v1
    v_lshlrev_b32 v48, 3, v1
    s_nop 0
    v_cndmask_b32 v48, v46, v48, vcc
    s_waitcnt vmcnt(0) lgkmcnt(0)
    s_barrier
    buffer_store_dword v47, v48, s[16:19], s82 offen sc1
    s_branch L_fin
L_p2of23:
    s_waitcnt vmcnt(18)
    v_mfma_f32_32x32x16_bf16 v[64:79], v[56:59], v[168:171], v[64:79]
    ds_read_b64_tr_b16 v[48:49], v4 offset:4096
    ds_read_b64_tr_b16 v[50:51], v4 offset:5120
    v_mfma_f32_32x32x16_bf16 v[80:95], v[56:59], v[172:175], v[80:95]
    ds_read_b64_tr_b16 v[52:53], v5 offset:4096
    ds_read_b64_tr_b16 v[54:55], v5 offset:5120
    buffer_load_dwordx4 v[192:195], v1, s[16:19], s96 offen offset:0 sc1
    v_mfma_f32_32x32x16_bf16 v[96:111], v[60:63], v[168:171], v[96:111]
    buffer_load_dwordx4 v[200:203], v1, s[16:19], s96 offen offset:1024 sc1
    v_mfma_f32_32x32x16_bf16 v[112:127], v[60:63], v[172:175], v[112:127]
    buffer_load_dwordx4 v[208:211], v1, s[16:19], s96 offen offset:2048 sc1
    s_waitcnt vmcnt(17) lgkmcnt(2)
    v_mfma_f32_32x32x16_bf16 v[64:79], v[48:51], v[128:131], v[64:79]
    ds_read_b64_tr_b16 v[56:57], v4 offset:6144
    ds_read_b64_tr_b16 v[58:59], v4 offset:7168
    v_mfma_f32_32x32x16_bf16 v[80:95], v[48:51], v[132:135], v[80:95]
    ds_read_b64_tr_b16 v[60:61], v5 offset:6144
    ds_read_b64_tr_b16 v[62:63], v5 offset:7168
    buffer_load_dwordx4 v[216:219], v1, s[16:19], s96 offen offset:3072 sc1
    s_waitcnt lgkmcnt(4)
    v_mfma_f32_32x32x16_bf16 v[96:111], v[52:55], v[128:131], v[96:111]
    buffer_load_dwordx4 v[224:227], v1, s[16:19], s68 offen offset:0 sc1
    v_mfma_f32_32x32x16_bf16 v[112:127], v[52:55], v[132:135], v[112:127]
    buffer_load_dwordx4 v[232:235], v1, s[16:19], s68 offen offset:1024 sc1
    s_waitcnt vmcnt(16) lgkmcnt(2)
    v_mfma_f32_32x32x16_bf16 v[64:79], v[56:59], v[136:139], v[64:79]
    ds_read_b64_tr_b16 v[48:49], v4 offset:8192
    ds_read_b64_tr_b16 v[50:51], v4 offset:9216
    v_mfma_f32_32x32x16_bf16 v[80:95], v[56:59], v[140:143], v[80:95]
    ds_read_b64_tr_b16 v[52:53], v5 offset:8192
    ds_read_b64_tr_b16 v[54:55], v5 offset:9216
    s_waitcnt lgkmcnt(4)
    v_mfma_f32_32x32x16_bf16 v[96:111], v[60:63], v[136:139], v[96:111]
    v_mfma_f32_32x32x16_bf16 v[112:127], v[60:63], v[140:143], v[112:127]
    buffer_load_dwordx4 v[240:243], v1, s[16:19], s68 offen offset:2048 sc1
    s_waitcnt vmcnt(13) lgkmcnt(2)
    v_mfma_f32_32x32x16_bf16 v[64:79], v[48:51], v[144:147], v[64:79]
    ds_read_b64_tr_b16 v[56:57], v4 offset:10240
    ds_read_b64_tr_b16 v[58:59], v4 offset:11264
    v_mfma_f32_32x32x16_bf16 v[80:95], v[48:51], v[148:151], v[80:95]
    ds_read_b64_tr_b16 v[60:61], v5 offset:10240
    ds_read_b64_tr_b16 v[62:63], v5 offset:11264
    s_waitcnt lgkmcnt(4)
    v_mfma_f32_32x32x16_bf16 v[96:111], v[52:55], v[144:147], v[96:111]
    v_mfma_f32_32x32x16_bf16 v[112:127], v[52:55], v[148:151], v[112:127]
    s_waitcnt vmcnt(9) lgkmcnt(2)
    v_mfma_f32_32x32x16_bf16 v[64:79], v[56:59], v[152:155], v[64:79]
    ds_read_b64_tr_b16 v[160:161], v6 offset:0
    ds_read_b64_tr_b16 v[162:163], v6 offset:1024
    v_mfma_f32_32x32x16_bf16 v[80:95], v[56:59], v[156:159], v[80:95]
    ds_read_b64_tr_b16 v[164:165], v6 offset:2048
    ds_read_b64_tr_b16 v[166:167], v6 offset:3072
    s_waitcnt lgkmcnt(4)
    v_mfma_f32_32x32x16_bf16 v[96:111], v[60:63], v[152:155], v[96:111]
    ds_read_b64_tr_b16 v[168:169], v6 offset:4096
    ds_read_b64_tr_b16 v[170:171], v6 offset:5120
    v_mfma_f32_32x32x16_bf16 v[112:127], v[60:63], v[156:159], v[112:127]
    ds_read_b64_tr_b16 v[172:173], v6 offset:6144
    ds_read_b64_tr_b16 v[174:175], v6 offset:7168
    s_branch L_p2tailf
L_p2of25:
    s_waitcnt vmcnt(10)
    v_mfma_f32_32x32x16_bf16 v[64:79], v[56:59], v[136:139], v[64:79]
    ds_read_b64_tr_b16 v[48:49], v4 offset:8192
    ds_read_b64_tr_b16 v[50:51], v4 offset:9216
    v_mfma_f32_32x32x16_bf16 v[80:95], v[56:59], v[140:143], v[80:95]
    ds_read_b64_tr_b16 v[52:53], v5 offset:8192
    ds_read_b64_tr_b16 v[54:55], v5 offset:9216
    buffer_load_dwordx4 v[192:195], v1, s[16:19], s96 offen offset:0 sc1
    v_mfma_f32_32x32x16_bf16 v[96:111], v[60:63], v[136:139], v[96:111]
    buffer_load_dwordx4 v[200:203], v1, s[16:19], s96 offen offset:1024 sc1
    v_mfma_f32_32x32x16_bf16 v[112:127], v[60:63], v[140:143], v[112:127]
    buffer_load_dwordx4 v[208:211], v1, s[16:19], s96 offen offset:2048 sc1
    s_waitcnt vmcnt(9) lgkmcnt(2)
    v_mfma_f32_32x32x16_bf16 v[64:79], v[48:51], v[144:147], v[64:79]
    ds_read_b64_tr_b16 v[56:57], v4 offset:10240
    ds_read_b64_tr_b16 v[58:59], v4 offset:11264
    v_mfma_f32_32x32x16_bf16 v[80:95], v[48:51], v[148:151], v[80:95]
    ds_read_b64_tr_b16 v[60:61], v5 offset:10240
    ds_read_b64_tr_b16 v[62:63], v5 offset:11264
    buffer_load_dwordx4 v[216:219], v1, s[16:19], s96 offen offset:3072 sc1
    s_waitcnt lgkmcnt(4)
    v_mfma_f32_32x32x16_bf16 v[96:111], v[52:55], v[144:147], v[96:111]
    buffer_load_dwordx4 v[224:227], v1, s[16:19], s68 offen offset:0 sc1
    v_mfma_f32_32x32x16_bf16 v[112:127], v[52:55], v[148:151], v[112:127]
    buffer_load_dwordx4 v[232:235], v1, s[16:19], s68 offen offset:1024 sc1
    s_waitcnt vmcnt(8) lgkmcnt(2)
    v_mfma_f32_32x32x16_bf16 v[64:79], v[56:59], v[152:155], v[64:79]
    ds_read_b64_tr_b16 v[160:161], v6 offset:0
    ds_read_b64_tr_b16 v[162:163], v6 offset:1024
    v_mfma_f32_32x32x16_bf16 v[80:95], v[56:59], v[156:159], v[80:95]
    ds_read_b64_tr_b16 v[164:165], v6 offset:2048
    ds_read_b64_tr_b16 v[166:167], v6 offset:3072
    s_waitcnt lgkmcnt(4)
    v_mfma_f32_32x32x16_bf16 v[96:111], v[60:63], v[152:155], v[96:111]
    ds_read_b64_tr_b16 v[168:169], v6 offset:4096
    ds_read_b64_tr_b16 v[170:171], v6 offset:5120
    v_mfma_f32_32x32x16_bf16 v[112:127], v[60:63], v[156:159], v[112:127]
    ds_read_b64_tr_b16 v[172:173], v6 offset:6144
    ds_read_b64_tr_b16 v[174:175], v6 offset:7168
    buffer_load_dwordx4 v[240:243], v1, s[16:19], s68 offen offset:2048 sc1
    s_branch L_p2tailf
L_p2of27:
    s_waitcnt vmcnt(2)
    v_mfma_f32_32x32x16_bf16 v[64:79], v[56:59], v[152:155], v[64:79]
    ds_read_b64_tr_b16 v[160:161], v6 offset:0
    ds_read_b64_tr_b16 v[162:163], v6 offset:1024
    v_mfma_f32_32x32x16_bf16 v[80:95], v[56:59], v[156:159], v[80:95]
    ds_read_b64_tr_b16 v[164:165], v6 offset:2048
    ds_read_b64_tr_b16 v[166:167], v6 offset:3072
    buffer_load_dwordx4 v[192:195], v1, s[16:19], s96 offen offset:0 sc1
    v_mfma_f32_32x32x16_bf16 v[96:111], v[60:63], v[152:155], v[96:111]
    ds_read_b64_tr_b16 v[168:169], v6 offset:4096
    ds_read_b64_tr_b16 v[170:171], v6 offset:5120
    buffer_load_dwordx4 v[200:203], v1, s[16:19], s96 offen offset:1024 sc1
    v_mfma_f32_32x32x16_bf16 v[112:127], v[60:63], v[156:159], v[112:127]
    ds_read_b64_tr_b16 v[172:173], v6 offset:6144
    ds_read_b64_tr_b16 v[174:175], v6 offset:7168
    buffer_load_dwordx4 v[208:211], v1, s[16:19], s96 offen offset:2048 sc1
    buffer_load_dwordx4 v[216:219], v1, s[16:19], s96 offen offset:3072 sc1
    buffer_load_dwordx4 v[224:227], v1, s[16:19], s68 offen offset:0 sc1
    buffer_load_dwordx4 v[232:235], v1, s[16:19], s68 offen offset:1024 sc1
    buffer_load_dwordx4 v[240:243], v1, s[16:19], s68 offen offset:2048 sc1
    s_branch L_p2tailf
L_p2f:
    s_setprio 1
    buffer_load_dword v44, v31, s[16:19], s73 offen offset:256 sc1
    v_lshrrev_b32 v16, 4, v1
    v_bfe_u32 v17, v16, 2, 2
    v_and_b32 v18, 3, v16
    v_bfe_u32 v19, v16, 4, 1
    v_lshl_add_u32 v18, v19, 2, v18
    v_lshrrev_b32 v19, 1, v17
    v_lshlrev_b32 v19, 6, v19
    v_lshl_add_u32 v18, v18, 3, v19
    v_lshl_add_u32 v18, v17, 7, v18
    v_lshrrev_b32 v19, 5, v16
    v_lshl_add_u32 v19, v19, 9, v18
    v_add_u32 v4, s59, v19
    v_xor_b32 v5, 64, v4
    v_add_u32 v6, s60, v19
    v_xor_b32 v7, 64, v6
    s_xor_b32 s88, s89, 4
    s_add_u32 m0, s59, 0
    s_mul_i32 s88, s88, 14336
    s_add_u32 s88, s88, s58
    buffer_load_dwordx4 v2, s[20:23], s88 offen lds
    v_add_u32 v13, s100, v19
    v_xor_b32 v15, 64, v13
    v_subrev_u32 v14, 16, v45
    v_mov_b32 v8, v116
    v_lshlrev_b32 v248, 16, v108
    v_and_b32 v249, 0xffff0000, v108
    v_lshlrev_b32 v108, 16, v112
    v_and_b32 v112, 0xffff0000, v112
    v_add_f32 v248, v248, v108
    v_add_f32 v249, v249, v112
    v_lshlrev_b32 v250, 16, v109
    v_and_b32 v251, 0xffff0000, v109
    v_lshlrev_b32 v109, 16, v113
    v_and_b32 v113, 0xffff0000, v113
    buffer_load_dwordx4 v3, s[20:23], s88 offen offset:1024 lds
    v_add_f32 v250, v250, v109
    v_add_f32 v251, v251, v113
    v_lshlrev_b32 v252, 16, v110
    v_and_b32 v253, 0xffff0000, v110
    v_lshlrev_b32 v110, 16, v114
    v_and_b32 v114, 0xffff0000, v114
    v_add_f32 v252, v252, v110
    v_add_f32 v253, v253, v114
    v_lshlrev_b32 v254, 16, v111
    v_and_b32 v255, 0xffff0000, v111
    v_lshlrev_b32 v111, 16, v115
    v_and_b32 v115, 0xffff0000, v115
    v_add_f32 v254, v254, v111
    v_add_f32 v255, v255, v115
    ds_read_b64_tr_b16 v[48:49], v6 offset:0
    ds_read_b64_tr_b16 v[50:51], v6 offset:1024
    ds_read_b64_tr_b16 v[52:53], v7 offset:0
    ds_read_b64_tr_b16 v[54:55], v7 offset:1024
    s_waitcnt vmcnt(11) lgkmcnt(2)
    v_mfma_f32_32x32x16_bf16 v[64:79], v[48:51], v[128:131], 0
    ds_read_b64_tr_b16 v[56:57], v6 offset:2048
    ds_read_b64_tr_b16 v[58:59], v6 offset:3072
    s_xor_b32 s82, s89, 17
    s_lshl_b32 s82, s82, 10
    s_add_u32 s82, s82, s61
    buffer_load_dwordx4 v[168:171], v1, s[16:19], s82 offen sc1
    v_mfma_f32_32x32x16_bf16 v[80:95], v[48:51], v[132:135], 0
    ds_read_b64_tr_b16 v[60:61], v7 offset:2048
    ds_read_b64_tr_b16 v[62:63], v7 offset:3072
    buffer_load_dwordx4 v[172:175], v12, s[16:19], s82 offen sc1
    s_waitcnt lgkmcnt(4)
    v_mfma_f32_32x32x16_bf16 v[96:111], v[52:55], v[128:131], 0
    s_xor_b32 s88, s89, 5
    s_add_u32 m0, s59, 2048
    s_mul_i32 s88, s88, 14336
    s_add_u32 s88, s88, s58
    buffer_load_dwordx4 v2, s[20:23], s88 offen lds
    v_mfma_f32_32x32x16_bf16 v[112:127], v[52:55], v[132:135], 0
    buffer_load_dwordx4 v3, s[20:23], s88 offen offset:1024 lds
    s_waitcnt vmcnt(13) lgkmcnt(2)
    v_mfma_f32_32x32x16_bf16 v[64:79], v[56:59], v[136:139], v[64:79]
    ds_read_b64_tr_b16 v[48:49], v6 offset:4096
    ds_read_b64_tr_b16 v[50:51], v6 offset:5120
    s_xor_b32 s82, s89, 18
    s_lshl_b32 s82, s82, 10
    s_add_u32 s82, s82, s61
    buffer_load_dwordx4 v[128:131], v1, s[16:19], s82 offen sc1
    v_mfma_f32_32x32x16_bf16 v[80:95], v[56:59], v[140:143], v[80:95]
    ds_read_b64_tr_b16 v[52:53], v7 offset:4096
    ds_read_b64_tr_b16 v[54:55], v7 offset:5120
    buffer_load_dwordx4 v[132:135], v12, s[16:19], s82 offen sc1
    s_waitcnt lgkmcnt(4)
    v_mfma_f32_32x32x16_bf16 v[96:111], v[60:63], v[136:139], v[96:111]
    s_xor_b32 s88, s89, 6
    s_add_u32 m0, s59, 4096
    s_mul_i32 s88, s88, 14336
    s_add_u32 s88, s88, s58
    buffer_load_dwordx4 v2, s[20:23], s88 offen lds
    v_mfma_f32_32x32x16_bf16 v[112:127], v[60:63], v[140:143], v[112:127]
    buffer_load_dwordx4 v3, s[20:23], s88 offen offset:1024 lds
    s_waitcnt vmcnt(15) lgkmcnt(2)
    v_mfma_f32_32x32x16_bf16 v[64:79], v[48:51], v[144:147], v[64:79]
    ds_read_b64_tr_b16 v[56:57], v6 offset:6144
    ds_read_b64_tr_b16 v[58:59], v6 offset:7168
    s_xor_b32 s82, s89, 19
    s_lshl_b32 s82, s82, 10
    s_add_u32 s82, s82, s61
    buffer_load_dwordx4 v[136:139], v1, s[16:19], s82 offen sc1
    v_mfma_f32_32x32x16_bf16 v[80:95], v[48:51], v[148:151], v[80:95]
    ds_read_b64_tr_b16 v[60:61], v7 offset:6144
    ds_read_b64_tr_b16 v[62:63], v7 offset:7168
    buffer_load_dwordx4 v[140:143], v12, s[16:19], s82 offen sc1
    s_waitcnt lgkmcnt(4)
    v_mfma_f32_32x32x16_bf16 v[96:111], v[52:55], v[144:147], v[96:111]
    s_xor_b32 s88, s89, 22
    s_add_u32 m0, s60, 0
    s_mul_i32 s88, s88, 14336
    s_add_u32 s88, s88, s58
    buffer_load_dwordx4 v2, s[20:23], s88 offen lds
    v_mfma_f32_32x32x16_bf16 v[112:127], v[52:55], v[148:151], v[112:127]
    buffer_load_dwordx4 v3, s[20:23], s88 offen offset:1024 lds
    s_waitcnt vmcnt(14)
    v_cmp_ne_u32 vcc, 0, v44
    s_nop 0
    s_andn2_b32 s95, 3, vcc_lo
    s_cbranch_scc1 L_slow12
L_ret12:
    s_waitcnt lgkmcnt(2)
    v_mfma_f32_32x32x16_bf16 v[64:79], v[56:59], v[152:155], v[64:79]
    ds_read_b64_tr_b16 v[48:49], v6 offset:8192
    ds_read_b64_tr_b16 v[50:51], v6 offset:9216
    s_xor_b32 s82, s89, 4
    s_lshl_b32 s82, s82, 10
    s_add_u32 s82, s82, s61
    buffer_load_dwordx4 v[144:147], v1, s[16:19], s82 offen sc1
    v_mfma_f32_32x32x16_bf16 v[80:95], v[56:59], v[156:159], v[80:95]
    ds_read_b64_tr_b16 v[52:53], v7 offset:8192
    ds_read_b64_tr_b16 v[54:55], v7 offset:9216
    buffer_load_dwordx4 v[148:151], v12, s[16:19], s82 offen sc1
    s_waitcnt lgkmcnt(4)
    v_mfma_f32_32x32x16_bf16 v[96:111], v[60:63], v[152:155], v[96:111]
    s_xor_b32 s88, s89, 23
    s_add_u32 m0, s60, 2048
    s_mul_i32 s88, s88, 14336
    s_add_u32 s88, s88, s58
    buffer_load_dwordx4 v2, s[20:23], s88 offen lds
    v_mfma_f32_32x32x16_bf16 v[112:127], v[60:63], v[156:159], v[112:127]
    buffer_load_dwordx4 v3, s[20:23], s88 offen offset:1024 lds
    s_waitcnt lgkmcnt(2)
    v_mfma_f32_32x32x16_bf16 v[64:79], v[48:51], v[160:163], v[64:79]
    ds_read_b64_tr_b16 v[56:57], v13 offset:0
    ds_read_b64_tr_b16 v[58:59], v13 offset:1024
    s_xor_b32 s82, s89, 5
    s_lshl_b32 s82, s82, 10
    s_add_u32 s82, s82, s61
    buffer_load_dwordx4 v[152:155], v1, s[16:19], s82 offen sc1
    v_mfma_f32_32x32x16_bf16 v[80:95], v[48:51], v[164:167], v[80:95]
    ds_read_b64_tr_b16 v[60:61], v15 offset:0
    ds_read_b64_tr_b16 v[62:63], v15 offset:1024
    buffer_load_dwordx4 v[156:159], v12, s[16:19], s82 offen sc1
    s_waitcnt lgkmcnt(4)
    v_mfma_f32_32x32x16_bf16 v[96:111], v[52:55], v[160:163], v[96:111]
    s_xor_b32 s88, s89, 8
    s_add_u32 m0, s60, 4096
    s_mul_i32 s88, s88, 14336
    s_add_u32 s88, s88, s58
    buffer_load_dwordx4 v2, s[20:23], s88 offen lds
    v_mfma_f32_32x32x16_bf16 v[112:127], v[52:55], v[164:167], v[112:127]
    buffer_load_dwordx4 v3, s[20:23], s88 offen offset:1024 lds
    s_waitcnt vmcnt(18) lgkmcnt(2)
    v_mfma_f32_32x32x16_bf16 v[64:79], v[56:59], v[168:171], v[64:79]
    ds_read_b64_tr_b16 v[48:49], v13 offset:2048
    ds_read_b64_tr_b16 v[50:51], v13 offset:3072
    s_xor_b32 s82, s89, 6
    s_lshl_b32 s82, s82, 10
    s_add_u32 s82, s82, s61
    buffer_load_dwordx4 v[160:163], v1, s[16:19], s82 offen sc1
    v_mfma_f32_32x32x16_bf16 v[80:95], v[56:59], v[172:175], v[80:95]
    ds_read_b64_tr_b16 v[52:53], v15 offset:2048
    ds_read_b64_tr_b16 v[54:55], v15 offset:3072
    buffer_load_dwordx4 v[164:167], v12, s[16:19], s82 offen sc1
    s_waitcnt lgkmcnt(4)
    v_mfma_f32_32x32x16_bf16 v[96:111], v[60:63], v[168:171], v[96:111]
    s_xor_b32 s88, s89, 9
    s_add_u32 m0, s60, 6144
    s_mul_i32 s88, s88, 14336
    s_add_u32 s88, s88, s58
    buffer_load_dwordx4 v2, s[20:23], s88 offen lds
    v_mfma_f32_32x32x16_bf16 v[112:127], v[60:63], v[172:175], v[112:127]
    buffer_load_dwordx4 v3, s[20:23], s88 offen offset:1024 lds
    s_waitcnt vmcnt(18) lgkmcnt(2)
    v_mfma_f32_32x32x16_bf16 v[64:79], v[48:51], v[128:131], v[64:79]
    ds_read_b64_tr_b16 v[56:57], v13 offset:4096
    ds_read_b64_tr_b16 v[58:59], v13 offset:5120
    s_xor_b32 s82, s89, 7
    s_lshl_b32 s82, s82, 10
    s_add_u32 s82, s82, s61
    buffer_load_dwordx4 v[168:171], v1, s[16:19], s82 offen sc1
    v_mfma_f32_32x32x16_bf16 v[80:95], v[48:51], v[132:135], v[80:95]
    ds_read_b64_tr_b16 v[60:61], v15 offset:4096
    ds_read_b64_tr_b16 v[62:63], v15 offset:5120
    buffer_load_dwordx4 v[172:175], v12, s[16:19], s82 offen sc1
    s_waitcnt lgkmcnt(4)
    v_mfma_f32_32x32x16_bf16 v[96:111], v[52:55], v[128:131], v[96:111]
    s_xor_b32 s88, s89, 10
    s_add_u32 m0, s60, 8192
    s_mul_i32 s88, s88, 14336
    s_add_u32 s88, s88, s58
    buffer_load_dwordx4 v2, s[20:23], s88 offen lds
    v_mfma_f32_32x32x16_bf16 v[112:127], v[52:55], v[132:135], v[112:127]
    buffer_load_dwordx4 v3, s[20:23], s88 offen offset:1024 lds
    s_waitcnt vmcnt(18) lgkmcnt(2)
    v_mfma_f32_32x32x16_bf16 v[64:79], v[56:59], v[136:139], v[64:79]
    ds_read_b64_tr_b16 v[48:49], v4 offset:0
    ds_read_b64_tr_b16 v[50:51], v4 offset:1024
    s_xor_b32 s82, s89, 20
    s_lshl_b32 s82, s82, 10
    s_add_u32 s82, s82, s61
    buffer_load_dwordx4 v[128:131], v1, s[16:19], s82 offen sc1
    v_mfma_f32_32x32x16_bf16 v[80:95], v[56:59], v[140:143], v[80:95]
    ds_read_b64_tr_b16 v[52:53], v5 offset:0
    ds_read_b64_tr_b16 v[54:55], v5 offset:1024
    buffer_load_dwordx4 v[132:135], v12, s[16:19], s82 offen sc1
    s_waitcnt lgkmcnt(4)
    v_mfma_f32_32x32x16_bf16 v[96:111], v[60:63], v[136:139], v[96:111]
    s_xor_b32 s88, s89, 11
    s_add_u32 m0, s100, 0
    s_mul_i32 s88, s88, 14336
    s_add_u32 s88, s88, s58
    buffer_load_dwordx4 v2, s[20:23], s88 offen lds
    v_mfma_f32_32x32x16_bf16 v[112:127], v[60:63], v[140:143], v[112:127]
    buffer_load_dwordx4 v3, s[20:23], s88 offen offset:1024 lds
    s_waitcnt vmcnt(18) lgkmcnt(2)
    v_mfma_f32_32x32x16_bf16 v[64:79], v[48:51], v[144:147], v[64:79]
    ds_read_b64_tr_b16 v[56:57], v4 offset:2048
    ds_read_b64_tr_b16 v[58:59], v4 offset:3072
    s_xor_b32 s82, s89, 21
    s_lshl_b32 s82, s82, 10
    s_add_u32 s82, s82, s61
    buffer_load_dwordx4 v[136:139], v1, s[16:19], s82 offen sc1
    v_mfma_f32_32x32x16_bf16 v[80:95], v[48:51], v[148:151], v[80:95]
    ds_read_b64_tr_b16 v[60:61], v5 offset:2048
    ds_read_b64_tr_b16 v[62:63], v5 offset:3072
    buffer_load_dwordx4 v[140:143], v12, s[16:19], s82 offen sc1
    s_waitcnt lgkmcnt(4)
    v_mfma_f32_32x32x16_bf16 v[96:111], v[52:55], v[144:147], v[96:111]
    s_xor_b32 s88, s89, 24
    s_add_u32 m0, s100, 2048
    s_mul_i32 s88, s88, 14336
    s_add_u32 s88, s88, s58
    buffer_load_dwordx4 v2, s[20:23], s88 offen lds
    v_mfma_f32_32x32x16_bf16 v[112:127], v[52:55], v[148:151], v[112:127]
    buffer_load_dwordx4 v3, s[20:23], s88 offen offset:1024 lds
    s_waitcnt vmcnt(18) lgkmcnt(2)
    v_mfma_f32_32x32x16_bf16 v[64:79], v[56:59], v[152:155], v[64:79]
    ds_read_b64_tr_b16 v[48:49], v4 offset:4096
    ds_read_b64_tr_b16 v[50:51], v4 offset:5120
    s_xor_b32 s82, s89, 22
    s_lshl_b32 s82, s82, 10
    s_add_u32 s82, s82, s61
    buffer_load_dwordx4 v[144:147], v1, s[16:19], s82 offen sc1
    v_mfma_f32_32x32x16_bf16 v[80:95], v[56:59], v[156:159], v[80:95]
    ds_read_b64_tr_b16 v[52:53], v5 offset:4096
    ds_read_b64_tr_b16 v[54:55], v5 offset:5120
    buffer_load_dwordx4 v[148:151], v12, s[16:19], s82 offen sc1
    s_waitcnt lgkmcnt(4)
    v_mfma_f32_32x32x16_bf16 v[96:111], v[60:63], v[152:155], v[96:111]
    ds_read_b32 v11, v14
    s_xor_b32 s88, s89, 25
    s_add_u32 m0, s100, 4096
    s_mul_i32 s88, s88, 14336
    s_add_u32 s88, s88, s58
    buffer_load_dwordx4 v2, s[20:23], s88 offen lds
    v_mfma_f32_32x32x16_bf16 v[112:127], v[60:63], v[156:159], v[112:127]
    buffer_load_dwordx4 v3, s[20:23], s88 offen offset:1024 lds
    s_waitcnt lgkmcnt(0)
    v_readfirstlane_b32 s95, v11
    s_nop 0
    s_cmp_lt_u32 s95, 1
    s_cbranch_scc1 L_slow13
L_ret13:
    s_waitcnt vmcnt(18)
    v_mfma_f32_32x32x16_bf16 v[64:79], v[48:51], v[160:163], v[64:79]
    ds_read_b64_tr_b16 v[56:57], v4 offset:6144
    ds_read_b64_tr_b16 v[58:59], v4 offset:7168
    s_xor_b32 s82, s89, 23
    s_lshl_b32 s82, s82, 10
    s_add_u32 s82, s82, s61
    buffer_load_dwordx4 v[152:155], v1, s[16:19], s82 offen sc1
    v_mfma_f32_32x32x16_bf16 v[80:95], v[48:51], v[164:167], v[80:95]
    ds_read_b64_tr_b16 v[60:61], v5 offset:6144
    ds_read_b64_tr_b16 v[62:63], v5 offset:7168
    buffer_load_dwordx4 v[156:159], v12, s[16:19], s82 offen sc1
    s_xor_b32 s88, s89, 26
    s_add_u32 m0, s59, 0
    s_mul_i32 s88, s88, 14336
    s_add_u32 s88, s88, s58
    buffer_load_dwordx4 v2, s[20:23], s88 offen lds
    v_mfma_f32_32x32x16_bf16 v[96:111], v[52:55], v[160:163], v[96:111]
    ds_read_b32 v11, v14
    buffer_load_dwordx4 v3, s[20:23], s88 offen offset:1024 lds
    v_bfe_u32 v177, v0, 3, 5
    v_mfma_f32_32x32x16_bf16 v[112:127], v[52:55], v[164:167], v[112:127]
    v_and_b32 v178, 0x70, v1
    v_and_b32 v179, 7, v177
    s_waitcnt lgkmcnt(0)
    v_readfirstlane_b32 s95, v11
    s_nop 0
    s_cmp_lt_u32 s95, 3
    s_cbranch_scc1 L_slow14
L_ret14:
    s_waitcnt vmcnt(18)
    v_mfma_f32_32x32x16_bf16 v[64:79], v[56:59], v[168:171], v[64:79]
    ds_read_b64_tr_b16 v[48:49], v4 offset:8192
    ds_read_b64_tr_b16 v[50:51], v4 offset:9216
    s_xor_b32 s82, s89, 8
    s_lshl_b32 s82, s82, 10
    s_add_u32 s82, s82, s61
    buffer_load_dwordx4 v[160:163], v1, s[16:19], s82 offen sc1
    buffer_load_dwordx4 v[164:167], v12, s[16:19], s82 offen sc1
    v_mfma_f32_32x32x16_bf16 v[80:95], v[56:59], v[172:175], v[80:95]
    ds_read_b64_tr_b16 v[52:53], v5 offset:8192
    ds_read_b64_tr_b16 v[54:55], v5 offset:9216
    s_xor_b32 s88, s89, 27
    s_add_u32 m0, s59, 2048
    s_mul_i32 s88, s88, 14336
    s_add_u32 s88, s88, s58
    buffer_load_dwordx4 v2, s[20:23], s88 offen lds
    buffer_load_dwordx4 v3, s[20:23], s88 offen offset:1024 lds
    v_mfma_f32_32x32x16_bf16 v[96:111], v[60:63], v[168:171], v[96:111]
    v_bfe_u32 v180, v177, 1, 1
    v_lshl_add_u32 v179, v180, 3, v179
    v_mfma_f32_32x32x16_bf16 v[112:127], v[60:63], v[172:175], v[112:127]
    v_lshlrev_b32 v179, 4, v179
    v_xor_b32 v179, v179, v178
    s_waitcnt vmcnt(18) lgkmcnt(2)
    v_mfma_f32_32x32x16_bf16 v[64:79], v[48:51], v[128:131], v[64:79]
    ds_read_b64_tr_b16 v[56:57], v4 offset:10240
    ds_read_b64_tr_b16 v[58:59], v4 offset:11264
    s_xor_b32 s82, s89, 9
    s_lshl_b32 s82, s82, 10
    s_add_u32 s82, s82, s61
    buffer_load_dwordx4 v[168:171], v1, s[16:19], s82 offen sc1
    v_mfma_f32_32x32x16_bf16 v[80:95], v[48:51], v[132:135], v[80:95]
    ds_read_b64_tr_b16 v[60:61], v5 offset:10240
    ds_read_b64_tr_b16 v[62:63], v5 offset:11264
    buffer_load_dwordx4 v[172:175], v12, s[16:19], s82 offen sc1
    s_and_b32 s88, s89, 3
    s_xor_b32 s88, s88, 12
    s_add_u32 m0, s59, 4096
    s_mul_i32 s88, s88, 14336
    s_add_u32 s88, s88, s58
    buffer_load_dwordx4 v2, s[20:23], s88 offen lds
    s_waitcnt lgkmcnt(4)
    v_mfma_f32_32x32x16_bf16 v[96:111], v[52:55], v[128:131], v[96:111]
    buffer_load_dwordx4 v3, s[20:23], s88 offen offset:1024 lds
    v_lshl_add_u32 v9, v177, 8, v179
    v_mfma_f32_32x32x16_bf16 v[112:127], v[52:55], v[132:135], v[112:127]
    v_add_u32 v9, 114688, v9
    v_xor_b32 v10, 128, v9
    s_waitcnt vmcnt(18) lgkmcnt(2)
    v_mfma_f32_32x32x16_bf16 v[64:79], v[56:59], v[136:139], v[64:79]
    ds_read_b64_tr_b16 v[48:49], v6 offset:0
    ds_read_b64_tr_b16 v[50:51], v6 offset:1024
    s_xor_b32 s82, s89, 10
    s_lshl_b32 s82, s82, 10
    s_add_u32 s82, s82, s61
    buffer_load_dwordx4 v[128:131], v1, s[16:19], s82 offen sc1
    buffer_load_dwordx4 v[132:135], v12, s[16:19], s82 offen sc1
    v_mfma_f32_32x32x16_bf16 v[80:95], v[56:59], v[140:143], v[80:95]
    ds_read_b64_tr_b16 v[52:53], v7 offset:0
    ds_read_b64_tr_b16 v[54:55], v7 offset:1024
    s_and_b32 s88, s89, 3
    s_xor_b32 s88, s88, 13
    s_add_u32 m0, s59, 6144
    s_mul_i32 s88, s88, 14336
    s_add_u32 s88, s88, s58
    buffer_load_dwordx4 v2, s[20:23], s88 offen lds
    buffer_load_dwordx4 v3, s[20:23], s88 offen offset:1024 lds
    s_waitcnt lgkmcnt(4)
    v_mfma_f32_32x32x16_bf16 v[96:111], v[60:63], v[136:139], v[96:111]
    v_add_u32 v0, 46592, v2
    v_cndmask_b32 v0, v2, v0, s[92:93]
    v_mfma_f32_32x32x16_bf16 v[112:127], v[60:63], v[140:143], v[112:127]
    v_bfe_u32 v16, v1, 4, 5
    v_and_b32 v17, 7, v16
    s_waitcnt vmcnt(18) lgkmcnt(2)
    v_mfma_f32_32x32x16_bf16 v[64:79], v[48:51], v[144:147], v[64:79]
    ds_read_b64_tr_b16 v[56:57], v6 offset:2048
    ds_read_b64_tr_b16 v[58:59], v6 offset:3072
    s_xor_b32 s82, s89, 11
    s_lshl_b32 s82, s82, 10
    s_add_u32 s82, s82, s61
    buffer_load_dwordx4 v[136:139], v1, s[16:19], s82 offen sc1
    buffer_load_dwordx4 v[140:143], v12, s[16:19], s82 offen sc1
    v_mfma_f32_32x32x16_bf16 v[80:95], v[48:51], v[148:151], v[80:95]
    ds_read_b64_tr_b16 v[60:61], v7 offset:2048
    ds_read_b64_tr_b16 v[62:63], v7 offset:3072
    s_and_b32 s88, s89, 3
    s_xor_b32 s88, s88, 14
    s_add_u32 m0, s59, 8192
    s_mul_i32 s88, s88, 14336
    s_add_u32 s88, s88, s58
    buffer_load_dwordx4 v2, s[20:23], s88 offen lds
    buffer_load_dwordx4 v3, s[20:23], s88 offen offset:1024 lds
    s_waitcnt lgkmcnt(4)
    v_mfma_f32_32x32x16_bf16 v[96:111], v[52:55], v[144:147], v[96:111]
    v_bfe_u32 v18, v16, 1, 1
    v_lshrrev_b32 v19, 9, v1
    v_mfma_f32_32x32x16_bf16 v[112:127], v[52:55], v[148:151], v[112:127]
    v_xor_b32 v18, v18, v19
    v_lshl_add_u32 v17, v18, 3, v17
    s_waitcnt vmcnt(18) lgkmcnt(2)
    v_mfma_f32_32x32x16_bf16 v[64:79], v[56:59], v[152:155], v[64:79]
    ds_read_b64_tr_b16 v[48:49], v6 offset:4096
    ds_read_b64_tr_b16 v[50:51], v6 offset:5120
    s_xor_b32 s82, s89, 24
    s_lshl_b32 s82, s82, 10
    s_add_u32 s82, s82, s61
    buffer_load_dwordx4 v[144:147], v1, s[16:19], s82 offen sc1
    v_mfma_f32_32x32x16_bf16 v[80:95], v[56:59], v[156:159], v[80:95]
    ds_read_b64_tr_b16 v[52:53], v7 offset:4096
    ds_read_b64_tr_b16 v[54:55], v7 offset:5120
    buffer_load_dwordx4 v[148:151], v12, s[16:19], s82 offen sc1
    s_and_b32 s88, s89, 3
    s_xor_b32 s88, s88, 15
    s_add_u32 m0, s59, 10240
    s_mul_i32 s88, s88, 14336
    s_add_u32 s88, s88, s58
    buffer_load_dwordx4 v2, s[20:23], s88 offen lds
    s_waitcnt lgkmcnt(4)
    v_mfma_f32_32x32x16_bf16 v[96:111], v[60:63], v[152:155], v[96:111]
    buffer_load_dwordx4 v3, s[20:23], s88 offen offset:1024 lds
    v_lshlrev_b32 v17, 4, v17
    v_mfma_f32_32x32x16_bf16 v[112:127], v[60:63], v[156:159], v[112:127]
    v_lshl_add_u32 v17, v16, 8, v17
    v_add_u32 v24, s59, v17
    s_waitcnt vmcnt(18) lgkmcnt(2)
    v_mfma_f32_32x32x16_bf16 v[64:79], v[48:51], v[160:163], v[64:79]
    ds_read_b64_tr_b16 v[56:57], v6 offset:6144
    ds_read_b64_tr_b16 v[58:59], v6 offset:7168
    s_xor_b32 s82, s89, 25
    s_lshl_b32 s82, s82, 10
    s_add_u32 s82, s82, s61
    buffer_load_dwordx4 v[152:155], v1, s[16:19], s82 offen sc1
    buffer_load_dwordx4 v[156:159], v12, s[16:19], s82 offen sc1
    v_mfma_f32_32x32x16_bf16 v[80:95], v[48:51], v[164:167], v[80:95]
    ds_read_b64_tr_b16 v[60:61], v7 offset:6144
    ds_read_b64_tr_b16 v[62:63], v7 offset:7168
    s_add_u32 m0, s60, 0
    s_add_u32 s88, s62, 0
    buffer_load_dwordx4 v2, s[24:27], s88 offen offset:0 lds
    s_add_u32 s88, s62, 6144
    buffer_load_dwordx4 v2, s[24:27], s88 offen offset:1024 lds
    s_waitcnt lgkmcnt(4)
    v_mfma_f32_32x32x16_bf16 v[96:111], v[52:55], v[160:163], v[96:111]
    v_add_u32 v32, s60, v17
    v_xor_b32 v25, 16, v24
    v_mfma_f32_32x32x16_bf16 v[112:127], v[52:55], v[164:167], v[112:127]
    v_xor_b32 v26, 32, v24
    v_xor_b32 v27, 48, v24
    s_waitcnt vmcnt(18) lgkmcnt(2)
    v_mfma_f32_32x32x16_bf16 v[64:79], v[56:59], v[168:171], v[64:79]
    ds_read_b64_tr_b16 v[48:49], v6 offset:8192
    ds_read_b64_tr_b16 v[50:51], v6 offset:9216
    s_xor_b32 s82, s89, 26
    s_lshl_b32 s82, s82, 10
    s_add_u32 s82, s82, s61
    buffer_load_dwordx4 v[160:163], v1, s[16:19], s82 offen sc1
    v_mfma_f32_32x32x16_bf16 v[80:95], v[56:59], v[172:175], v[80:95]
    ds_read_b64_tr_b16 v[52:53], v7 offset:8192
    ds_read_b64_tr_b16 v[54:55], v7 offset:9216
    buffer_load_dwordx4 v[164:167], v12, s[16:19], s82 offen sc1
    s_add_u32 m0, s60, 2048
    s_add_u32 s88, s62, 14336
    buffer_load_dwordx4 v2, s[24:27], s88 offen offset:0 lds
    s_waitcnt lgkmcnt(4)
    v_mfma_f32_32x32x16_bf16 v[96:111], v[60:63], v[168:171], v[96:111]
    s_add_u32 s88, s62, 20480
    buffer_load_dwordx4 v0, s[24:27], s88 offen offset:1024 lds
    v_xor_b32 v28, 64, v24
    v_mfma_f32_32x32x16_bf16 v[112:127], v[60:63], v[172:175], v[112:127]
    v_xor_b32 v29, 80, v24
    v_xor_b32 v30, 96, v24
    s_waitcnt vmcnt(18) lgkmcnt(2)
    v_mfma_f32_32x32x16_bf16 v[64:79], v[48:51], v[128:131], v[64:79]
    ds_read_b64_tr_b16 v[56:57], v13 offset:0
    ds_read_b64_tr_b16 v[58:59], v13 offset:1024
    s_xor_b32 s82, s89, 27
    s_lshl_b32 s82, s82, 10
    s_add_u32 s82, s82, s61
    buffer_load_dwordx4 v[168:171], v1, s[16:19], s82 offen sc1
    buffer_load_dwordx4 v[172:175], v12, s[16:19], s82 offen sc1
    v_mfma_f32_32x32x16_bf16 v[80:95], v[48:51], v[132:135], v[80:95]
    ds_read_b64_tr_b16 v[60:61], v15 offset:0
    ds_read_b64_tr_b16 v[62:63], v15 offset:1024
    s_add_u32 m0, s60, 4096
    s_add_u32 s88, s62, 50176
    buffer_load_dwordx4 v2, s[24:27], s88 offen offset:0 lds
    s_add_u32 s88, s62, 56320
    buffer_load_dwordx4 v2, s[24:27], s88 offen offset:1024 lds
    s_waitcnt lgkmcnt(4)
    v_mfma_f32_32x32x16_bf16 v[96:111], v[52:55], v[128:131], v[96:111]
    v_xor_b32 v31, 112, v24
    v_xor_b32 v33, 16, v32
    v_mfma_f32_32x32x16_bf16 v[112:127], v[52:55], v[132:135], v[112:127]
    v_xor_b32 v34, 32, v32
    v_xor_b32 v35, 48, v32
    s_waitcnt vmcnt(18) lgkmcnt(2)
    v_mfma_f32_32x32x16_bf16 v[64:79], v[56:59], v[136:139], v[64:79]
    ds_read_b64_tr_b16 v[48:49], v13 offset:2048
    ds_read_b64_tr_b16 v[50:51], v13 offset:3072
    s_and_b32 s82, s89, 3
    s_xor_b32 s82, s82, 12
    s_lshl_b32 s82, s82, 10
    s_add_u32 s82, s82, s61
    buffer_load_dwordx4 v[128:131], v1, s[16:19], s82 offen sc1
    buffer_load_dwordx4 v[132:135], v12, s[16:19], s82 offen sc1
    v_mfma_f32_32x32x16_bf16 v[80:95], v[56:59], v[140:143], v[80:95]
    ds_read_b64_tr_b16 v[52:53], v15 offset:2048
    ds_read_b64_tr_b16 v[54:55], v15 offset:3072
    s_add_u32 m0, s60, 6144
    s_add_u32 s88, s62, 64512
    buffer_load_dwordx4 v2, s[24:27], s88 offen offset:0 lds
    s_add_u32 s88, s62, 99328
    buffer_load_dwordx4 v2, s[24:27], s88 offen offset:1024 lds
    s_waitcnt lgkmcnt(4)
    v_mfma_f32_32x32x16_bf16 v[96:111], v[60:63], v[136:139], v[96:111]
    v_xor_b32 v36, 64, v32
    v_xor_b32 v37, 80, v32
    v_mfma_f32_32x32x16_bf16 v[112:127], v[60:63], v[140:143], v[112:127]
    v_xor_b32 v38, 96, v32
    v_xor_b32 v39, 112, v32
    s_waitcnt vmcnt(18) lgkmcnt(2)
    v_mfma_f32_32x32x16_bf16 v[64:79], v[48:51], v[144:147], v[64:79]
    ds_read_b64_tr_b16 v[56:57], v13 offset:4096
    ds_read_b64_tr_b16 v[58:59], v13 offset:5120
    s_and_b32 s82, s89, 3
    s_xor_b32 s82, s82, 13
    s_lshl_b32 s82, s82, 10
    s_add_u32 s82, s82, s61
    buffer_load_dwordx4 v[136:139], v1, s[16:19], s82 offen sc1
    v_mfma_f32_32x32x16_bf16 v[80:95], v[48:51], v[148:151], v[80:95]
    ds_read_b64_tr_b16 v[60:61], v15 offset:4096
    ds_read_b64_tr_b16 v[62:63], v15 offset:5120
    buffer_load_dwordx4 v[140:143], v12, s[16:19], s82 offen sc1
    s_waitcnt lgkmcnt(4)
    v_mfma_f32_32x32x16_bf16 v[96:111], v[52:55], v[144:147], v[96:111]
    s_add_u32 m0, s60, 8192
    s_add_u32 s88, s62, 107520
    buffer_load_dwordx4 v2, s[24:27], s88 offen offset:0 lds
    v_mfma_f32_32x32x16_bf16 v[112:127], v[52:55], v[148:151], v[112:127]
    s_add_u32 s88, s62, 113664
    buffer_load_dwordx4 v2, s[24:27], s88 offen offset:1024 lds
    s_waitcnt vmcnt(18) lgkmcnt(2)
    v_mfma_f32_32x32x16_bf16 v[64:79], v[56:59], v[152:155], v[64:79]
    ds_read_b64_tr_b16 v[48:49], v4 offset:0
    ds_read_b64_tr_b16 v[50:51], v4 offset:1024
    s_and_b32 s82, s89, 3
    s_xor_b32 s82, s82, 14
    s_lshl_b32 s82, s82, 10
    s_add_u32 s82, s82, s61
    buffer_load_dwordx4 v[144:147], v1, s[16:19], s82 offen sc1
    v_mfma_f32_32x32x16_bf16 v[80:95], v[56:59], v[156:159], v[80:95]
    ds_read_b64_tr_b16 v[52:53], v5 offset:0
    ds_read_b64_tr_b16 v[54:55], v5 offset:1024
    buffer_load_dwordx4 v[148:151], v12, s[16:19], s82 offen sc1
    s_waitcnt lgkmcnt(4)
    v_mfma_f32_32x32x16_bf16 v[96:111], v[60:63], v[152:155], v[96:111]
    s_add_u32 m0, s100, 0
    s_add_u32 s88, s62, 121856
    buffer_load_dwordx4 v0, s[24:27], s88 offen offset:0 lds
    v_mfma_f32_32x32x16_bf16 v[112:127], v[60:63], v[156:159], v[112:127]
    s_add_u32 s88, s62, 149504
    buffer_load_dwordx4 v2, s[24:27], s88 offen offset:1024 lds
    s_waitcnt vmcnt(18) lgkmcnt(2)
    v_mfma_f32_32x32x16_bf16 v[64:79], v[48:51], v[160:163], v[64:79]
    ds_read_b64_tr_b16 v[56:57], v4 offset:2048
    ds_read_b64_tr_b16 v[58:59], v4 offset:3072
    s_and_b32 s82, s89, 3
    s_xor_b32 s82, s82, 15
    s_lshl_b32 s82, s82, 10
    s_add_u32 s82, s82, s61
    buffer_load_dwordx4 v[152:155], v1, s[16:19], s82 offen sc1
    v_mfma_f32_32x32x16_bf16 v[80:95], v[48:51], v[164:167], v[80:95]
    ds_read_b64_tr_b16 v[60:61], v5 offset:2048
    ds_read_b64_tr_b16 v[62:63], v5 offset:3072
    buffer_load_dwordx4 v[156:159], v12, s[16:19], s82 offen sc1
    s_waitcnt lgkmcnt(4)
    v_mfma_f32_32x32x16_bf16 v[96:111], v[52:55], v[160:163], v[96:111]
    ds_read_b32 v11, v14
    s_add_u32 m0, s100, 2048
    s_add_u32 s88, s62, 157696
    buffer_load_dwordx4 v2, s[24:27], s88 offen offset:0 lds
    v_mfma_f32_32x32x16_bf16 v[112:127], v[52:55], v[164:167], v[112:127]
    s_add_u32 s88, s62, 163840
    buffer_load_dwordx4 v2, s[24:27], s88 offen offset:1024 lds
    s_waitcnt lgkmcnt(0)
    v_readfirstlane_b32 s95, v11
    s_nop 0
    s_cmp_lt_u32 s95, 7
    s_cbranch_scc0 L_p2of23
    s_waitcnt vmcnt(18)
    v_mfma_f32_32x32x16_bf16 v[64:79], v[56:59], v[168:171], v[64:79]
    ds_read_b64_tr_b16 v[48:49], v4 offset:4096
    ds_read_b64_tr_b16 v[50:51], v4 offset:5120
    v_mfma_f32_32x32x16_bf16 v[80:95], v[56:59], v[172:175], v[80:95]
    ds_read_b64_tr_b16 v[52:53], v5 offset:4096
    ds_read_b64_tr_b16 v[54:55], v5 offset:5120
    v_mfma_f32_32x32x16_bf16 v[96:111], v[60:63], v[168:171], v[96:111]
    v_mfma_f32_32x32x16_bf16 v[112:127], v[60:63], v[172:175], v[112:127]
    s_waitcnt vmcnt(14) lgkmcnt(2)
    v_mfma_f32_32x32x16_bf16 v[64:79], v[48:51], v[128:131], v[64:79]
    ds_read_b64_tr_b16 v[56:57], v4 offset:6144
    ds_read_b64_tr_b16 v[58:59], v4 offset:7168
    v_mfma_f32_32x32x16_bf16 v[80:95], v[48:51], v[132:135], v[80:95]
    ds_read_b64_tr_b16 v[60:61], v5 offset:6144
    ds_read_b64_tr_b16 v[62:63], v5 offset:7168
    s_waitcnt lgkmcnt(4)
    v_mfma_f32_32x32x16_bf16 v[96:111], v[52:55], v[128:131], v[96:111]
    ds_read_b32 v11, v14
    v_mfma_f32_32x32x16_bf16 v[112:127], v[52:55], v[132:135], v[112:127]
    s_waitcnt lgkmcnt(0)
    v_readfirstlane_b32 s95, v11
    s_nop 0
    s_cmp_lt_u32 s95, 7
    s_cbranch_scc0 L_p2of25
    s_waitcnt vmcnt(10)
    v_mfma_f32_32x32x16_bf16 v[64:79], v[56:59], v[136:139], v[64:79]
    ds_read_b64_tr_b16 v[48:49], v4 offset:8192
    ds_read_b64_tr_b16 v[50:51], v4 offset:9216
    v_mfma_f32_32x32x16_bf16 v[80:95], v[56:59], v[140:143], v[80:95]
    ds_read_b64_tr_b16 v[52:53], v5 offset:8192
    ds_read_b64_tr_b16 v[54:55], v5 offset:9216
    v_mfma_f32_32x32x16_bf16 v[96:111], v[60:63], v[136:139], v[96:111]
    v_mfma_f32_32x32x16_bf16 v[112:127], v[60:63], v[140:143], v[112:127]
    s_waitcnt vmcnt(6) lgkmcnt(2)
    v_mfma_f32_32x32x16_bf16 v[64:79], v[48:51], v[144:147], v[64:79]
    ds_read_b64_tr_b16 v[56:57], v4 offset:10240
    ds_read_b64_tr_b16 v[58:59], v4 offset:11264
    v_mfma_f32_32x32x16_bf16 v[80:95], v[48:51], v[148:151], v[80:95]
    ds_read_b64_tr_b16 v[60:61], v5 offset:10240
    ds_read_b64_tr_b16 v[62:63], v5 offset:11264
    s_waitcnt lgkmcnt(4)
    v_mfma_f32_32x32x16_bf16 v[96:111], v[52:55], v[144:147], v[96:111]
    ds_read_b32 v11, v14
    v_mfma_f32_32x32x16_bf16 v[112:127], v[52:55], v[148:151], v[112:127]
    s_waitcnt lgkmcnt(0)
    v_readfirstlane_b32 s95, v11
    s_nop 0
    s_cmp_lt_u32 s95, 7
    s_cbranch_scc0 L_p2of27
    s_waitcnt vmcnt(2)
    v_mfma_f32_32x32x16_bf16 v[64:79], v[56:59], v[152:155], v[64:79]
    ds_read_b64_tr_b16 v[160:161], v6 offset:0
    ds_read_b64_tr_b16 v[162:163], v6 offset:1024
    v_mfma_f32_32x32x16_bf16 v[80:95], v[56:59], v[156:159], v[80:95]
    ds_read_b64_tr_b16 v[164:165], v6 offset:2048
    ds_read_b64_tr_b16 v[166:167], v6 offset:3072
    v_mfma_f32_32x32x16_bf16 v[96:111], v[60:63], v[152:155], v[96:111]
    ds_read_b64_tr_b16 v[168:169], v6 offset:4096
    ds_read_b64_tr_b16 v[170:171], v6 offset:5120
    ds_read_b32 v11, v14
    v_mfma_f32_32x32x16_bf16 v[112:127], v[60:63], v[156:159], v[112:127]
    ds_read_b64_tr_b16 v[172:173], v6 offset:6144
    ds_read_b64_tr_b16 v[174:175], v6 offset:7168
    s_waitcnt lgkmcnt(2)
    v_readfirstlane_b32 s95, v11
    s_nop 0
    s_cmp_lt_u32 s95, 7
    s_cbranch_scc1 L_slow15
L_ret15:
    buffer_load_dwordx4 v[192:195], v1, s[16:19], s96 offen offset:0 sc1
    buffer_load_dwordx4 v[200:203], v1, s[16:19], s96 offen offset:1024 sc1
    buffer_load_dwordx4 v[208:211], v1, s[16:19], s96 offen offset:2048 sc1
    buffer_load_dwordx4 v[216:219], v1, s[16:19], s96 offen offset:3072 sc1
    buffer_load_dwordx4 v[224:227], v1, s[16:19], s68 offen offset:0 sc1
    buffer_load_dwordx4 v[232:235], v1, s[16:19], s68 offen offset:1024 sc1
    buffer_load_dwordx4 v[240:243], v1, s[16:19], s68 offen offset:2048 sc1
L_p2tailf:
    s_waitcnt vmcnt(6) lgkmcnt(6)
    v_mfma_f32_32x32x16_bf16 v[64:79], v[160:163], v[192:195], v[64:79]
    buffer_load_dwordx4 v[196:199], v12, s[16:19], s96 offen offset:0 sc1
    ds_read_b64_tr_b16 v[176:177], v6 offset:8192
    ds_read_b64_tr_b16 v[178:179], v6 offset:9216
    s_waitcnt vmcnt(6) lgkmcnt(6)
    v_mfma_f32_32x32x16_bf16 v[64:79], v[164:167], v[200:203], v[64:79]
    buffer_load_dwordx4 v[204:207], v12, s[16:19], s96 offen offset:1024 sc1
    ds_read_b64_tr_b16 v[180:181], v13 offset:0
    ds_read_b64_tr_b16 v[182:183], v13 offset:1024
    s_waitcnt vmcnt(6) lgkmcnt(6)
    v_mfma_f32_32x32x16_bf16 v[64:79], v[168:171], v[208:211], v[64:79]
    buffer_load_dwordx4 v[212:215], v12, s[16:19], s96 offen offset:2048 sc1
    ds_read_b64_tr_b16 v[184:185], v13 offset:2048
    ds_read_b64_tr_b16 v[186:187], v13 offset:3072
    s_waitcnt vmcnt(6) lgkmcnt(6)
    v_mfma_f32_32x32x16_bf16 v[64:79], v[172:175], v[216:219], v[64:79]
    buffer_load_dwordx4 v[220:223], v12, s[16:19], s96 offen offset:3072 sc1
    ds_read_b64_tr_b16 v[128:129], v7 offset:0
    ds_read_b64_tr_b16 v[130:131], v7 offset:1024
    s_waitcnt vmcnt(6) lgkmcnt(6)
    v_mfma_f32_32x32x16_bf16 v[64:79], v[176:179], v[224:227], v[64:79]
    buffer_load_dwordx4 v[228:231], v12, s[16:19], s68 offen offset:0 sc1
    ds_read_b64_tr_b16 v[132:133], v7 offset:2048
    ds_read_b64_tr_b16 v[134:135], v7 offset:3072
    s_waitcnt vmcnt(6) lgkmcnt(6)
    v_mfma_f32_32x32x16_bf16 v[64:79], v[180:183], v[232:235], v[64:79]
    buffer_load_dwordx4 v[236:239], v12, s[16:19], s68 offen offset:1024 sc1
    ds_read_b64_tr_b16 v[136:137], v7 offset:4096
    ds_read_b64_tr_b16 v[138:139], v7 offset:5120
    s_waitcnt vmcnt(6) lgkmcnt(6)
    v_mfma_f32_32x32x16_bf16 v[64:79], v[184:187], v[240:243], v[64:79]
    buffer_load_dwordx4 v[244:247], v12, s[16:19], s68 offen offset:2048 sc1
    ds_read_b64_tr_b16 v[140:141], v7 offset:6144
    ds_read_b64_tr_b16 v[142:143], v7 offset:7168
    s_waitcnt lgkmcnt(6)
    v_mfma_f32_32x32x16_bf16 v[96:111], v[128:131], v[192:195], v[96:111]
    ds_read_b64_tr_b16 v[144:145], v7 offset:8192
    ds_read_b64_tr_b16 v[146:147], v7 offset:9216
    s_waitcnt lgkmcnt(6)
    v_mfma_f32_32x32x16_bf16 v[96:111], v[132:135], v[200:203], v[96:111]
    ds_read_b64_tr_b16 v[148:149], v15 offset:0
    ds_read_b64_tr_b16 v[150:151], v15 offset:1024
    s_waitcnt lgkmcnt(6)
    v_mfma_f32_32x32x16_bf16 v[96:111], v[136:139], v[208:211], v[96:111]
    ds_read_b64_tr_b16 v[152:153], v15 offset:2048
    ds_read_b64_tr_b16 v[154:155], v15 offset:3072
    s_waitcnt lgkmcnt(6)
    v_mfma_f32_32x32x16_bf16 v[96:111], v[140:143], v[216:219], v[96:111]
    s_waitcnt lgkmcnt(4)
    v_mfma_f32_32x32x16_bf16 v[96:111], v[144:147], v[224:227], v[96:111]
    s_waitcnt lgkmcnt(2)
    v_mfma_f32_32x32x16_bf16 v[96:111], v[148:151], v[232:235], v[96:111]
    s_waitcnt lgkmcnt(0)
    v_mfma_f32_32x32x16_bf16 v[96:111], v[152:155], v[240:243], v[96:111]
    ds_write_b128 v24, v[64:67]
    s_waitcnt vmcnt(6)
    v_mfma_f32_32x32x16_bf16 v[80:95], v[160:163], v[196:199], v[80:95]
    ds_write_b128 v25, v[68:71]
    s_waitcnt vmcnt(5)
    v_mfma_f32_32x32x16_bf16 v[80:95], v[164:167], v[204:207], v[80:95]
    s_waitcnt vmcnt(4)
    v_mfma_f32_32x32x16_bf16 v[80:95], v[168:171], v[212:215], v[80:95]
    ds_write_b128 v26, v[72:75]
    s_waitcnt vmcnt(3)
    v_mfma_f32_32x32x16_bf16 v[80:95], v[172:175], v[220:223], v[80:95]
    s_waitcnt vmcnt(2)
    v_mfma_f32_32x32x16_bf16 v[80:95], v[176:179], v[228:231], v[80:95]
    ds_write_b128 v27, v[76:79]
    s_waitcnt vmcnt(1)
    v_mfma_f32_32x32x16_bf16 v[80:95], v[180:183], v[236:239], v[80:95]
    s_waitcnt vmcnt(0)
    v_mfma_f32_32x32x16_bf16 v[80:95], v[184:187], v[244:247], v[80:95]
    ds_write_b128 v28, v[96:99]
    v_mfma_f32_32x32x16_bf16 v[112:127], v[128:131], v[196:199], v[112:127]
    v_mfma_f32_32x32x16_bf16 v[112:127], v[132:135], v[204:207], v[112:127]
    ds_write_b128 v29, v[100:103]
    v_mfma_f32_32x32x16_bf16 v[112:127], v[136:139], v[212:215], v[112:127]
    v_mfma_f32_32x32x16_bf16 v[112:127], v[140:143], v[220:223], v[112:127]
    ds_write_b128 v30, v[104:107]
    v_mfma_f32_32x32x16_bf16 v[112:127], v[144:147], v[228:231], v[112:127]
    v_mfma_f32_32x32x16_bf16 v[112:127], v[148:151], v[236:239], v[112:127]
    ds_write_b128 v31, v[108:111]
    v_mfma_f32_32x32x16_bf16 v[112:127], v[152:155], v[244:247], v[112:127]
    s_nop 0
    ds_write_b128 v32, v[80:83]
    ds_write_b128 v33, v[84:87]
    ds_write_b128 v34, v[88:91]
    ds_write_b128 v35, v[92:95]
    s_nop 6
    ds_write_b128 v36, v[112:115]
    ds_write_b128 v37, v[116:119]
    ds_write_b128 v38, v[120:123]
    ds_write_b128 v39, v[124:127]
    s_waitcnt lgkmcnt(0)
    s_barrier
    ds_read_b128 v[128:131], v9 offset:0
    ds_read_b128 v[132:135], v10 offset:0
    ds_read_b128 v[136:139], v9 offset:10240
    ds_read_b128 v[140:143], v10 offset:10240
    ds_read_b128 v[144:147], v9 offset:20480
    ds_read_b128 v[148:151], v10 offset:20480
    ds_read_b128 v[152:155], v9 offset:30720
    ds_read_b128 v[156:159], v10 offset:30720
    s_waitcnt lgkmcnt(6)
    v_pk_add_f32 v[248:249], v[248:249], v[128:129]
    v_pk_add_f32 v[250:251], v[250:251], v[130:131]
    v_pk_add_f32 v[252:253], v[252:253], v[132:133]
    v_pk_add_f32 v[254:255], v[254:255], v[134:135]
    s_waitcnt lgkmcnt(4)
    v_pk_add_f32 v[248:249], v[248:249], v[136:137]
    v_pk_add_f32 v[250:251], v[250:251], v[138:139]
    v_pk_add_f32 v[252:253], v[252:253], v[140:141]
    v_pk_add_f32 v[254:255], v[254:255], v[142:143]
    s_waitcnt lgkmcnt(2)
    v_pk_add_f32 v[248:249], v[248:249], v[144:145]
    v_pk_add_f32 v[250:251], v[250:251], v[146:147]
    v_pk_add_f32 v[252:253], v[252:253], v[148:149]
    v_pk_add_f32 v[254:255], v[254:255], v[150:151]
    s_waitcnt lgkmcnt(0)
    v_pk_add_f32 v[248:249], v[248:249], v[152:153]
    v_pk_add_f32 v[250:251], v[250:251], v[154:155]
    v_pk_add_f32 v[252:253], v[252:253], v[156:157]
    v_pk_add_f32 v[254:255], v[254:255], v[158:159]
    v_cvt_pk_bf16_f32 v248, v248, v249
    v_cvt_pk_bf16_f32 v249, v250, v251
    v_cvt_pk_bf16_f32 v250, v252, v253
    v_cvt_pk_bf16_f32 v251, v254, v255
    buffer_store_dwordx4 v[248:251], v8, s[28:31], s63 offen sc1
    s_branch L_fin
L_p2ok23:
    s_waitcnt vmcnt(18)
    v_mfma_f32_32x32x16_bf16 v[64:79], v[56:59], v[168:171], v[64:79]
    ds_read_b64_tr_b16 v[48:49], v6 offset:4096
    ds_read_b64_tr_b16 v[50:51], v6 offset:5120
    s_add_u32 m0, s59, 10240
    s_add_u32 s88, s62, 107520
    buffer_load_dwordx4 v2, s[24:27], s88 offen offset:0 lds
    v_mfma_f32_32x32x16_bf16 v[80:95], v[56:59], v[172:175], v[80:95]
    ds_read_b64_tr_b16 v[52:53], v7 offset:4096
    ds_read_b64_tr_b16 v[54:55], v7 offset:5120
    s_add_u32 s88, s62, 113664
    buffer_load_dwordx4 v2, s[24:27], s88 offen offset:1024 lds
    s_add_u32 m0, s60, 0
    s_add_u32 s88, s62, 121856
    buffer_load_dwordx4 v0, s[24:27], s88 offen offset:0 lds
    v_mfma_f32_32x32x16_bf16 v[96:111], v[60:63], v[168:171], v[96:111]
    s_add_u32 s88, s62, 149504
    buffer_load_dwordx4 v2, s[24:27], s88 offen offset:1024 lds
    buffer_load_dwordx4 v[192:195], v1, s[16:19], s96 offen offset:0 sc1
    v_mfma_f32_32x32x16_bf16 v[112:127], v[60:63], v[172:175], v[112:127]
    buffer_load_dwordx4 v[200:203], v1, s[16:19], s96 offen offset:1024 sc1
    buffer_load_dwordx4 v[208:211], v1, s[16:19], s96 offen offset:2048 sc1
    s_waitcnt vmcnt(21) lgkmcnt(2)
    v_mfma_f32_32x32x16_bf16 v[64:79], v[48:51], v[128:131], v[64:79]
    ds_read_b64_tr_b16 v[56:57], v6 offset:6144
    ds_read_b64_tr_b16 v[58:59], v6 offset:7168
    s_add_u32 m0, s60, 2048
    s_add_u32 s88, s62, 157696
    buffer_load_dwordx4 v2, s[24:27], s88 offen offset:0 lds
    v_mfma_f32_32x32x16_bf16 v[80:95], v[48:51], v[132:135], v[80:95]
    ds_read_b64_tr_b16 v[60:61], v7 offset:6144
    ds_read_b64_tr_b16 v[62:63], v7 offset:7168
    s_add_u32 s88, s62, 163840
    buffer_load_dwordx4 v2, s[24:27], s88 offen offset:1024 lds
    s_waitcnt lgkmcnt(4)
    v_mfma_f32_32x32x16_bf16 v[96:111], v[52:55], v[128:131], v[96:111]
    buffer_load_dwordx4 v[216:219], v1, s[16:19], s96 offen offset:3072 sc1
    v_mfma_f32_32x32x16_bf16 v[112:127], v[52:55], v[132:135], v[112:127]
    buffer_load_dwordx4 v[224:227], v1, s[16:19], s68 offen offset:0 sc1
    buffer_load_dwordx4 v[232:235], v1, s[16:19], s68 offen offset:1024 sc1
    s_waitcnt vmcnt(22) lgkmcnt(2)
    v_mfma_f32_32x32x16_bf16 v[64:79], v[56:59], v[136:139], v[64:79]
    ds_read_b64_tr_b16 v[48:49], v6 offset:8192
    ds_read_b64_tr_b16 v[50:51], v6 offset:9216
    v_mfma_f32_32x32x16_bf16 v[80:95], v[56:59], v[140:143], v[80:95]
    ds_read_b64_tr_b16 v[52:53], v7 offset:8192
    ds_read_b64_tr_b16 v[54:55], v7 offset:9216
    s_waitcnt lgkmcnt(4)
    v_mfma_f32_32x32x16_bf16 v[96:111], v[60:63], v[136:139], v[96:111]
    v_mfma_f32_32x32x16_bf16 v[112:127], v[60:63], v[140:143], v[112:127]
    buffer_load_dwordx4 v[240:243], v1, s[16:19], s68 offen offset:2048 sc1
    s_waitcnt vmcnt(19) lgkmcnt(2)
    v_mfma_f32_32x32x16_bf16 v[64:79], v[48:51], v[144:147], v[64:79]
    ds_read_b64_tr_b16 v[56:57], v4 offset:0
    ds_read_b64_tr_b16 v[58:59], v4 offset:1024
    v_mfma_f32_32x32x16_bf16 v[80:95], v[48:51], v[148:151], v[80:95]
    ds_read_b64_tr_b16 v[60:61], v5 offset:0
    ds_read_b64_tr_b16 v[62:63], v5 offset:1024
    s_waitcnt lgkmcnt(4)
    v_mfma_f32_32x32x16_bf16 v[96:111], v[52:55], v[144:147], v[96:111]
    v_mfma_f32_32x32x16_bf16 v[112:127], v[52:55], v[148:151], v[112:127]
    s_waitcnt vmcnt(15) lgkmcnt(2)
    v_mfma_f32_32x32x16_bf16 v[64:79], v[56:59], v[152:155], v[64:79]
    ds_read_b64_tr_b16 v[160:161], v4 offset:2048
    ds_read_b64_tr_b16 v[162:163], v4 offset:3072
    v_mfma_f32_32x32x16_bf16 v[80:95], v[56:59], v[156:159], v[80:95]
    ds_read_b64_tr_b16 v[164:165], v4 offset:4096
    ds_read_b64_tr_b16 v[166:167], v4 offset:5120
    s_waitcnt lgkmcnt(4)
    v_mfma_f32_32x32x16_bf16 v[96:111], v[60:63], v[152:155], v[96:111]
    ds_read_b64_tr_b16 v[168:169], v4 offset:6144
    ds_read_b64_tr_b16 v[170:171], v4 offset:7168
    v_mfma_f32_32x32x16_bf16 v[112:127], v[60:63], v[156:159], v[112:127]
    s_waitcnt vmcnt(13)
    ds_read_b64_tr_b16 v[172:173], v4 offset:8192
    ds_read_b64_tr_b16 v[174:175], v4 offset:9216
    s_branch L_p2tailk
L_p2ok25:
    s_waitcnt vmcnt(16)
    v_mfma_f32_32x32x16_bf16 v[64:79], v[56:59], v[136:139], v[64:79]
    ds_read_b64_tr_b16 v[48:49], v6 offset:8192
    ds_read_b64_tr_b16 v[50:51], v6 offset:9216
    v_mfma_f32_32x32x16_bf16 v[80:95], v[56:59], v[140:143], v[80:95]
    ds_read_b64_tr_b16 v[52:53], v7 offset:8192
    ds_read_b64_tr_b16 v[54:55], v7 offset:9216
    buffer_load_dwordx4 v[192:195], v1, s[16:19], s96 offen offset:0 sc1
    v_mfma_f32_32x32x16_bf16 v[96:111], v[60:63], v[136:139], v[96:111]
    buffer_load_dwordx4 v[200:203], v1, s[16:19], s96 offen offset:1024 sc1
    v_mfma_f32_32x32x16_bf16 v[112:127], v[60:63], v[140:143], v[112:127]
    buffer_load_dwordx4 v[208:211], v1, s[16:19], s96 offen offset:2048 sc1
    s_waitcnt vmcnt(15) lgkmcnt(2)
    v_mfma_f32_32x32x16_bf16 v[64:79], v[48:51], v[144:147], v[64:79]
    ds_read_b64_tr_b16 v[56:57], v4 offset:0
    ds_read_b64_tr_b16 v[58:59], v4 offset:1024
    v_mfma_f32_32x32x16_bf16 v[80:95], v[48:51], v[148:151], v[80:95]
    ds_read_b64_tr_b16 v[60:61], v5 offset:0
    ds_read_b64_tr_b16 v[62:63], v5 offset:1024
    buffer_load_dwordx4 v[216:219], v1, s[16:19], s96 offen offset:3072 sc1
    s_waitcnt lgkmcnt(4)
    v_mfma_f32_32x32x16_bf16 v[96:111], v[52:55], v[144:147], v[96:111]
    buffer_load_dwordx4 v[224:227], v1, s[16:19], s68 offen offset:0 sc1
    v_mfma_f32_32x32x16_bf16 v[112:127], v[52:55], v[148:151], v[112:127]
    buffer_load_dwordx4 v[232:235], v1, s[16:19], s68 offen offset:1024 sc1
    s_waitcnt vmcnt(14) lgkmcnt(2)
    v_mfma_f32_32x32x16_bf16 v[64:79], v[56:59], v[152:155], v[64:79]
    ds_read_b64_tr_b16 v[160:161], v4 offset:2048
    ds_read_b64_tr_b16 v[162:163], v4 offset:3072
    v_mfma_f32_32x32x16_bf16 v[80:95], v[56:59], v[156:159], v[80:95]
    ds_read_b64_tr_b16 v[164:165], v4 offset:4096
    ds_read_b64_tr_b16 v[166:167], v4 offset:5120
    s_waitcnt lgkmcnt(4)
    v_mfma_f32_32x32x16_bf16 v[96:111], v[60:63], v[152:155], v[96:111]
    ds_read_b64_tr_b16 v[168:169], v4 offset:6144
    ds_read_b64_tr_b16 v[170:171], v4 offset:7168
    v_mfma_f32_32x32x16_bf16 v[112:127], v[60:63], v[156:159], v[112:127]
    s_waitcnt vmcnt(12)
    ds_read_b64_tr_b16 v[172:173], v4 offset:8192
    ds_read_b64_tr_b16 v[174:175], v4 offset:9216
    buffer_load_dwordx4 v[240:243], v1, s[16:19], s68 offen offset:2048 sc1
    s_branch L_p2tailk
L_p2ok27:
    s_waitcnt vmcnt(8)
    v_mfma_f32_32x32x16_bf16 v[64:79], v[56:59], v[152:155], v[64:79]
    ds_read_b64_tr_b16 v[160:161], v4 offset:2048
    ds_read_b64_tr_b16 v[162:163], v4 offset:3072
    v_mfma_f32_32x32x16_bf16 v[80:95], v[56:59], v[156:159], v[80:95]
    ds_read_b64_tr_b16 v[164:165], v4 offset:4096
    ds_read_b64_tr_b16 v[166:167], v4 offset:5120
    buffer_load_dwordx4 v[192:195], v1, s[16:19], s96 offen offset:0 sc1
    v_mfma_f32_32x32x16_bf16 v[96:111], v[60:63], v[152:155], v[96:111]
    ds_read_b64_tr_b16 v[168:169], v4 offset:6144
    ds_read_b64_tr_b16 v[170:171], v4 offset:7168
    buffer_load_dwordx4 v[200:203], v1, s[16:19], s96 offen offset:1024 sc1
    v_mfma_f32_32x32x16_bf16 v[112:127], v[60:63], v[156:159], v[112:127]
    s_waitcnt vmcnt(8)
    ds_read_b64_tr_b16 v[172:173], v4 offset:8192
    ds_read_b64_tr_b16 v[174:175], v4 offset:9216
    buffer_load_dwordx4 v[208:211], v1, s[16:19], s96 offen offset:2048 sc1
    buffer_load_dwordx4 v[216:219], v1, s[16:19], s96 offen offset:3072 sc1
    buffer_load_dwordx4 v[224:227], v1, s[16:19], s68 offen offset:0 sc1
    buffer_load_dwordx4 v[232:235], v1, s[16:19], s68 offen offset:1024 sc1
    buffer_load_dwordx4 v[240:243], v1, s[16:19], s68 offen offset:2048 sc1
    s_branch L_p2tailk
L_p2k:
    s_setprio 1
    s_xor_b32 s82, s89, 3
    s_lshl_b32 s82, s82, 10
    s_add_u32 s82, s82, s61
    buffer_load_dwordx4 v[152:155], v1, s[16:19], s82 offen sc1
    v_lshrrev_b32 v16, 4, v1
    v_bfe_u32 v17, v16, 2, 2
    v_and_b32 v18, 3, v16
    v_bfe_u32 v19, v16, 4, 1
    buffer_load_dwordx4 v[156:159], v12, s[16:19], s82 offen sc1
    v_lshl_add_u32 v18, v19, 2, v18
    v_lshrrev_b32 v19, 1, v17
    v_lshlrev_b32 v19, 6, v19
    v_lshl_add_u32 v18, v18, 3, v19
    s_xor_b32 s88, s89, 18
    s_add_u32 m0, s59, 2048
    s_mul_i32 s88, s88, 14336
    s_add_u32 s88, s88, s58
    buffer_load_dwordx4 v2, s[20:23], s88 offen lds
    v_lshl_add_u32 v18, v17, 7, v18
    v_lshrrev_b32 v19, 5, v16
    v_lshl_add_u32 v19, v19, 9, v18
    v_add_u32 v4, s59, v19
    buffer_load_dwordx4 v3, s[20:23], s88 offen offset:1024 lds
    v_xor_b32 v5, 64, v4
    v_add_u32 v6, s60, v19
    v_xor_b32 v7, 64, v6
    v_subrev_u32 v14, 16, v45
    s_xor_b32 s82, s89, 16
    s_lshl_b32 s82, s82, 10
    s_add_u32 s82, s82, s61
    buffer_load_dwordx4 v[160:163], v1, s[16:19], s82 offen sc1
    v_mov_b32 v8, v72
    s_waitcnt vmcnt(11)
    v_lshlrev_b32 v248, 16, v64
    v_and_b32 v249, 0xffff0000, v64
    buffer_load_dwordx4 v[164:167], v12, s[16:19], s82 offen sc1
    v_lshlrev_b32 v64, 16, v68
    v_and_b32 v68, 0xffff0000, v68
    v_add_f32 v248, v248, v64
    s_xor_b32 s88, s89, 19
    s_add_u32 m0, s59, 4096
    s_mul_i32 s88, s88, 14336
    s_add_u32 s88, s88, s58
    buffer_load_dwordx4 v2, s[20:23], s88 offen lds
    v_add_f32 v249, v249, v68
    v_lshlrev_b32 v250, 16, v65
    v_and_b32 v251, 0xffff0000, v65
    v_lshlrev_b32 v65, 16, v69
    buffer_load_dwordx4 v3, s[20:23], s88 offen offset:1024 lds
    v_and_b32 v69, 0xffff0000, v69
    v_add_f32 v250, v250, v65
    v_add_f32 v251, v251, v69
    v_lshlrev_b32 v252, 16, v66
    buffer_load_dword v44, v31, s[16:19], s73 offen offset:256 sc1
    v_and_b32 v253, 0xffff0000, v66
    v_lshlrev_b32 v66, 16, v70
    v_and_b32 v70, 0xffff0000, v70
    v_add_f32 v252, v252, v66
    s_xor_b32 s88, s89, 4
    s_add_u32 m0, s59, 6144
    s_mul_i32 s88, s88, 14336
    s_add_u32 s88, s88, s58
    buffer_load_dwordx4 v2, s[20:23], s88 offen lds
    v_add_f32 v253, v253, v70
    v_lshlrev_b32 v254, 16, v67
    v_and_b32 v255, 0xffff0000, v67
    v_lshlrev_b32 v67, 16, v71
    buffer_load_dwordx4 v3, s[20:23], s88 offen offset:1024 lds
    v_and_b32 v71, 0xffff0000, v71
    v_add_f32 v254, v254, v67
    v_add_f32 v255, v255, v71
    ds_read_b64_tr_b16 v[48:49], v6 offset:0
    ds_read_b64_tr_b16 v[50:51], v6 offset:1024
    ds_read_b64_tr_b16 v[52:53], v7 offset:0
    ds_read_b64_tr_b16 v[54:55], v7 offset:1024
    s_waitcnt vmcnt(15) lgkmcnt(2)
    v_mfma_f32_32x32x16_bf16 v[64:79], v[48:51], v[128:131], 0
    ds_read_b64_tr_b16 v[56:57], v6 offset:2048
    ds_read_b64_tr_b16 v[58:59], v6 offset:3072
    s_xor_b32 s82, s89, 17
    s_lshl_b32 s82, s82, 10
    s_add_u32 s82, s82, s61
    buffer_load_dwordx4 v[168:171], v1, s[16:19], s82 offen sc1
    v_mfma_f32_32x32x16_bf16 v[80:95], v[48:51], v[132:135], 0
    ds_read_b64_tr_b16 v[60:61], v7 offset:2048
    ds_read_b64_tr_b16 v[62:63], v7 offset:3072
    buffer_load_dwordx4 v[172:175], v12, s[16:19], s82 offen sc1
    s_waitcnt lgkmcnt(4)
    v_mfma_f32_32x32x16_bf16 v[96:111], v[52:55], v[128:131], 0
    s_xor_b32 s88, s89, 5
    s_add_u32 m0, s59, 8192
    s_mul_i32 s88, s88, 14336
    s_add_u32 s88, s88, s58
    buffer_load_dwordx4 v2, s[20:23], s88 offen lds
    v_mfma_f32_32x32x16_bf16 v[112:127], v[52:55], v[132:135], 0
    buffer_load_dwordx4 v3, s[20:23], s88 offen offset:1024 lds
    s_waitcnt vmcnt(17) lgkmcnt(2)
    v_mfma_f32_32x32x16_bf16 v[64:79], v[56:59], v[136:139], v[64:79]
    ds_read_b64_tr_b16 v[48:49], v6 offset:4096
    ds_read_b64_tr_b16 v[50:51], v6 offset:5120
    s_xor_b32 s82, s89, 18
    s_lshl_b32 s82, s82, 10
    s_add_u32 s82, s82, s61
    buffer_load_dwordx4 v[128:131], v1, s[16:19], s82 offen sc1
    v_mfma_f32_32x32x16_bf16 v[80:95], v[56:59], v[140:143], v[80:95]
    ds_read_b64_tr_b16 v[52:53], v7 offset:4096
    ds_read_b64_tr_b16 v[54:55], v7 offset:5120
    buffer_load_dwordx4 v[132:135], v12, s[16:19], s82 offen sc1
    s_waitcnt lgkmcnt(4)
    v_mfma_f32_32x32x16_bf16 v[96:111], v[60:63], v[136:139], v[96:111]
    s_xor_b32 s88, s89, 6
    s_add_u32 m0, s59, 10240
    s_mul_i32 s88, s88, 14336
    s_add_u32 s88, s88, s58
    buffer_load_dwordx4 v2, s[20:23], s88 offen lds
    v_mfma_f32_32x32x16_bf16 v[112:127], v[60:63], v[140:143], v[112:127]
    buffer_load_dwordx4 v3, s[20:23], s88 offen offset:1024 lds
    s_waitcnt vmcnt(19) lgkmcnt(2)
    v_mfma_f32_32x32x16_bf16 v[64:79], v[48:51], v[144:147], v[64:79]
    ds_read_b64_tr_b16 v[56:57], v6 offset:6144
    ds_read_b64_tr_b16 v[58:59], v6 offset:7168
    s_xor_b32 s82, s89, 19
    s_lshl_b32 s82, s82, 10
    s_add_u32 s82, s82, s61
    buffer_load_dwordx4 v[136:139], v1, s[16:19], s82 offen sc1
    v_mfma_f32_32x32x16_bf16 v[80:95], v[48:51], v[148:151], v[80:95]
    ds_read_b64_tr_b16 v[60:61], v7 offset:6144
    ds_read_b64_tr_b16 v[62:63], v7 offset:7168
    buffer_load_dwordx4 v[140:143], v12, s[16:19], s82 offen sc1
    s_waitcnt lgkmcnt(4)
    v_mfma_f32_32x32x16_bf16 v[96:111], v[52:55], v[144:147], v[96:111]
    s_xor_b32 s88, s89, 7
    s_add_u32 m0, s60, 0
    s_mul_i32 s88, s88, 14336
    s_add_u32 s88, s88, s58
    buffer_load_dwordx4 v2, s[20:23], s88 offen lds
    v_mfma_f32_32x32x16_bf16 v[112:127], v[52:55], v[148:151], v[112:127]
    buffer_load_dwordx4 v3, s[20:23], s88 offen offset:1024 lds
    s_waitcnt vmcnt(14)
    v_cmp_ne_u32 vcc, 0, v44
    s_nop 0
    s_andn2_b32 s95, 3, vcc_lo
    s_cbranch_scc1 L_slow16
L_ret16:
    s_waitcnt lgkmcnt(2)
    v_mfma_f32_32x32x16_bf16 v[64:79], v[56:59], v[152:155], v[64:79]
    ds_read_b64_tr_b16 v[48:49], v6 offset:8192
    ds_read_b64_tr_b16 v[50:51], v6 offset:9216
    s_xor_b32 s82, s89, 4
    s_lshl_b32 s82, s82, 10
    s_add_u32 s82, s82, s61
    buffer_load_dwordx4 v[144:147], v1, s[16:19], s82 offen sc1
    v_mfma_f32_32x32x16_bf16 v[80:95], v[56:59], v[156:159], v[80:95]
    ds_read_b64_tr_b16 v[52:53], v7 offset:8192
    ds_read_b64_tr_b16 v[54:55], v7 offset:9216
    buffer_load_dwordx4 v[148:151], v12, s[16:19], s82 offen sc1
    s_waitcnt lgkmcnt(4)
    v_mfma_f32_32x32x16_bf16 v[96:111], v[60:63], v[152:155], v[96:111]
    s_xor_b32 s88, s89, 20
    s_add_u32 m0, s60, 2048
    s_mul_i32 s88, s88, 14336
    s_add_u32 s88, s88, s58
    buffer_load_dwordx4 v2, s[20:23], s88 offen lds
    v_mfma_f32_32x32x16_bf16 v[112:127], v[60:63], v[156:159], v[112:127]
    buffer_load_dwordx4 v3, s[20:23], s88 offen offset:1024 lds
    s_waitcnt lgkmcnt(2)
    v_mfma_f32_32x32x16_bf16 v[64:79], v[48:51], v[160:163], v[64:79]
    ds_read_b64_tr_b16 v[56:57], v4 offset:0
    ds_read_b64_tr_b16 v[58:59], v4 offset:1024
    s_xor_b32 s82, s89, 5
    s_lshl_b32 s82, s82, 10
    s_add_u32 s82, s82, s61
    buffer_load_dwordx4 v[152:155], v1, s[16:19], s82 offen sc1
    v_mfma_f32_32x32x16_bf16 v[80:95], v[48:51], v[164:167], v[80:95]
    ds_read_b64_tr_b16 v[60:61], v5 offset:0
    ds_read_b64_tr_b16 v[62:63], v5 offset:1024
    buffer_load_dwordx4 v[156:159], v12, s[16:19], s82 offen sc1
    s_waitcnt lgkmcnt(4)
    v_mfma_f32_32x32x16_bf16 v[96:111], v[52:55], v[160:163], v[96:111]
    s_xor_b32 s88, s89, 21
    s_add_u32 m0, s60, 4096
    s_mul_i32 s88, s88, 14336
    s_add_u32 s88, s88, s58
    buffer_load_dwordx4 v2, s[20:23], s88 offen lds
    v_mfma_f32_32x32x16_bf16 v[112:127], v[52:55], v[164:167], v[112:127]
    buffer_load_dwordx4 v3, s[20:23], s88 offen offset:1024 lds
    s_waitcnt vmcnt(18) lgkmcnt(2)
    v_mfma_f32_32x32x16_bf16 v[64:79], v[56:59], v[168:171], v[64:79]
    ds_read_b64_tr_b16 v[48:49], v4 offset:2048
    ds_read_b64_tr_b16 v[50:51], v4 offset:3072
    s_xor_b32 s82, s89, 6
    s_lshl_b32 s82, s82, 10
    s_add_u32 s82, s82, s61
    buffer_load_dwordx4 v[160:163], v1, s[16:19], s82 offen sc1
    v_mfma_f32_32x32x16_bf16 v[80:95], v[56:59], v[172:175], v[80:95]
    ds_read_b64_tr_b16 v[52:53], v5 offset:2048
    ds_read_b64_tr_b16 v[54:55], v5 offset:3072
    buffer_load_dwordx4 v[164:167], v12, s[16:19], s82 offen sc1
    s_waitcnt lgkmcnt(4)
    v_mfma_f32_32x32x16_bf16 v[96:111], v[60:63], v[168:171], v[96:111]
    s_xor_b32 s88, s89, 22
    s_add_u32 m0, s60, 6144
    s_mul_i32 s88, s88, 14336
    s_add_u32 s88, s88, s58
    buffer_load_dwordx4 v2, s[20:23], s88 offen lds
    v_mfma_f32_32x32x16_bf16 v[112:127], v[60:63], v[172:175], v[112:127]
    buffer_load_dwordx4 v3, s[20:23], s88 offen offset:1024 lds
    s_waitcnt vmcnt(18) lgkmcnt(2)
    v_mfma_f32_32x32x16_bf16 v[64:79], v[48:51], v[128:131], v[64:79]
    ds_read_b64_tr_b16 v[56:57], v4 offset:4096
    ds_read_b64_tr_b16 v[58:59], v4 offset:5120
    s_xor_b32 s82, s89, 7
    s_lshl_b32 s82, s82, 10
    s_add_u32 s82, s82, s61
    buffer_load_dwordx4 v[168:171], v1, s[16:19], s82 offen sc1
    v_mfma_f32_32x32x16_bf16 v[80:95], v[48:51], v[132:135], v[80:95]
    ds_read_b64_tr_b16 v[60:61], v5 offset:4096
    ds_read_b64_tr_b16 v[62:63], v5 offset:5120
    buffer_load_dwordx4 v[172:175], v12, s[16:19], s82 offen sc1
    s_waitcnt lgkmcnt(4)
    v_mfma_f32_32x32x16_bf16 v[96:111], v[52:55], v[128:131], v[96:111]
    s_xor_b32 s88, s89, 23
    s_add_u32 m0, s60, 8192
    s_mul_i32 s88, s88, 14336
    s_add_u32 s88, s88, s58
    buffer_load_dwordx4 v2, s[20:23], s88 offen lds
    v_mfma_f32_32x32x16_bf16 v[112:127], v[52:55], v[132:135], v[112:127]
    buffer_load_dwordx4 v3, s[20:23], s88 offen offset:1024 lds
    s_waitcnt vmcnt(18) lgkmcnt(2)
    v_mfma_f32_32x32x16_bf16 v[64:79], v[56:59], v[136:139], v[64:79]
    ds_read_b64_tr_b16 v[48:49], v4 offset:6144
    ds_read_b64_tr_b16 v[50:51], v4 offset:7168
    s_xor_b32 s82, s89, 20
    s_lshl_b32 s82, s82, 10
    s_add_u32 s82, s82, s61
    buffer_load_dwordx4 v[128:131], v1, s[16:19], s82 offen sc1
    v_mfma_f32_32x32x16_bf16 v[80:95], v[56:59], v[140:143], v[80:95]
    ds_read_b64_tr_b16 v[52:53], v5 offset:6144
    ds_read_b64_tr_b16 v[54:55], v5 offset:7168
    buffer_load_dwordx4 v[132:135], v12, s[16:19], s82 offen sc1
    s_waitcnt lgkmcnt(4)
    v_mfma_f32_32x32x16_bf16 v[96:111], v[60:63], v[136:139], v[96:111]
    s_xor_b32 s88, s89, 8
    s_add_u32 m0, s59, 0
    s_mul_i32 s88, s88, 14336
    s_add_u32 s88, s88, s58
    buffer_load_dwordx4 v2, s[20:23], s88 offen lds
    v_mfma_f32_32x32x16_bf16 v[112:127], v[60:63], v[140:143], v[112:127]
    buffer_load_dwordx4 v3, s[20:23], s88 offen offset:1024 lds
    s_waitcnt vmcnt(18) lgkmcnt(2)
    v_mfma_f32_32x32x16_bf16 v[64:79], v[48:51], v[144:147], v[64:79]
    ds_read_b64_tr_b16 v[56:57], v4 offset:8192
    ds_read_b64_tr_b16 v[58:59], v4 offset:9216
    s_xor_b32 s82, s89, 21
    s_lshl_b32 s82, s82, 10
    s_add_u32 s82, s82, s61
    buffer_load_dwordx4 v[136:139], v1, s[16:19], s82 offen sc1
    v_mfma_f32_32x32x16_bf16 v[80:95], v[48:51], v[148:151], v[80:95]
    ds_read_b64_tr_b16 v[60:61], v5 offset:8192
    ds_read_b64_tr_b16 v[62:63], v5 offset:9216
    buffer_load_dwordx4 v[140:143], v12, s[16:19], s82 offen sc1
    s_waitcnt lgkmcnt(4)
    v_mfma_f32_32x32x16_bf16 v[96:111], v[52:55], v[144:147], v[96:111]
    s_xor_b32 s88, s89, 9
    s_add_u32 m0, s59, 2048
    s_mul_i32 s88, s88, 14336
    s_add_u32 s88, s88, s58
    buffer_load_dwordx4 v2, s[20:23], s88 offen lds
    v_mfma_f32_32x32x16_bf16 v[112:127], v[52:55], v[148:151], v[112:127]
    buffer_load_dwordx4 v3, s[20:23], s88 offen offset:1024 lds
    s_waitcnt vmcnt(18) lgkmcnt(2)
    v_mfma_f32_32x32x16_bf16 v[64:79], v[56:59], v[152:155], v[64:79]
    ds_read_b64_tr_b16 v[48:49], v4 offset:10240
    ds_read_b64_tr_b16 v[50:51], v4 offset:11264
    s_xor_b32 s82, s89, 22
    s_lshl_b32 s82, s82, 10
    s_add_u32 s82, s82, s61
    buffer_load_dwordx4 v[144:147], v1, s[16:19], s82 offen sc1
    v_mfma_f32_32x32x16_bf16 v[80:95], v[56:59], v[156:159], v[80:95]
    ds_read_b64_tr_b16 v[52:53], v5 offset:10240
    ds_read_b64_tr_b16 v[54:55], v5 offset:11264
    buffer_load_dwordx4 v[148:151], v12, s[16:19], s82 offen sc1
    s_waitcnt lgkmcnt(4)
    v_mfma_f32_32x32x16_bf16 v[96:111], v[60:63], v[152:155], v[96:111]
    ds_read_b32 v11, v14
    s_xor_b32 s88, s89, 10
    s_add_u32 m0, s59, 4096
    s_mul_i32 s88, s88, 14336
    s_add_u32 s88, s88, s58
    buffer_load_dwordx4 v2, s[20:23], s88 offen lds
    v_mfma_f32_32x32x16_bf16 v[112:127], v[60:63], v[156:159], v[112:127]
    buffer_load_dwordx4 v3, s[20:23], s88 offen offset:1024 lds
    s_waitcnt vmcnt(18) lgkmcnt(3)
    v_mfma_f32_32x32x16_bf16 v[64:79], v[48:51], v[160:163], v[64:79]
    ds_read_b64_tr_b16 v[56:57], v6 offset:0
    ds_read_b64_tr_b16 v[58:59], v6 offset:1024
    s_xor_b32 s82, s89, 23
    s_lshl_b32 s82, s82, 10
    s_add_u32 s82, s82, s61
    buffer_load_dwordx4 v[152:155], v1, s[16:19], s82 offen sc1
    v_mfma_f32_32x32x16_bf16 v[80:95], v[48:51], v[164:167], v[80:95]
    ds_read_b64_tr_b16 v[60:61], v7 offset:0
    ds_read_b64_tr_b16 v[62:63], v7 offset:1024
    buffer_load_dwordx4 v[156:159], v12, s[16:19], s82 offen sc1
    s_xor_b32 s88, s89, 11
    s_add_u32 m0, s59, 6144
    s_mul_i32 s88, s88, 14336
    s_add_u32 s88, s88, s58
    buffer_load_dwordx4 v2, s[20:23], s88 offen lds
    s_waitcnt lgkmcnt(5)
    v_mfma_f32_32x32x16_bf16 v[96:111], v[52:55], v[160:163], v[96:111]
    ds_read_b32 v11, v14
    buffer_load_dwordx4 v3, s[20:23], s88 offen offset:1024 lds
    v_bfe_u32 v177, v0, 3, 5
    v_mfma_f32_32x32x16_bf16 v[112:127], v[52:55], v[164:167], v[112:127]
    v_and_b32 v178, 0x70, v1
    v_and_b32 v179, 7, v177
    s_waitcnt lgkmcnt(0)
    v_readfirstlane_b32 s95, v11
    s_nop 0
    s_cmp_lt_u32 s95, 3
    s_cbranch_scc1 L_slow17
L_ret17:
    s_waitcnt vmcnt(18)
    v_mfma_f32_32x32x16_bf16 v[64:79], v[56:59], v[168:171], v[64:79]
    ds_read_b64_tr_b16 v[48:49], v6 offset:2048
    ds_read_b64_tr_b16 v[50:51], v6 offset:3072
    s_xor_b32 s82, s89, 8
    s_lshl_b32 s82, s82, 10
    s_add_u32 s82, s82, s61
    buffer_load_dwordx4 v[160:163], v1, s[16:19], s82 offen sc1
    buffer_load_dwordx4 v[164:167], v12, s[16:19], s82 offen sc1
    v_mfma_f32_32x32x16_bf16 v[80:95], v[56:59], v[172:175], v[80:95]
    ds_read_b64_tr_b16 v[52:53], v7 offset:2048
    ds_read_b64_tr_b16 v[54:55], v7 offset:3072
    s_xor_b32 s88, s89, 24
    s_add_u32 m0, s59, 8192
    s_mul_i32 s88, s88, 14336
    s_add_u32 s88, s88, s58
    buffer_load_dwordx4 v2, s[20:23], s88 offen lds
    buffer_load_dwordx4 v3, s[20:23], s88 offen offset:1024 lds
    v_mfma_f32_32x32x16_bf16 v[96:111], v[60:63], v[168:171], v[96:111]
    v_bfe_u32 v180, v177, 1, 1
    v_lshl_add_u32 v179, v180, 3, v179
    v_mfma_f32_32x32x16_bf16 v[112:127], v[60:63], v[172:175], v[112:127]
    v_lshlrev_b32 v179, 4, v179
    v_xor_b32 v179, v179, v178
    s_waitcnt vmcnt(18) lgkmcnt(2)
    v_mfma_f32_32x32x16_bf16 v[64:79], v[48:51], v[128:131], v[64:79]
    ds_read_b64_tr_b16 v[56:57], v6 offset:4096
    ds_read_b64_tr_b16 v[58:59], v6 offset:5120
    s_xor_b32 s82, s89, 9
    s_lshl_b32 s82, s82, 10
    s_add_u32 s82, s82, s61
    buffer_load_dwordx4 v[168:171], v1, s[16:19], s82 offen sc1
    v_mfma_f32_32x32x16_bf16 v[80:95], v[48:51], v[132:135], v[80:95]
    ds_read_b64_tr_b16 v[60:61], v7 offset:4096
    ds_read_b64_tr_b16 v[62:63], v7 offset:5120
    buffer_load_dwordx4 v[172:175], v12, s[16:19], s82 offen sc1
    s_xor_b32 s88, s89, 25
    s_add_u32 m0, s59, 10240
    s_mul_i32 s88, s88, 14336
    s_add_u32 s88, s88, s58
    buffer_load_dwordx4 v2, s[20:23], s88 offen lds
    s_waitcnt lgkmcnt(4)
    v_mfma_f32_32x32x16_bf16 v[96:111], v[52:55], v[128:131], v[96:111]
    buffer_load_dwordx4 v3, s[20:23], s88 offen offset:1024 lds
    v_lshl_add_u32 v9, v177, 8, v179
    v_mfma_f32_32x32x16_bf16 v[112:127], v[52:55], v[132:135], v[112:127]
    v_add_u32 v9, 114688, v9
    v_xor_b32 v10, 128, v9
    s_waitcnt vmcnt(18) lgkmcnt(2)
    v_mfma_f32_32x32x16_bf16 v[64:79], v[56:59], v[136:139], v[64:79]
    ds_read_b64_tr_b16 v[48:49], v6 offset:6144
    ds_read_b64_tr_b16 v[50:51], v6 offset:7168
    s_xor_b32 s82, s89, 10
    s_lshl_b32 s82, s82, 10
    s_add_u32 s82, s82, s61
    buffer_load_dwordx4 v[128:131], v1, s[16:19], s82 offen sc1
    buffer_load_dwordx4 v[132:135], v12, s[16:19], s82 offen sc1
    v_mfma_f32_32x32x16_bf16 v[80:95], v[56:59], v[140:143], v[80:95]
    ds_read_b64_tr_b16 v[52:53], v7 offset:6144
    ds_read_b64_tr_b16 v[54:55], v7 offset:7168
    s_xor_b32 s88, s89, 26
    s_add_u32 m0, s60, 0
    s_mul_i32 s88, s88, 14336
    s_add_u32 s88, s88, s58
    buffer_load_dwordx4 v2, s[20:23], s88 offen lds
    buffer_load_dwordx4 v3, s[20:23], s88 offen offset:1024 lds
    s_waitcnt lgkmcnt(4)
    v_mfma_f32_32x32x16_bf16 v[96:111], v[60:63], v[136:139], v[96:111]
    v_add_u32 v0, 46592, v2
    v_cndmask_b32 v0, v2, v0, s[92:93]
    v_mfma_f32_32x32x16_bf16 v[112:127], v[60:63], v[140:143], v[112:127]
    v_bfe_u32 v16, v1, 4, 5
    v_and_b32 v17, 7, v16
    s_waitcnt vmcnt(18) lgkmcnt(2)
    v_mfma_f32_32x32x16_bf16 v[64:79], v[48:51], v[144:147], v[64:79]
    ds_read_b64_tr_b16 v[56:57], v6 offset:8192
    ds_read_b64_tr_b16 v[58:59], v6 offset:9216
    s_xor_b32 s82, s89, 11
    s_lshl_b32 s82, s82, 10
    s_add_u32 s82, s82, s61
    buffer_load_dwordx4 v[136:139], v1, s[16:19], s82 offen sc1
    buffer_load_dwordx4 v[140:143], v12, s[16:19], s82 offen sc1
    v_mfma_f32_32x32x16_bf16 v[80:95], v[48:51], v[148:151], v[80:95]
    ds_read_b64_tr_b16 v[60:61], v7 offset:8192
    ds_read_b64_tr_b16 v[62:63], v7 offset:9216
    s_xor_b32 s88, s89, 27
    s_add_u32 m0, s60, 2048
    s_mul_i32 s88, s88, 14336
    s_add_u32 s88, s88, s58
    buffer_load_dwordx4 v2, s[20:23], s88 offen lds
    buffer_load_dwordx4 v3, s[20:23], s88 offen offset:1024 lds
    s_waitcnt lgkmcnt(4)
    v_mfma_f32_32x32x16_bf16 v[96:111], v[52:55], v[144:147], v[96:111]
    v_bfe_u32 v18, v16, 1, 1
    v_lshrrev_b32 v19, 9, v1
    v_mfma_f32_32x32x16_bf16 v[112:127], v[52:55], v[148:151], v[112:127]
    v_xor_b32 v18, v18, v19
    v_lshl_add_u32 v17, v18, 3, v17
    s_waitcnt vmcnt(18) lgkmcnt(2)
    v_mfma_f32_32x32x16_bf16 v[64:79], v[56:59], v[152:155], v[64:79]
    ds_read_b64_tr_b16 v[48:49], v4 offset:0
    ds_read_b64_tr_b16 v[50:51], v4 offset:1024
    s_xor_b32 s82, s89, 24
    s_lshl_b32 s82, s82, 10
    s_add_u32 s82, s82, s61
    buffer_load_dwordx4 v[144:147], v1, s[16:19], s82 offen sc1
    v_mfma_f32_32x32x16_bf16 v[80:95], v[56:59], v[156:159], v[80:95]
    ds_read_b64_tr_b16 v[52:53], v5 offset:0
    ds_read_b64_tr_b16 v[54:55], v5 offset:1024
    buffer_load_dwordx4 v[148:151], v12, s[16:19], s82 offen sc1
    s_and_b32 s88, s89, 3
    s_xor_b32 s88, s88, 12
    s_add_u32 m0, s60, 4096
    s_mul_i32 s88, s88, 14336
    s_add_u32 s88, s88, s58
    buffer_load_dwordx4 v2, s[20:23], s88 offen lds
    s_waitcnt lgkmcnt(4)
    v_mfma_f32_32x32x16_bf16 v[96:111], v[60:63], v[152:155], v[96:111]
    buffer_load_dwordx4 v3, s[20:23], s88 offen offset:1024 lds
    v_lshlrev_b32 v17, 4, v17
    v_mfma_f32_32x32x16_bf16 v[112:127], v[60:63], v[156:159], v[112:127]
    v_lshl_add_u32 v17, v16, 8, v17
    v_add_u32 v24, s59, v17
    s_waitcnt vmcnt(18) lgkmcnt(2)
    v_mfma_f32_32x32x16_bf16 v[64:79], v[48:51], v[160:163], v[64:79]
    ds_read_b64_tr_b16 v[56:57], v4 offset:2048
    ds_read_b64_tr_b16 v[58:59], v4 offset:3072
    s_xor_b32 s82, s89, 25
    s_lshl_b32 s82, s82, 10
    s_add_u32 s82, s82, s61
    buffer_load_dwordx4 v[152:155], v1, s[16:19], s82 offen sc1
    buffer_load_dwordx4 v[156:159], v12, s[16:19], s82 offen sc1
    v_mfma_f32_32x32x16_bf16 v[80:95], v[48:51], v[164:167], v[80:95]
    ds_read_b64_tr_b16 v[60:61], v5 offset:2048
    ds_read_b64_tr_b16 v[62:63], v5 offset:3072
    s_and_b32 s88, s89, 3
    s_xor_b32 s88, s88, 13
    s_add_u32 m0, s60, 6144
    s_mul_i32 s88, s88, 14336
    s_add_u32 s88, s88, s58
    buffer_load_dwordx4 v2, s[20:23], s88 offen lds
    buffer_load_dwordx4 v3, s[20:23], s88 offen offset:1024 lds
    s_waitcnt lgkmcnt(4)
    v_mfma_f32_32x32x16_bf16 v[96:111], v[52:55], v[160:163], v[96:111]
    v_add_u32 v32, s60, v17
    v_xor_b32 v25, 16, v24
    v_mfma_f32_32x32x16_bf16 v[112:127], v[52:55], v[164:167], v[112:127]
    v_xor_b32 v26, 32, v24
    v_xor_b32 v27, 48, v24
    s_waitcnt vmcnt(18) lgkmcnt(2)
    v_mfma_f32_32x32x16_bf16 v[64:79], v[56:59], v[168:171], v[64:79]
    ds_read_b64_tr_b16 v[48:49], v4 offset:4096
    ds_read_b64_tr_b16 v[50:51], v4 offset:5120
    s_xor_b32 s82, s89, 26
    s_lshl_b32 s82, s82, 10
    s_add_u32 s82, s82, s61
    buffer_load_dwordx4 v[160:163], v1, s[16:19], s82 offen sc1
    v_mfma_f32_32x32x16_bf16 v[80:95], v[56:59], v[172:175], v[80:95]
    ds_read_b64_tr_b16 v[52:53], v5 offset:4096
    ds_read_b64_tr_b16 v[54:55], v5 offset:5120
    buffer_load_dwordx4 v[164:167], v12, s[16:19], s82 offen sc1
    s_and_b32 s88, s89, 3
    s_xor_b32 s88, s88, 14
    s_add_u32 m0, s60, 8192
    s_mul_i32 s88, s88, 14336
    s_add_u32 s88, s88, s58
    buffer_load_dwordx4 v2, s[20:23], s88 offen lds
    s_waitcnt lgkmcnt(4)
    v_mfma_f32_32x32x16_bf16 v[96:111], v[60:63], v[168:171], v[96:111]
    buffer_load_dwordx4 v3, s[20:23], s88 offen offset:1024 lds
    v_xor_b32 v28, 64, v24
    v_mfma_f32_32x32x16_bf16 v[112:127], v[60:63], v[172:175], v[112:127]
    v_xor_b32 v29, 80, v24
    v_xor_b32 v30, 96, v24
    s_waitcnt vmcnt(18) lgkmcnt(2)
    v_mfma_f32_32x32x16_bf16 v[64:79], v[48:51], v[128:131], v[64:79]
    ds_read_b64_tr_b16 v[56:57], v4 offset:6144
    ds_read_b64_tr_b16 v[58:59], v4 offset:7168
    s_xor_b32 s82, s89, 27
    s_lshl_b32 s82, s82, 10
    s_add_u32 s82, s82, s61
    buffer_load_dwordx4 v[168:171], v1, s[16:19], s82 offen sc1
    buffer_load_dwordx4 v[172:175], v12, s[16:19], s82 offen sc1
    v_mfma_f32_32x32x16_bf16 v[80:95], v[48:51], v[132:135], v[80:95]
    ds_read_b64_tr_b16 v[60:61], v5 offset:6144
    ds_read_b64_tr_b16 v[62:63], v5 offset:7168
    s_and_b32 s88, s89, 3
    s_xor_b32 s88, s88, 15
    s_add_u32 m0, s59, 0
    s_mul_i32 s88, s88, 14336
    s_add_u32 s88, s88, s58
    buffer_load_dwordx4 v2, s[20:23], s88 offen lds
    buffer_load_dwordx4 v3, s[20:23], s88 offen offset:1024 lds
    s_waitcnt lgkmcnt(4)
    v_mfma_f32_32x32x16_bf16 v[96:111], v[52:55], v[128:131], v[96:111]
    v_xor_b32 v31, 112, v24
    v_xor_b32 v33, 16, v32
    v_mfma_f32_32x32x16_bf16 v[112:127], v[52:55], v[132:135], v[112:127]
    v_xor_b32 v34, 32, v32
    v_xor_b32 v35, 48, v32
    s_waitcnt vmcnt(18) lgkmcnt(2)
    v_mfma_f32_32x32x16_bf16 v[64:79], v[56:59], v[136:139], v[64:79]
    ds_read_b64_tr_b16 v[48:49], v4 offset:8192
    ds_read_b64_tr_b16 v[50:51], v4 offset:9216
    s_and_b32 s82, s89, 3
    s_xor_b32 s82, s82, 12
    s_lshl_b32 s82, s82, 10
    s_add_u32 s82, s82, s61
    buffer_load_dwordx4 v[128:131], v1, s[16:19], s82 offen sc1
    buffer_load_dwordx4 v[132:135], v12, s[16:19], s82 offen sc1
    v_mfma_f32_32x32x16_bf16 v[80:95], v[56:59], v[140:143], v[80:95]
    ds_read_b64_tr_b16 v[52:53], v5 offset:8192
    ds_read_b64_tr_b16 v[54:55], v5 offset:9216
    s_add_u32 m0, s59, 2048
    s_add_u32 s88, s62, 0
    buffer_load_dwordx4 v2, s[24:27], s88 offen offset:0 lds
    s_add_u32 s88, s62, 6144
    buffer_load_dwordx4 v2, s[24:27], s88 offen offset:1024 lds
    s_waitcnt lgkmcnt(4)
    v_mfma_f32_32x32x16_bf16 v[96:111], v[60:63], v[136:139], v[96:111]
    v_xor_b32 v36, 64, v32
    v_xor_b32 v37, 80, v32
    v_mfma_f32_32x32x16_bf16 v[112:127], v[60:63], v[140:143], v[112:127]
    v_xor_b32 v38, 96, v32
    v_xor_b32 v39, 112, v32
    s_waitcnt vmcnt(18) lgkmcnt(2)
    v_mfma_f32_32x32x16_bf16 v[64:79], v[48:51], v[144:147], v[64:79]
    ds_read_b64_tr_b16 v[56:57], v4 offset:10240
    ds_read_b64_tr_b16 v[58:59], v4 offset:11264
    s_and_b32 s82, s89, 3
    s_xor_b32 s82, s82, 13
    s_lshl_b32 s82, s82, 10
    s_add_u32 s82, s82, s61
    buffer_load_dwordx4 v[136:139], v1, s[16:19], s82 offen sc1
    v_mfma_f32_32x32x16_bf16 v[80:95], v[48:51], v[148:151], v[80:95]
    ds_read_b64_tr_b16 v[60:61], v5 offset:10240
    ds_read_b64_tr_b16 v[62:63], v5 offset:11264
    buffer_load_dwordx4 v[140:143], v12, s[16:19], s82 offen sc1
    s_waitcnt lgkmcnt(4)
    v_mfma_f32_32x32x16_bf16 v[96:111], v[52:55], v[144:147], v[96:111]
    s_add_u32 m0, s59, 4096
    s_add_u32 s88, s62, 14336
    buffer_load_dwordx4 v2, s[24:27], s88 offen offset:0 lds
    v_mfma_f32_32x32x16_bf16 v[112:127], v[52:55], v[148:151], v[112:127]
    s_add_u32 s88, s62, 20480
    buffer_load_dwordx4 v0, s[24:27], s88 offen offset:1024 lds
    s_waitcnt vmcnt(18) lgkmcnt(2)
    v_mfma_f32_32x32x16_bf16 v[64:79], v[56:59], v[152:155], v[64:79]
    ds_read_b64_tr_b16 v[48:49], v6 offset:0
    ds_read_b64_tr_b16 v[50:51], v6 offset:1024
    s_and_b32 s82, s89, 3
    s_xor_b32 s82, s82, 14
    s_lshl_b32 s82, s82, 10
    s_add_u32 s82, s82, s61
    buffer_load_dwordx4 v[144:147], v1, s[16:19], s82 offen sc1
    v_mfma_f32_32x32x16_bf16 v[80:95], v[56:59], v[156:159], v[80:95]
    ds_read_b64_tr_b16 v[52:53], v7 offset:0
    ds_read_b64_tr_b16 v[54:55], v7 offset:1024
    buffer_load_dwordx4 v[148:151], v12, s[16:19], s82 offen sc1
    s_waitcnt lgkmcnt(4)
    v_mfma_f32_32x32x16_bf16 v[96:111], v[60:63], v[152:155], v[96:111]
    s_add_u32 m0, s59, 6144
    s_add_u32 s88, s62, 50176
    buffer_load_dwordx4 v2, s[24:27], s88 offen offset:0 lds
    v_mfma_f32_32x32x16_bf16 v[112:127], v[60:63], v[156:159], v[112:127]
    s_add_u32 s88, s62, 56320
    buffer_load_dwordx4 v2, s[24:27], s88 offen offset:1024 lds
    s_waitcnt vmcnt(18) lgkmcnt(2)
    v_mfma_f32_32x32x16_bf16 v[64:79], v[48:51], v[160:163], v[64:79]
    ds_read_b64_tr_b16 v[56:57], v6 offset:2048
    ds_read_b64_tr_b16 v[58:59], v6 offset:3072
    s_and_b32 s82, s89, 3
    s_xor_b32 s82, s82, 15
    s_lshl_b32 s82, s82, 10
    s_add_u32 s82, s82, s61
    buffer_load_dwordx4 v[152:155], v1, s[16:19], s82 offen sc1
    v_mfma_f32_32x32x16_bf16 v[80:95], v[48:51], v[164:167], v[80:95]
    ds_read_b64_tr_b16 v[60:61], v7 offset:2048
    ds_read_b64_tr_b16 v[62:63], v7 offset:3072
    buffer_load_dwordx4 v[156:159], v12, s[16:19], s82 offen sc1
    s_waitcnt lgkmcnt(4)
    v_mfma_f32_32x32x16_bf16 v[96:111], v[52:55], v[160:163], v[96:111]
    ds_read_b32 v11, v14
    s_add_u32 m0, s59, 8192
    s_add_u32 s88, s62, 64512
    buffer_load_dwordx4 v2, s[24:27], s88 offen offset:0 lds
    v_mfma_f32_32x32x16_bf16 v[112:127], v[52:55], v[164:167], v[112:127]
    s_add_u32 s88, s62, 99328
    buffer_load_dwordx4 v2, s[24:27], s88 offen offset:1024 lds
    s_waitcnt lgkmcnt(0)
    v_readfirstlane_b32 s95, v11
    s_nop 0
    s_cmp_lt_u32 s95, 7
    s_cbranch_scc0 L_p2ok23
    s_waitcnt vmcnt(18)
    v_mfma_f32_32x32x16_bf16 v[64:79], v[56:59], v[168:171], v[64:79]
    ds_read_b64_tr_b16 v[48:49], v6 offset:4096
    ds_read_b64_tr_b16 v[50:51], v6 offset:5120
    s_add_u32 m0, s59, 10240
    s_add_u32 s88, s62, 107520
    buffer_load_dwordx4 v2, s[24:27], s88 offen offset:0 lds
    v_mfma_f32_32x32x16_bf16 v[80:95], v[56:59], v[172:175], v[80:95]
    ds_read_b64_tr_b16 v[52:53], v7 offset:4096
    ds_read_b64_tr_b16 v[54:55], v7 offset:5120
    s_add_u32 s88, s62, 113664
    buffer_load_dwordx4 v2, s[24:27], s88 offen offset:1024 lds
    v_mfma_f32_32x32x16_bf16 v[96:111], v[60:63], v[168:171], v[96:111]
    s_add_u32 m0, s60, 0
    s_add_u32 s88, s62, 121856
    buffer_load_dwordx4 v0, s[24:27], s88 offen offset:0 lds
    v_mfma_f32_32x32x16_bf16 v[112:127], v[60:63], v[172:175], v[112:127]
    s_add_u32 s88, s62, 149504
    buffer_load_dwordx4 v2, s[24:27], s88 offen offset:1024 lds
    s_waitcnt vmcnt(18) lgkmcnt(2)
    v_mfma_f32_32x32x16_bf16 v[64:79], v[48:51], v[128:131], v[64:79]
    ds_read_b64_tr_b16 v[56:57], v6 offset:6144
    ds_read_b64_tr_b16 v[58:59], v6 offset:7168
    v_mfma_f32_32x32x16_bf16 v[80:95], v[48:51], v[132:135], v[80:95]
    ds_read_b64_tr_b16 v[60:61], v7 offset:6144
    ds_read_b64_tr_b16 v[62:63], v7 offset:7168
    s_add_u32 m0, s60, 2048
    s_add_u32 s88, s62, 157696
    buffer_load_dwordx4 v2, s[24:27], s88 offen offset:0 lds
    s_waitcnt lgkmcnt(4)
    v_mfma_f32_32x32x16_bf16 v[96:111], v[52:55], v[128:131], v[96:111]
    ds_read_b32 v11, v14
    v_mfma_f32_32x32x16_bf16 v[112:127], v[52:55], v[132:135], v[112:127]
    s_add_u32 s88, s62, 163840
    buffer_load_dwordx4 v2, s[24:27], s88 offen offset:1024 lds
    s_waitcnt lgkmcnt(0)
    v_readfirstlane_b32 s95, v11
    s_nop 0
    s_cmp_lt_u32 s95, 7
    s_cbranch_scc0 L_p2ok25
    s_waitcnt vmcnt(16)
    v_mfma_f32_32x32x16_bf16 v[64:79], v[56:59], v[136:139], v[64:79]
    ds_read_b64_tr_b16 v[48:49], v6 offset:8192
    ds_read_b64_tr_b16 v[50:51], v6 offset:9216
    v_mfma_f32_32x32x16_bf16 v[80:95], v[56:59], v[140:143], v[80:95]
    ds_read_b64_tr_b16 v[52:53], v7 offset:8192
    ds_read_b64_tr_b16 v[54:55], v7 offset:9216
    v_mfma_f32_32x32x16_bf16 v[96:111], v[60:63], v[136:139], v[96:111]
    v_mfma_f32_32x32x16_bf16 v[112:127], v[60:63], v[140:143], v[112:127]
    s_waitcnt vmcnt(12) lgkmcnt(2)
    v_mfma_f32_32x32x16_bf16 v[64:79], v[48:51], v[144:147], v[64:79]
    ds_read_b64_tr_b16 v[56:57], v4 offset:0
    ds_read_b64_tr_b16 v[58:59], v4 offset:1024
    v_mfma_f32_32x32x16_bf16 v[80:95], v[48:51], v[148:151], v[80:95]
    ds_read_b64_tr_b16 v[60:61], v5 offset:0
    ds_read_b64_tr_b16 v[62:63], v5 offset:1024
    s_waitcnt lgkmcnt(4)
    v_mfma_f32_32x32x16_bf16 v[96:111], v[52:55], v[144:147], v[96:111]
    ds_read_b32 v11, v14
    v_mfma_f32_32x32x16_bf16 v[112:127], v[52:55], v[148:151], v[112:127]
    s_waitcnt lgkmcnt(0)
    v_readfirstlane_b32 s95, v11
    s_nop 0
    s_cmp_lt_u32 s95, 7
    s_cbranch_scc0 L_p2ok27
    s_waitcnt vmcnt(8)
    v_mfma_f32_32x32x16_bf16 v[64:79], v[56:59], v[152:155], v[64:79]
    ds_read_b64_tr_b16 v[160:161], v4 offset:2048
    ds_read_b64_tr_b16 v[162:163], v4 offset:3072
    v_mfma_f32_32x32x16_bf16 v[80:95], v[56:59], v[156:159], v[80:95]
    ds_read_b64_tr_b16 v[164:165], v4 offset:4096
    ds_read_b64_tr_b16 v[166:167], v4 offset:5120
    v_mfma_f32_32x32x16_bf16 v[96:111], v[60:63], v[152:155], v[96:111]
    ds_read_b64_tr_b16 v[168:169], v4 offset:6144
    ds_read_b64_tr_b16 v[170:171], v4 offset:7168
    ds_read_b32 v11, v14
    v_mfma_f32_32x32x16_bf16 v[112:127], v[60:63], v[156:159], v[112:127]
    s_waitcnt vmcnt(6)
    ds_read_b64_tr_b16 v[172:173], v4 offset:8192
    ds_read_b64_tr_b16 v[174:175], v4 offset:9216
    s_waitcnt lgkmcnt(2)
    v_readfirstlane_b32 s95, v11
    s_nop 0
    s_cmp_lt_u32 s95, 7
    s_cbranch_scc1 L_slow18
L_ret18:
    buffer_load_dwordx4 v[192:195], v1, s[16:19], s96 offen offset:0 sc1
    buffer_load_dwordx4 v[200:203], v1, s[16:19], s96 offen offset:1024 sc1
    buffer_load_dwordx4 v[208:211], v1, s[16:19], s96 offen offset:2048 sc1
    buffer_load_dwordx4 v[216:219], v1, s[16:19], s96 offen offset:3072 sc1
    buffer_load_dwordx4 v[224:227], v1, s[16:19], s68 offen offset:0 sc1
    buffer_load_dwordx4 v[232:235], v1, s[16:19], s68 offen offset:1024 sc1
    buffer_load_dwordx4 v[240:243], v1, s[16:19], s68 offen offset:2048 sc1
L_p2tailk:
    s_waitcnt vmcnt(6) lgkmcnt(6)
    v_mfma_f32_32x32x16_bf16 v[64:79], v[160:163], v[192:195], v[64:79]
    buffer_load_dwordx4 v[196:199], v12, s[16:19], s96 offen offset:0 sc1
    ds_read_b64_tr_b16 v[176:177], v4 offset:10240
    ds_read_b64_tr_b16 v[178:179], v4 offset:11264
    s_waitcnt vmcnt(6) lgkmcnt(6)
    v_mfma_f32_32x32x16_bf16 v[64:79], v[164:167], v[200:203], v[64:79]
    buffer_load_dwordx4 v[204:207], v12, s[16:19], s96 offen offset:1024 sc1
    ds_read_b64_tr_b16 v[180:181], v6 offset:0
    ds_read_b64_tr_b16 v[182:183], v6 offset:1024
    s_waitcnt vmcnt(6) lgkmcnt(6)
    v_mfma_f32_32x32x16_bf16 v[64:79], v[168:171], v[208:211], v[64:79]
    buffer_load_dwordx4 v[212:215], v12, s[16:19], s96 offen offset:2048 sc1
    s_waitcnt vmcnt(7)
    ds_read_b64_tr_b16 v[184:185], v6 offset:2048
    ds_read_b64_tr_b16 v[186:187], v6 offset:3072
    s_waitcnt vmcnt(6) lgkmcnt(6)
    v_mfma_f32_32x32x16_bf16 v[64:79], v[172:175], v[216:219], v[64:79]
    buffer_load_dwordx4 v[220:223], v12, s[16:19], s96 offen offset:3072 sc1
    ds_read_b64_tr_b16 v[128:129], v5 offset:2048
    ds_read_b64_tr_b16 v[130:131], v5 offset:3072
    s_waitcnt vmcnt(6) lgkmcnt(6)
    v_mfma_f32_32x32x16_bf16 v[64:79], v[176:179], v[224:227], v[64:79]
    buffer_load_dwordx4 v[228:231], v12, s[16:19], s68 offen offset:0 sc1
    ds_read_b64_tr_b16 v[132:133], v5 offset:4096
    ds_read_b64_tr_b16 v[134:135], v5 offset:5120
    s_waitcnt vmcnt(6) lgkmcnt(6)
    v_mfma_f32_32x32x16_bf16 v[64:79], v[180:183], v[232:235], v[64:79]
    buffer_load_dwordx4 v[236:239], v12, s[16:19], s68 offen offset:1024 sc1
    ds_read_b64_tr_b16 v[136:137], v5 offset:6144
    ds_read_b64_tr_b16 v[138:139], v5 offset:7168
    s_waitcnt vmcnt(6) lgkmcnt(6)
    v_mfma_f32_32x32x16_bf16 v[64:79], v[184:187], v[240:243], v[64:79]
    buffer_load_dwordx4 v[244:247], v12, s[16:19], s68 offen offset:2048 sc1
    ds_read_b64_tr_b16 v[140:141], v5 offset:8192
    ds_read_b64_tr_b16 v[142:143], v5 offset:9216
    s_waitcnt lgkmcnt(6)
    v_mfma_f32_32x32x16_bf16 v[96:111], v[128:131], v[192:195], v[96:111]
    ds_read_b64_tr_b16 v[144:145], v5 offset:10240
    ds_read_b64_tr_b16 v[146:147], v5 offset:11264
    s_waitcnt lgkmcnt(6)
    v_mfma_f32_32x32x16_bf16 v[96:111], v[132:135], v[200:203], v[96:111]
    ds_read_b64_tr_b16 v[148:149], v7 offset:0
    ds_read_b64_tr_b16 v[150:151], v7 offset:1024
    s_waitcnt lgkmcnt(6)
    v_mfma_f32_32x32x16_bf16 v[96:111], v[136:139], v[208:211], v[96:111]
    ds_read_b64_tr_b16 v[152:153], v7 offset:2048
    ds_read_b64_tr_b16 v[154:155], v7 offset:3072
    s_waitcnt lgkmcnt(6)
    v_mfma_f32_32x32x16_bf16 v[96:111], v[140:143], v[216:219], v[96:111]
    s_waitcnt lgkmcnt(4)
    v_mfma_f32_32x32x16_bf16 v[96:111], v[144:147], v[224:227], v[96:111]
    s_waitcnt lgkmcnt(2)
    v_mfma_f32_32x32x16_bf16 v[96:111], v[148:151], v[232:235], v[96:111]
    s_waitcnt lgkmcnt(0)
    v_mfma_f32_32x32x16_bf16 v[96:111], v[152:155], v[240:243], v[96:111]
    ds_write_b128 v24, v[64:67]
    s_waitcnt vmcnt(6)
    v_mfma_f32_32x32x16_bf16 v[80:95], v[160:163], v[196:199], v[80:95]
    ds_write_b128 v25, v[68:71]
    s_waitcnt vmcnt(5)
    v_mfma_f32_32x32x16_bf16 v[80:95], v[164:167], v[204:207], v[80:95]
    s_waitcnt vmcnt(4)
    v_mfma_f32_32x32x16_bf16 v[80:95], v[168:171], v[212:215], v[80:95]
    ds_write_b128 v26, v[72:75]
    s_waitcnt vmcnt(3)
    v_mfma_f32_32x32x16_bf16 v[80:95], v[172:175], v[220:223], v[80:95]
    s_waitcnt vmcnt(2)
    v_mfma_f32_32x32x16_bf16 v[80:95], v[176:179], v[228:231], v[80:95]
    ds_write_b128 v27, v[76:79]
    s_waitcnt vmcnt(1)
    v_mfma_f32_32x32x16_bf16 v[80:95], v[180:183], v[236:239], v[80:95]
    s_waitcnt vmcnt(0)
    v_mfma_f32_32x32x16_bf16 v[80:95], v[184:187], v[244:247], v[80:95]
    ds_write_b128 v28, v[96:99]
    v_mfma_f32_32x32x16_bf16 v[112:127], v[128:131], v[196:199], v[112:127]
    v_mfma_f32_32x32x16_bf16 v[112:127], v[132:135], v[204:207], v[112:127]
    ds_write_b128 v29, v[100:103]
    v_mfma_f32_32x32x16_bf16 v[112:127], v[136:139], v[212:215], v[112:127]
    v_mfma_f32_32x32x16_bf16 v[112:127], v[140:143], v[220:223], v[112:127]
    ds_write_b128 v30, v[104:107]
    v_mfma_f32_32x32x16_bf16 v[112:127], v[144:147], v[228:231], v[112:127]
    v_mfma_f32_32x32x16_bf16 v[112:127], v[148:151], v[236:239], v[112:127]
    ds_write_b128 v31, v[108:111]
    v_mfma_f32_32x32x16_bf16 v[112:127], v[152:155], v[244:247], v[112:127]
    s_nop 0
    ds_write_b128 v32, v[80:83]
    ds_write_b128 v33, v[84:87]
    ds_write_b128 v34, v[88:91]
    ds_write_b128 v35, v[92:95]
    s_nop 6
    ds_write_b128 v36, v[112:115]
    ds_write_b128 v37, v[116:119]
    ds_write_b128 v38, v[120:123]
    ds_write_b128 v39, v[124:127]
    s_waitcnt lgkmcnt(0)
    s_barrier
    ds_read_b128 v[128:131], v9 offset:0
    ds_read_b128 v[132:135], v10 offset:0
    ds_read_b128 v[136:139], v9 offset:10240
    ds_read_b128 v[140:143], v10 offset:10240
    ds_read_b128 v[144:147], v9 offset:20480
    ds_read_b128 v[148:151], v10 offset:20480
    ds_read_b128 v[152:155], v9 offset:30720
    ds_read_b128 v[156:159], v10 offset:30720
    s_waitcnt lgkmcnt(6)
    v_pk_add_f32 v[248:249], v[248:249], v[128:129]
    v_pk_add_f32 v[250:251], v[250:251], v[130:131]
    v_pk_add_f32 v[252:253], v[252:253], v[132:133]
    v_pk_add_f32 v[254:255], v[254:255], v[134:135]
    s_waitcnt lgkmcnt(4)
    v_pk_add_f32 v[248:249], v[248:249], v[136:137]
    v_pk_add_f32 v[250:251], v[250:251], v[138:139]
    v_pk_add_f32 v[252:253], v[252:253], v[140:141]
    v_pk_add_f32 v[254:255], v[254:255], v[142:143]
    s_waitcnt lgkmcnt(2)
    v_pk_add_f32 v[248:249], v[248:249], v[144:145]
    v_pk_add_f32 v[250:251], v[250:251], v[146:147]
    v_pk_add_f32 v[252:253], v[252:253], v[148:149]
    v_pk_add_f32 v[254:255], v[254:255], v[150:151]
    s_waitcnt lgkmcnt(0)
    v_pk_add_f32 v[248:249], v[248:249], v[152:153]
    v_pk_add_f32 v[250:251], v[250:251], v[154:155]
    v_pk_add_f32 v[252:253], v[252:253], v[156:157]
    v_pk_add_f32 v[254:255], v[254:255], v[158:159]
    v_cvt_pk_bf16_f32 v248, v248, v249
    v_cvt_pk_bf16_f32 v249, v250, v251
    v_cvt_pk_bf16_f32 v250, v252, v253
    v_cvt_pk_bf16_f32 v251, v254, v255
    buffer_store_dwordx4 v[248:251], v8, s[28:31], s63 offen sc1
    s_branch L_fin
L_p2a:
    s_and_b32 s82, s80, 30
    s_lshr_b32 s83, s4, 1
    s_add_u32 s82, s82, s83
    s_and_b32 s83, s80, 1
    s_lshl1_add_u32 s82, s82, s83
    s_lshl3_add_u32 s82, s82, s7
    s_lshl_b32 s82, s82, 7
    s_add_u32 s73, s82, 0x920000
    s_and_b32 s83, s4, 1
    s_lshl3_add_u32 s88, s83, s73
    s_add_u32 s88, s88, 8
    v_mov_b32 v59, 3
L_pa19:
    s_buffer_load_dwordx2 s[82:83], s[16:19], s88 glc
    s_add_u32 s94, s94, 1
    s_cmp_gt_u32 s94, 0x10000
    s_waitcnt lgkmcnt(0)
    s_cbranch_scc1 L_pz19
    s_and_b32 s82, s82, s83
    s_cbranch_scc0 L_pa19
L_pz19:
    ds_write_b32 v45, v59
    v_bfe_u32 v49, v0, 3, 5
    v_and_b32 v50, 0x70, v1
    v_and_b32 v51, 7, v49
    v_bfe_u32 v52, v49, 1, 1
    v_lshl_add_u32 v51, v52, 3, v51
    v_lshlrev_b32 v51, 4, v51
    v_xor_b32 v51, v51, v50
    v_lshl_add_u32 v9, v49, 8, v51
    v_xor_b32 v10, 128, v9
    v_mov_b32 v63, 7
L_pa20:
    s_buffer_load_dword s82, s[16:19], s73 glc
    s_add_u32 s94, s94, 1
    s_cmp_gt_u32 s94, 0x10000
    s_waitcnt lgkmcnt(0)
    s_cbranch_scc1 L_pz20
    s_and_b32 s82, s82, s82
    s_cbranch_scc0 L_pa20
L_pz20:
    ds_write_b32 v45, v63
    s_waitcnt lgkmcnt(0)
    s_barrier
    ds_read_b128 v[128:131], v9 offset:0
    ds_read_b128 v[132:135], v10 offset:0
    ds_read_b128 v[136:139], v9 offset:12288
    ds_read_b128 v[140:143], v10 offset:12288
    ds_read_b128 v[144:147], v9 offset:24576
    ds_read_b128 v[148:151], v10 offset:24576
    ds_read_b128 v[152:155], v9 offset:36864
    ds_read_b128 v[156:159], v10 offset:36864
    s_waitcnt lgkmcnt(6)
    v_pk_add_f32 v[248:249], v[248:249], v[128:129]
    v_pk_add_f32 v[250:251], v[250:251], v[130:131]
    v_pk_add_f32 v[252:253], v[252:253], v[132:133]
    v_pk_add_f32 v[254:255], v[254:255], v[134:135]
    s_waitcnt lgkmcnt(4)
    v_pk_add_f32 v[248:249], v[248:249], v[136:137]
    v_pk_add_f32 v[250:251], v[250:251], v[138:139]
    v_pk_add_f32 v[252:253], v[252:253], v[140:141]
    v_pk_add_f32 v[254:255], v[254:255], v[142:143]
    s_waitcnt lgkmcnt(2)
    v_pk_add_f32 v[248:249], v[248:249], v[144:145]
    v_pk_add_f32 v[250:251], v[250:251], v[146:147]
    v_pk_add_f32 v[252:253], v[252:253], v[148:149]
    v_pk_add_f32 v[254:255], v[254:255], v[150:151]
    s_waitcnt lgkmcnt(0)
    v_pk_add_f32 v[248:249], v[248:249], v[152:153]
    v_pk_add_f32 v[250:251], v[250:251], v[154:155]
    v_pk_add_f32 v[252:253], v[252:253], v[156:157]
    v_pk_add_f32 v[254:255], v[254:255], v[158:159]
    v_cvt_pk_bf16_f32 v248, v248, v249
    v_cvt_pk_bf16_f32 v249, v250, v251
    v_cvt_pk_bf16_f32 v250, v252, v253
    v_cvt_pk_bf16_f32 v251, v254, v255
    buffer_store_dwordx4 v[248:251], v8, s[28:31], s63 offen sc1
L_fin:
L_end:
    s_endpgm
L_slow0:
    s_add_u32 s94, s94, 1
    s_cmp_gt_u32 s94, 0x10000
    s_cbranch_scc1 L_ret0
    buffer_load_dword v44, v46, s[40:43], 0 offen sc1
    s_waitcnt vmcnt(0)
    v_cmp_le_u32 vcc, 32, v44
    s_nop 1
    s_andn2_b32 s95, 0x1, vcc_lo
    s_cbranch_scc1 L_slow0
    s_branch L_ret0
L_slow2:
    s_add_u32 s94, s94, 1
    s_cmp_gt_u32 s94, 0x10000
    s_cbranch_scc1 L_ret2
    buffer_load_dword v44, v31, s[16:19], s73 offen offset:0 sc1
    s_waitcnt vmcnt(0)
    v_cmp_ne_u32 vcc, 0, v44
    s_nop 1
    s_andn2_b32 s95, 3, vcc_lo
    s_cbranch_scc1 L_slow2
    s_branch L_ret2
L_slow3:
    s_add_u32 s94, s94, 1
    s_cmp_gt_u32 s94, 0x10000
    s_cbranch_scc1 L_ret3
    buffer_load_dword v44, v46, s[40:43], 0 offen sc1
    s_waitcnt vmcnt(0)
    v_cmp_le_u32 vcc, 32, v44
    s_nop 1
    s_andn2_b32 s95, 0x1, vcc_lo
    s_cbranch_scc1 L_slow3
    s_branch L_ret3
L_slow6:
    s_add_u32 s94, s94, 1
    s_cmp_gt_u32 s94, 0x10000
    s_cbranch_scc1 L_ret6
    buffer_load_dword v44, v46, s[40:43], 0 offen sc1
    s_waitcnt vmcnt(0)
    v_cmp_le_u32 vcc, 32, v44
    s_nop 1
    s_andn2_b32 s95, 0x1, vcc_lo
    s_cbranch_scc1 L_slow6
    s_branch L_ret6
L_slow7:
    s_add_u32 s94, s94, 1
    s_cmp_gt_u32 s94, 0x10000
    s_cbranch_scc1 L_ret7
    buffer_load_dword v38, v39, s[16:19], s90 offen sc1
    s_waitcnt vmcnt(0)
    v_cmp_le_u32 vcc, 1, v38
    s_nop 1
    s_andn2_b32 s95, 0xffffffff, vcc_lo
    s_cbranch_scc1 L_slow7
    s_branch L_ret7
L_slow8:
    s_add_u32 s94, s94, 1
    s_cmp_gt_u32 s94, 0x10000
    s_cbranch_scc1 L_ret8
    buffer_load_dword v44, v31, s[16:19], s73 offen offset:0 sc1
    s_waitcnt vmcnt(0)
    v_cmp_ne_u32 vcc, 0, v44
    s_nop 1
    s_andn2_b32 s95, 3, vcc_lo
    s_cbranch_scc1 L_slow8
    s_branch L_ret8
L_slow9:
    s_add_u32 s94, s94, 1
    s_cmp_gt_u32 s94, 0x10000
    s_cbranch_scc1 L_ret9
    buffer_load_dword v44, v46, s[40:43], 0 offen sc1
    s_waitcnt vmcnt(0)
    v_cmp_le_u32 vcc, 32, v44
    s_nop 1
    s_andn2_b32 s95, 0x1, vcc_lo
    s_cbranch_scc1 L_slow9
    s_branch L_ret9
L_slow10:
    s_add_u32 s94, s94, 1
    s_cmp_gt_u32 s94, 0x10000
    s_cbranch_scc1 L_ret10
    buffer_load_dword v38, v39, s[16:19], s90 offen sc1
    s_waitcnt vmcnt(0)
    v_cmp_le_u32 vcc, 1, v38
    s_nop 1
    s_andn2_b32 s95, 0xffffffff, vcc_lo
    s_cbranch_scc1 L_slow10
    s_branch L_ret10
L_slow11:
    s_add_u32 s94, s94, 1
    s_cmp_gt_u32 s94, 0x10000
    s_cbranch_scc1 L_ret11
    buffer_load_dword v44, v31, s[16:19], s73 offen offset:0 sc1
    s_waitcnt vmcnt(0)
    v_cmp_ne_u32 vcc, 0, v44
    s_nop 1
    s_andn2_b32 s95, 3, vcc_lo
    s_cbranch_scc1 L_slow11
    s_branch L_ret11
L_slow12:
    s_add_u32 s94, s94, 1
    s_cmp_gt_u32 s94, 0x10000
    s_cbranch_scc1 L_ret12
    buffer_load_dword v44, v31, s[16:19], s73 offen offset:256 sc1
    s_waitcnt vmcnt(0)
    v_cmp_ne_u32 vcc, 0, v44
    s_nop 1
    s_andn2_b32 s95, 3, vcc_lo
    s_cbranch_scc1 L_slow12
    s_branch L_ret12
L_slow13:
    s_add_u32 s94, s94, 1
    s_cmp_gt_u32 s94, 0x80000
    s_cbranch_scc1 L_ret13
    ds_read_b32 v11, v14
    s_waitcnt lgkmcnt(0)
    v_readfirstlane_b32 s95, v11
    s_nop 0
    s_cmp_lt_u32 s95, 1
    s_cbranch_scc1 L_slow13
    s_branch L_ret13
L_slow14:
    s_add_u32 s94, s94, 1
    s_cmp_gt_u32 s94, 0x80000
    s_cbranch_scc1 L_ret14
    ds_read_b32 v11, v14
    s_waitcnt lgkmcnt(0)
    v_readfirstlane_b32 s95, v11
    s_nop 0
    s_cmp_lt_u32 s95, 3
    s_cbranch_scc1 L_slow14
    s_branch L_ret14
L_slow15:
    s_add_u32 s94, s94, 1
    s_cmp_gt_u32 s94, 0x80000
    s_cbranch_scc1 L_ret15
    ds_read_b32 v11, v14
    s_waitcnt lgkmcnt(0)
    v_readfirstlane_b32 s95, v11
    s_nop 0
    s_cmp_lt_u32 s95, 7
    s_cbranch_scc1 L_slow15
    s_branch L_ret15
L_slow16:
    s_add_u32 s94, s94, 1
    s_cmp_gt_u32 s94, 0x10000
    s_cbranch_scc1 L_ret16
    buffer_load_dword v44, v31, s[16:19], s73 offen offset:256 sc1
    s_waitcnt vmcnt(0)
    v_cmp_ne_u32 vcc, 0, v44
    s_nop 1
    s_andn2_b32 s95, 3, vcc_lo
    s_cbranch_scc1 L_slow16
    s_branch L_ret16
L_slow17:
    s_add_u32 s94, s94, 1
    s_cmp_gt_u32 s94, 0x80000
    s_cbranch_scc1 L_ret17
    ds_read_b32 v11, v14
    s_waitcnt lgkmcnt(0)
    v_readfirstlane_b32 s95, v11
    s_nop 0
    s_cmp_lt_u32 s95, 3
    s_cbranch_scc1 L_slow17
    s_branch L_ret17
L_slow18:
    s_add_u32 s94, s94, 1
    s_cmp_gt_u32 s94, 0x80000
    s_cbranch_scc1 L_ret18
    ds_read_b32 v11, v14
    s_waitcnt lgkmcnt(0)
    v_readfirstlane_b32 s95, v11
    s_nop 0
    s_cmp_lt_u32 s95, 7
    s_cbranch_scc1 L_slow18
    s_branch L_ret18
L_codeend:
.section .rodata,"a"
.p2align 6
.amdhsa_kernel parallel_sum__linear_attn_block__dense_activation_gelu__prompt_kernel
  .amdhsa_next_free_vgpr 256
  .amdhsa_next_free_sgpr 102
  .amdhsa_accum_offset 256
  .amdhsa_group_segment_fixed_size 0
  .amdhsa_kernarg_size 88
  .amdhsa_user_sgpr_count 2
  .amdhsa_user_sgpr_kernarg_segment_ptr 1
  .amdhsa_system_sgpr_workgroup_id_x 1
.end_amdhsa_kernel
```
